```python
import torch

def _softmax(x, axis=-1):
    return torch.softmax(x, dim=axis)

def _gelu(x):
    return torch.nn.functional.gelu(x, approximate='tanh')

def _silu(x):
    return torch.nn.functional.silu(x)

def _sigmoid(x):
    return torch.sigmoid(x)

def _layernorm(x, axis=-1, eps=1e-05):
    m = x.mean(dim=axis, keepdim=True)
    v = x.var(dim=axis, keepdim=True, unbiased=False)
    return (x - m) / torch.sqrt(v + eps)

def _scatter_add(tgt, idx, src, axis=0):
    return tgt.clone().index_add_(axis, idx, src)

def _segment_sum(src, seg, n):
    out = torch.zeros((n,) + src.shape[1:], dtype=src.dtype)
    return out.index_add_(0, seg, src)

def _pad(x, pw):
    flat = tuple((v for pair in reversed(pw) for v in pair))
    return torch.nn.functional.pad(x, flat)
kernel_name = 'sequential_preLN__memory_aug_recurrent_mem_tr__glu_gated_geglu__prompt'

def setup_inputs():

    _w = lambda a: (lambda t: t.to(torch.bfloat16) if t.is_floating_point() else t)(torch.as_tensor(a))

    def _A_setup():
        B, S, Dm = (1, 2048, 640)
        H, Dh = (32, 192)
        M, seg = (8, 32)
        seg = min(seg, S)
        S = S // seg * seg
        return {'x': _w((lambda *s: torch.randn(*s, dtype=torch.bfloat16) * 0.05)(B, S, Dm)), 'mem0': _w((lambda *s: torch.randn(*s, dtype=torch.bfloat16) * 0.2)(B, M, Dm)), 'Wq': _w((lambda *s: torch.randn(*s, dtype=torch.bfloat16) * 1.6)(Dm, H, Dh) * Dm ** (-0.5)), 'Wk': _w((lambda *s: torch.randn(*s, dtype=torch.bfloat16) * 1.6)(Dm, H, Dh) * Dm ** (-0.5)), 'Wv': _w((lambda *s: torch.randn(*s, dtype=torch.bfloat16) * 0.2)(Dm, H, Dh) * Dm ** (-0.5)), 'Wo': _w((lambda *s: torch.randn(*s, dtype=torch.bfloat16) * 0.2)(H, Dh, Dm) * (H * Dh) ** (-0.5)), 'seg_len': seg}
    _A_in = _A_setup()

    def _B_setup():
        B, S, Dm, Df = (1, 2048, 640, 1536)
        return {'x': _w((lambda *s: torch.randn(*s, dtype=torch.bfloat16) * 0.05)(B, S, Dm)), 'w_gate': _w((lambda *s: torch.randn(*s, dtype=torch.bfloat16) * 0.4)(Dm, Df) * Dm ** (-0.5)), 'w_up': _w((lambda *s: torch.randn(*s, dtype=torch.bfloat16) * 0.4)(Dm, Df) * Dm ** (-0.5)), 'w_down': _w((lambda *s: torch.randn(*s, dtype=torch.bfloat16) * 0.4)(Df, Dm) * Df ** (-0.5))}
    _B_in = _B_setup()
    return {'A_x': _A_in['x'], 'A_mem0': _A_in['mem0'], 'A_Wq': _A_in['Wq'], 'A_Wk': _A_in['Wk'], 'A_Wv': _A_in['Wv'], 'A_Wo': _A_in['Wo'], 'A_seg_len': _A_in['seg_len'], 'B_x': _B_in['x'], 'B_w_gate': _B_in['w_gate'], 'B_w_up': _B_in['w_up'], 'B_w_down': _B_in['w_down']}

def reference(A_x, A_mem0, A_Wq, A_Wk, A_Wv, A_Wo, A_seg_len, B_x, B_w_gate, B_w_up, B_w_down):

    def _A_ref(x, mem0, Wq, Wk, Wv, Wo, seg_len):
        B, S, Dm = x.shape
        H, Dh = (Wq.shape[1], Wq.shape[2])
        M = mem0.shape[1]
        scale = Dh ** (-0.5)
        n_seg = S // seg_len
        L = M + seg_len
        idx = torch.arange(L)
        mask = (idx[:, None] < M) | (idx[:, None] >= idx[None, :])
        mem = mem0
        outs = []
        for s in range(n_seg):
            xs = x[:, s * seg_len:(s + 1) * seg_len, :].clone()
            h = torch.concatenate([mem, xs], axis=1)
            q = torch.einsum('btd,dhe->bhte', h, Wq)
            k = torch.einsum('btd,dhe->bhte', h, Wk)
            v = torch.einsum('btd,dhe->bhte', h, Wv)
            scores = torch.einsum('bhqe,bhke->bhqk', q, k) * scale
            scores = torch.where(mask[None, None], scores, -1000000000.0)
            p = _softmax(scores, axis=-1)
            o = torch.einsum('bhqk,bhke->bhqe', p, v)
            o = torch.einsum('bhte,hed->btd', o, Wo)
            mem = o[:, :M, :].clone()
            outs.append(o[:, M:, :])
        return torch.concatenate(outs, axis=1)

    def _B_ref(x, w_gate, w_up, w_down):
        g = torch.einsum('bsd,df->bsf', x, w_gate)
        u = torch.einsum('bsd,df->bsf', x, w_up)
        h = _gelu(g) * u
        return torch.einsum('bsf,fd->bsd', h, w_down)
    x = A_x
    h = x + _A_ref(_layernorm(x, axis=-1), A_mem0, A_Wq, A_Wk, A_Wv, A_Wo, A_seg_len)
    h2 = h + _B_ref(_layernorm(h, axis=-1), B_w_gate, B_w_up, B_w_down)
    return h2
```

```asm
; @launch kernel=prep_kernel grid=(6596,1,1) block=(256,1,1) lds=8448
; @launch kernel=chain_kernel grid=(256,1,1) block=(256,1,1) lds=163840
.amdgcn_target "amdgcn-amd-amdhsa--gfx950"
.text
.p2align 8
.globl prep_kernel
.type prep_kernel,@function
prep_kernel:
    s_load_dwordx2 s[4:5], s[0:1], 104
    s_load_dwordx2 s[12:13], s[0:1], 0
    s_waitcnt lgkmcnt(0)
    s_and_b32 s5, s5, 0xffff
    s_mov_b32 s6, 268435456
    s_mov_b32 s7, 0x00020000
    s_and_b32 s13, s13, 0xffff
    s_mov_b32 s14, 2621440
    s_mov_b32 s15, 0x00020000
    s_cmp_ge_u32 s2, 6596
    s_cbranch_scc1 prep_done
    s_cmp_ge_u32 s2, 4560
    s_cbranch_scc1 prep_not_tr
prep_job0:
    s_cmp_ge_u32 s2, 960
    s_cbranch_scc1 prep_job1
    s_load_dwordx2 s[8:9], s[0:1], 16
    s_sub_u32 s21, s2, 0
    s_mul_hi_u32 s22, s21, 44739243
    s_mul_i32 s23, s22, 96
    s_sub_u32 s23, s21, s23
    s_mul_i32 s16, s22, 786432
    s_lshl_b32 s24, s23, 7
    s_add_u32 s16, s16, s24
    s_mov_b32 s17, 12288
    s_mov_b32 s20, 0
    s_mul_i32 s18, s23, 81920
    s_lshl_b32 s24, s22, 7
    s_add_u32 s18, s18, s24
    s_add_u32 s18, s18, 2621440
    s_mov_b32 s19, 1280
    s_waitcnt lgkmcnt(0)
    s_and_b32 s9, s9, 0xffff
    s_mov_b32 s10, 7864320
    s_mov_b32 s11, 0x00020000
    s_branch prep_tr_body
prep_job1:
    s_cmp_ge_u32 s2, 1920
    s_cbranch_scc1 prep_job2
    s_load_dwordx2 s[8:9], s[0:1], 24
    s_sub_u32 s21, s2, 960
    s_mul_hi_u32 s22, s21, 44739243
    s_mul_i32 s23, s22, 96
    s_sub_u32 s23, s21, s23
    s_mul_i32 s16, s22, 786432
    s_lshl_b32 s24, s23, 7
    s_add_u32 s16, s16, s24
    s_mov_b32 s17, 12288
    s_mov_b32 s20, 0
    s_mul_i32 s18, s23, 81920
    s_lshl_b32 s24, s22, 7
    s_add_u32 s18, s18, s24
    s_add_u32 s18, s18, 10485760
    s_mov_b32 s19, 1280
    s_waitcnt lgkmcnt(0)
    s_and_b32 s9, s9, 0xffff
    s_mov_b32 s10, 7864320
    s_mov_b32 s11, 0x00020000
    s_branch prep_tr_body
prep_job2:
    s_cmp_ge_u32 s2, 2880
    s_cbranch_scc1 prep_job3
    s_load_dwordx2 s[8:9], s[0:1], 32
    s_sub_u32 s21, s2, 1920
    s_mul_hi_u32 s22, s21, 44739243
    s_mul_i32 s23, s22, 96
    s_sub_u32 s23, s21, s23
    s_mul_i32 s16, s22, 786432
    s_lshl_b32 s24, s23, 7
    s_add_u32 s16, s16, s24
    s_mov_b32 s17, 12288
    s_mov_b32 s20, 0
    s_mul_i32 s18, s23, 81920
    s_lshl_b32 s24, s22, 7
    s_add_u32 s18, s18, s24
    s_add_u32 s18, s18, 18350080
    s_mov_b32 s19, 1280
    s_waitcnt lgkmcnt(0)
    s_and_b32 s9, s9, 0xffff
    s_mov_b32 s10, 7864320
    s_mov_b32 s11, 0x00020000
    s_branch prep_tr_body
prep_job3:
    s_cmp_ge_u32 s2, 3840
    s_cbranch_scc1 prep_job4
    s_load_dwordx2 s[8:9], s[0:1], 40
    s_sub_u32 s21, s2, 2880
    s_mul_hi_u32 s22, s21, 429496730
    s_mul_i32 s23, s22, 10
    s_sub_u32 s23, s21, s23
    s_mul_i32 s16, s22, 81920
    s_lshl_b32 s24, s23, 7
    s_add_u32 s16, s16, s24
    s_mov_b32 s17, 1280
    s_mov_b32 s20, 0
    s_mul_hi_u32 s24, s22, 1431655766
    s_mul_i32 s25, s24, 3
    s_sub_u32 s25, s22, s25
    s_mul_i32 s18, s24, 245760
    s_mul_i32 s24, s23, 24576
    s_add_u32 s18, s18, s24
    s_lshl_b32 s24, s25, 7
    s_add_u32 s18, s18, s24
    s_add_u32 s18, s18, 26214400
    s_mov_b32 s19, 384
    s_waitcnt lgkmcnt(0)
    s_and_b32 s9, s9, 0xffff
    s_mov_b32 s10, 7864320
    s_mov_b32 s11, 0x00020000
    s_branch prep_tr_body
prep_job4:
    s_cmp_ge_u32 s2, 4080
    s_cbranch_scc1 prep_job5
    s_load_dwordx2 s[8:9], s[0:1], 64
    s_sub_u32 s21, s2, 3840
    s_mul_hi_u32 s22, s21, 178956971
    s_mul_i32 s23, s22, 24
    s_sub_u32 s23, s21, s23
    s_mul_i32 s16, s22, 196608
    s_lshl_b32 s24, s23, 7
    s_add_u32 s16, s16, s24
    s_mov_b32 s17, 3072
    s_mov_b32 s20, 0
    s_mul_i32 s18, s23, 163840
    s_lshl_b32 s24, s22, 7
    s_add_u32 s18, s18, s24
    s_add_u32 s18, s18, 34078720
    s_mov_b32 s19, 1280
    s_mov_b32 s20, 1
    s_waitcnt lgkmcnt(0)
    s_and_b32 s9, s9, 0xffff
    s_mov_b32 s10, 1966080
    s_mov_b32 s11, 0x00020000
    s_branch prep_tr_body
prep_job5:
    s_cmp_ge_u32 s2, 4320
    s_cbranch_scc1 prep_job6
    s_load_dwordx2 s[8:9], s[0:1], 72
    s_sub_u32 s21, s2, 4080
    s_mul_hi_u32 s22, s21, 178956971
    s_mul_i32 s23, s22, 24
    s_sub_u32 s23, s21, s23
    s_mul_i32 s16, s22, 196608
    s_lshl_b32 s24, s23, 7
    s_add_u32 s16, s16, s24
    s_mov_b32 s17, 3072
    s_mov_b32 s20, 0
    s_mul_i32 s18, s23, 163840
    s_lshl_b32 s24, s22, 7
    s_add_u32 s18, s18, s24
    s_add_u32 s18, s18, 34099200
    s_mov_b32 s19, 1280
    s_mov_b32 s20, 1
    s_waitcnt lgkmcnt(0)
    s_and_b32 s9, s9, 0xffff
    s_mov_b32 s10, 1966080
    s_mov_b32 s11, 0x00020000
    s_branch prep_tr_body
prep_job6:
    s_cmp_ge_u32 s2, 4560
    s_cbranch_scc1 prep_job7
    s_load_dwordx2 s[8:9], s[0:1], 80
    s_sub_u32 s21, s2, 4320
    s_mul_hi_u32 s22, s21, 429496730
    s_mul_i32 s23, s22, 10
    s_sub_u32 s23, s21, s23
    s_mul_i32 s16, s22, 81920
    s_lshl_b32 s24, s23, 7
    s_add_u32 s16, s16, s24
    s_mov_b32 s17, 1280
    s_mov_b32 s20, 0
    s_mul_i32 s18, s23, 196608
    s_lshl_b32 s24, s22, 7
    s_add_u32 s18, s18, s24
    s_add_u32 s18, s18, 38010880
    s_mov_b32 s19, 3072
    s_waitcnt lgkmcnt(0)
    s_and_b32 s9, s9, 0xffff
    s_mov_b32 s10, 1966080
    s_mov_b32 s11, 0x00020000
    s_branch prep_tr_body
prep_job7:
    s_branch prep_done
prep_tr_body:
    v_lshrrev_b32 v1, 3, v0
    v_and_b32 v2, 7, v0
    v_mul_lo_u32 v3, v1, s17
    v_lshl_add_u32 v3, v2, 4, v3
    s_lshl_b32 s24, s17, 5
    s_add_u32 s25, s16, s24
    buffer_load_dwordx4 v[4:7], v3, s[8:11], s16 offen
    buffer_load_dwordx4 v[8:11], v3, s[8:11], s25 offen
    v_mul_u32_u24 v12, 132, v1
    v_lshl_add_u32 v12, v2, 4, v12
    s_waitcnt vmcnt(0)
    ds_write_b32 v12, v4 offset:0
    ds_write_b32 v12, v8 offset:4224
    ds_write_b32 v12, v5 offset:4
    ds_write_b32 v12, v9 offset:4228
    ds_write_b32 v12, v6 offset:8
    ds_write_b32 v12, v10 offset:4232
    ds_write_b32 v12, v7 offset:12
    ds_write_b32 v12, v11 offset:4236
    s_waitcnt lgkmcnt(0)
    s_barrier
    v_lshrrev_b32 v1, 2, v0
    v_and_b32 v2, 3, v0
    v_mul_u32_u24 v12, 2112, v2
    v_lshl_add_u32 v12, v1, 1, v12
    ds_read_u16 v4, v12 offset:0
    ds_read_u16 v16, v12 offset:132
    ds_read_u16 v5, v12 offset:264
    ds_read_u16 v17, v12 offset:396
    ds_read_u16 v6, v12 offset:528
    ds_read_u16 v18, v12 offset:660
    ds_read_u16 v7, v12 offset:792
    ds_read_u16 v19, v12 offset:924
    ds_read_u16 v8, v12 offset:1056
    ds_read_u16 v20, v12 offset:1188
    ds_read_u16 v9, v12 offset:1320
    ds_read_u16 v21, v12 offset:1452
    ds_read_u16 v10, v12 offset:1584
    ds_read_u16 v22, v12 offset:1716
    ds_read_u16 v11, v12 offset:1848
    ds_read_u16 v23, v12 offset:1980
    v_lshrrev_b32 v13, 4, v1
    v_lshlrev_b32 v13, 5, v13
    v_and_b32 v14, 15, v1
    v_add_u32 v13, v13, v14
    s_cmp_eq_u32 s20, 1
    s_cselect_b64 s[26:27], -1, 0
    v_cndmask_b32 v1, v1, v13, s[26:27]
    v_mul_lo_u32 v3, v1, s19
    v_lshl_add_u32 v3, v2, 5, v3
    s_waitcnt lgkmcnt(0)
    v_lshl_or_b32 v4, v16, 16, v4
    v_lshl_or_b32 v5, v17, 16, v5
    v_lshl_or_b32 v6, v18, 16, v6
    v_lshl_or_b32 v7, v19, 16, v7
    v_lshl_or_b32 v8, v20, 16, v8
    v_lshl_or_b32 v9, v21, 16, v9
    v_lshl_or_b32 v10, v22, 16, v10
    v_lshl_or_b32 v11, v23, 16, v11
    buffer_store_dwordx4 v[4:7], v3, s[4:7], s18 offen
    buffer_store_dwordx4 v[8:11], v3, s[4:7], s18 offen offset:16
    s_branch prep_done
prep_not_tr:
    s_cmp_ge_u32 s2, 5072
    s_cbranch_scc1 prep_fill
    s_sub_u32 s16, s2, 4560
    s_lshl_b32 s16, s16, 2
    v_lshrrev_b32 v1, 6, v0
    v_add_u32 v1, s16, v1
    v_mul_u32_u24 v1, 1280, v1
    v_and_b32 v2, 63, v0
    v_lshl_add_u32 v1, v2, 2, v1
    v_add_u32 v2, 0, v1
    buffer_load_dword v3, v1, s[12:15], 0 offen offset:0
    buffer_load_dword v4, v1, s[12:15], 0 offen offset:256
    buffer_load_dword v5, v1, s[12:15], 0 offen offset:512
    buffer_load_dword v6, v1, s[12:15], 0 offen offset:768
    buffer_load_dword v7, v1, s[12:15], 0 offen offset:1024
    s_waitcnt vmcnt(0)
    v_lshlrev_b32 v8, 16, v3
    v_and_b32 v9, 0xffff0000, v3
    v_lshlrev_b32 v10, 16, v4
    v_and_b32 v11, 0xffff0000, v4
    v_lshlrev_b32 v12, 16, v5
    v_and_b32 v13, 0xffff0000, v5
    v_lshlrev_b32 v14, 16, v6
    v_and_b32 v15, 0xffff0000, v6
    v_lshlrev_b32 v16, 16, v7
    v_and_b32 v17, 0xffff0000, v7
    v_add_f32 v18, v8, v9
    v_add_f32 v18, v18, v10
    v_add_f32 v18, v18, v11
    v_add_f32 v18, v18, v12
    v_add_f32 v18, v18, v13
    v_add_f32 v18, v18, v14
    v_add_f32 v18, v18, v15
    v_add_f32 v18, v18, v16
    v_add_f32 v18, v18, v17
    s_nop 1
    v_add_f32_dpp v18, v18, v18 row_shr:1 row_mask:0xf bank_mask:0xf bound_ctrl:0
    s_nop 1
    v_add_f32_dpp v18, v18, v18 row_shr:2 row_mask:0xf bank_mask:0xf bound_ctrl:0
    s_nop 1
    v_add_f32_dpp v18, v18, v18 row_shr:4 row_mask:0xf bank_mask:0xf bound_ctrl:0
    s_nop 1
    v_add_f32_dpp v18, v18, v18 row_shr:8 row_mask:0xf bank_mask:0xf bound_ctrl:0
    s_nop 1
    v_add_f32_dpp v18, v18, v18 row_bcast:15 row_mask:0xa bank_mask:0xf
    s_nop 1
    v_add_f32_dpp v18, v18, v18 row_bcast:31 row_mask:0xc bank_mask:0xf
    s_nop 0
    v_readlane_b32 s20, v18, 63
    s_nop 1
    v_mov_b32 v19, 0x3acccccd
    v_mul_f32 v19, s20, v19
    v_sub_f32 v20, v8, v19
    v_mul_f32 v18, v20, v20
    v_sub_f32 v20, v9, v19
    v_fmac_f32 v18, v20, v20
    v_sub_f32 v20, v10, v19
    v_fmac_f32 v18, v20, v20
    v_sub_f32 v20, v11, v19
    v_fmac_f32 v18, v20, v20
    v_sub_f32 v20, v12, v19
    v_fmac_f32 v18, v20, v20
    v_sub_f32 v20, v13, v19
    v_fmac_f32 v18, v20, v20
    v_sub_f32 v20, v14, v19
    v_fmac_f32 v18, v20, v20
    v_sub_f32 v20, v15, v19
    v_fmac_f32 v18, v20, v20
    v_sub_f32 v20, v16, v19
    v_fmac_f32 v18, v20, v20
    v_sub_f32 v20, v17, v19
    v_fmac_f32 v18, v20, v20
    s_nop 1
    v_add_f32_dpp v18, v18, v18 row_shr:1 row_mask:0xf bank_mask:0xf bound_ctrl:0
    s_nop 1
    v_add_f32_dpp v18, v18, v18 row_shr:2 row_mask:0xf bank_mask:0xf bound_ctrl:0
    s_nop 1
    v_add_f32_dpp v18, v18, v18 row_shr:4 row_mask:0xf bank_mask:0xf bound_ctrl:0
    s_nop 1
    v_add_f32_dpp v18, v18, v18 row_shr:8 row_mask:0xf bank_mask:0xf bound_ctrl:0
    s_nop 1
    v_add_f32_dpp v18, v18, v18 row_bcast:15 row_mask:0xa bank_mask:0xf
    s_nop 1
    v_add_f32_dpp v18, v18, v18 row_bcast:31 row_mask:0xc bank_mask:0xf
    s_nop 0
    v_readlane_b32 s21, v18, 63
    s_nop 1
    v_mov_b32 v20, 0x3acccccd
    v_mul_f32 v20, s21, v20
    v_cvt_pk_bf16_f32 v21, v19, v20
    v_lshlrev_b32 v19, 16, v21
    v_and_b32 v20, 0xffff0000, v21
    v_add_f32 v20, 0x3727c5ac, v20
    v_cvt_pk_bf16_f32 v20, v20, v20
    v_lshlrev_b32 v20, 16, v20
    v_sqrt_f32 v20, v20
    s_nop 0
    v_cvt_pk_bf16_f32 v20, v20, v20
    v_lshlrev_b32 v20, 16, v20
    v_rcp_f32 v20, v20
    s_nop 0
    v_sub_f32 v22, v8, v19
    v_sub_f32 v23, v9, v19
    v_cvt_pk_bf16_f32 v24, v22, v23
    v_lshlrev_b32 v22, 16, v24
    v_and_b32 v23, 0xffff0000, v24
    v_mul_f32 v22, v22, v20
    v_mul_f32 v23, v23, v20
    v_cvt_pk_bf16_f32 v25, v22, v23
    v_sub_f32 v22, v10, v19
    v_sub_f32 v23, v11, v19
    v_cvt_pk_bf16_f32 v24, v22, v23
    v_lshlrev_b32 v22, 16, v24
    v_and_b32 v23, 0xffff0000, v24
    v_mul_f32 v22, v22, v20
    v_mul_f32 v23, v23, v20
    v_cvt_pk_bf16_f32 v26, v22, v23
    v_sub_f32 v22, v12, v19
    v_sub_f32 v23, v13, v19
    v_cvt_pk_bf16_f32 v24, v22, v23
    v_lshlrev_b32 v22, 16, v24
    v_and_b32 v23, 0xffff0000, v24
    v_mul_f32 v22, v22, v20
    v_mul_f32 v23, v23, v20
    v_cvt_pk_bf16_f32 v27, v22, v23
    v_sub_f32 v22, v14, v19
    v_sub_f32 v23, v15, v19
    v_cvt_pk_bf16_f32 v24, v22, v23
    v_lshlrev_b32 v22, 16, v24
    v_and_b32 v23, 0xffff0000, v24
    v_mul_f32 v22, v22, v20
    v_mul_f32 v23, v23, v20
    v_cvt_pk_bf16_f32 v28, v22, v23
    v_sub_f32 v22, v16, v19
    v_sub_f32 v23, v17, v19
    v_cvt_pk_bf16_f32 v24, v22, v23
    v_lshlrev_b32 v22, 16, v24
    v_and_b32 v23, 0xffff0000, v24
    v_mul_f32 v22, v22, v20
    v_mul_f32 v23, v23, v20
    v_cvt_pk_bf16_f32 v29, v22, v23
    buffer_store_dword v25, v2, s[4:7], 0 offen offset:0
    buffer_store_dword v26, v2, s[4:7], 0 offen offset:256
    buffer_store_dword v27, v2, s[4:7], 0 offen offset:512
    buffer_store_dword v28, v2, s[4:7], 0 offen offset:768
    buffer_store_dword v29, v2, s[4:7], 0 offen offset:1024
    s_branch prep_done
prep_fill:
    s_cmp_ge_u32 s2, 6595
    s_cbranch_scc1 prep_mem0
    s_sub_u32 s16, s2, 5072
    s_lshl_b32 s16, s16, 14
    s_add_u32 s16, s16, 199370752
    v_lshlrev_b32 v1, 4, v0
    v_mov_b32 v4, -1
    v_mov_b32 v5, -1
    v_mov_b32 v6, -1
    v_mov_b32 v7, -1
    s_add_u32 s17, s16, 0
    buffer_store_dwordx4 v[4:7], v1, s[4:7], s17 offen
    s_add_u32 s17, s16, 4096
    buffer_store_dwordx4 v[4:7], v1, s[4:7], s17 offen
    s_add_u32 s17, s16, 8192
    buffer_store_dwordx4 v[4:7], v1, s[4:7], s17 offen
    s_add_u32 s17, s16, 12288
    buffer_store_dwordx4 v[4:7], v1, s[4:7], s17 offen
    s_branch prep_done
prep_mem0:
    s_load_dwordx2 s[8:9], s[0:1], 8
    s_waitcnt lgkmcnt(0)
    s_and_b32 s9, s9, 0xffff
    s_mov_b32 s10, 10240
    s_mov_b32 s11, 0x00020000
    s_mov_b32 s16, 199360512
    v_add_u32 v20, 0, v0
    v_lshrrev_b32 v21, 4, v20
    v_bfe_u32 v22, v20, 1, 3
    v_and_b32 v23, 1, v20
    v_mul_u32_u24 v24, 1280, v22
    v_lshl_add_u32 v24, v21, 5, v24
    v_lshl_add_u32 v24, v23, 4, v24
    v_lshlrev_b32 v1, 4, v20
    buffer_load_dwordx4 v[4:7], v24, s[8:11], 0 offen
    v_add_u32 v20, 256, v0
    v_lshrrev_b32 v21, 4, v20
    v_bfe_u32 v22, v20, 1, 3
    v_and_b32 v23, 1, v20
    v_mul_u32_u24 v24, 1280, v22
    v_lshl_add_u32 v24, v21, 5, v24
    v_lshl_add_u32 v24, v23, 4, v24
    v_lshlrev_b32 v2, 4, v20
    buffer_load_dwordx4 v[8:11], v24, s[8:11], 0 offen
    v_add_u32 v20, 512, v0
    v_lshrrev_b32 v21, 4, v20
    v_bfe_u32 v22, v20, 1, 3
    v_and_b32 v23, 1, v20
    v_mul_u32_u24 v24, 1280, v22
    v_lshl_add_u32 v24, v21, 5, v24
    v_lshl_add_u32 v24, v23, 4, v24
    v_lshlrev_b32 v3, 4, v20
    buffer_load_dwordx4 v[12:15], v24, s[8:11], 0 offen
    s_waitcnt vmcnt(0)
    buffer_store_dwordx4 v[4:7], v1, s[4:7], s16 offen
    buffer_store_dwordx4 v[8:11], v2, s[4:7], s16 offen
    v_cmp_gt_u32 vcc, 128, v0
    s_and_saveexec_b64 s[20:21], vcc
    buffer_store_dwordx4 v[12:15], v3, s[4:7], s16 offen
    s_mov_b64 exec, s[20:21]
    v_mov_b32 v16, 0
    v_mov_b32 v17, 0
    v_mov_b32 v18, 0
    v_mov_b32 v19, 0
    v_lshlrev_b32 v1, 4, v0
    s_mov_b32 s16, 224329728
    buffer_store_dwordx4 v[16:19], v1, s[4:7], s16 offen
    s_mov_b32 s16, 224333824
    buffer_store_dwordx4 v[16:19], v1, s[4:7], s16 offen
    s_mov_b32 s16, 224337920
    buffer_store_dwordx4 v[16:19], v1, s[4:7], s16 offen
    s_mov_b32 s16, 224342016
    buffer_store_dwordx4 v[16:19], v1, s[4:7], s16 offen
    s_mov_b32 s16, 224346112
    buffer_store_dwordx4 v[16:19], v1, s[4:7], s16 offen
    s_mov_b32 s16, 224350208
    buffer_store_dwordx4 v[16:19], v1, s[4:7], s16 offen
    s_mov_b32 s16, 224354304
    buffer_store_dwordx4 v[16:19], v1, s[4:7], s16 offen
    s_mov_b32 s16, 224358400
    buffer_store_dwordx4 v[16:19], v1, s[4:7], s16 offen
prep_done:
    s_endpgm
.p2align 8
.globl chain_kernel
.type chain_kernel,@function
chain_kernel:
    s_load_dwordx2 s[4:5], s[0:1], 104
    s_load_dwordx2 s[8:9], s[0:1], 0
    s_load_dwordx2 s[12:13], s[0:1], 88
    s_waitcnt lgkmcnt(0)
    s_and_b32 s5, s5, 0xffff
    s_mov_b32 s6, 268435456
    s_mov_b32 s7, 0x00020000
    s_and_b32 s9, s9, 0xffff
    s_mov_b32 s10, 2621440
    s_mov_b32 s11, 0x00020000
    s_and_b32 s13, s13, 0xffff
    s_mov_b32 s14, 2621440
    s_mov_b32 s15, 0x00020000
    s_mov_b32 s40, 0x00ff00ff
    s_mov_b32 s41, 0x00ff00ff
    s_mov_b32 s42, -1
    s_mov_b32 s43, 0
    s_cmp_ge_u32 s2, 256
    s_cbranch_scc1 chain_done
    s_cmp_ge_u32 s2, 104
    s_cbranch_scc1 chain_worker
    s_cmp_ge_u32 s2, 64
    s_cbranch_scc1 chain_red
    s_cmp_ge_u32 s2, 32
    s_cbranch_scc1 chain_vo
    v_and_b32 v1, 15, v0
    v_bfe_u32 v2, v0, 4, 2
    v_lshrrev_b32 v3, 6, v0
    s_nop 0
    v_readfirstlane_b32 s28, v3
    v_and_b32 v48, 63, v0
    v_add_u32 v49, 0, v48
    v_min_u32 v49, 159, v49
    v_mul_u32_u24 v52, 2560, v3
    v_lshl_add_u32 v4, v49, 4, v52
    v_lshrrev_b32 v50, 4, v49
    v_mul_u32_u24 v52, 10, v3
    v_add_u32 v50, v50, v52
    v_bfe_u32 v51, v49, 1, 3
    v_mul_u32_u24 v7, 1312, v51
    v_lshl_add_u32 v7, v50, 5, v7
    v_and_b32 v51, 1, v49
    v_lshl_add_u32 v7, v51, 4, v7
    v_add_u32 v7, 90112, v7
    v_add_u32 v49, 64, v48
    v_min_u32 v49, 159, v49
    v_mul_u32_u24 v52, 2560, v3
    v_lshl_add_u32 v5, v49, 4, v52
    v_lshrrev_b32 v50, 4, v49
    v_mul_u32_u24 v52, 10, v3
    v_add_u32 v50, v50, v52
    v_bfe_u32 v51, v49, 1, 3
    v_mul_u32_u24 v8, 1312, v51
    v_lshl_add_u32 v8, v50, 5, v8
    v_and_b32 v51, 1, v49
    v_lshl_add_u32 v8, v51, 4, v8
    v_add_u32 v8, 90112, v8
    v_add_u32 v49, 128, v48
    v_min_u32 v49, 159, v49
    v_mul_u32_u24 v52, 2560, v3
    v_lshl_add_u32 v6, v49, 4, v52
    v_lshrrev_b32 v50, 4, v49
    v_mul_u32_u24 v52, 10, v3
    v_add_u32 v50, v50, v52
    v_bfe_u32 v51, v49, 1, 3
    v_mul_u32_u24 v9, 1312, v51
    v_lshl_add_u32 v9, v50, 5, v9
    v_and_b32 v51, 1, v49
    v_lshl_add_u32 v9, v51, 4, v9
    v_add_u32 v9, 90112, v9
    v_and_b32 v48, 7, v1
    v_mul_u32_u24 v10, 1312, v48
    v_lshl_add_u32 v10, v2, 4, v10
    v_add_u32 v10, 90112, v10
    v_and_b32 v49, 63, v0
    v_mul_u32_u24 v11, 22528, v3
    v_lshl_add_u32 v11, v49, 4, v11
    v_xor_b32 v22, 16, v49
    v_lshlrev_b32 v22, 2, v22
    v_xor_b32 v23, 32, v49
    v_lshlrev_b32 v23, 2, v23
    v_lshrrev_b32 v50, 1, v3
    v_mul_u32_u24 v12, 3328, v50
    v_add_u32 v12, 100608, v12
    v_mul_u32_u24 v51, 416, v48
    v_add_u32 v12, v12, v51
    v_and_b32 v52, 1, v3
    v_mul_u32_u24 v52, 192, v52
    v_lshl_add_u32 v52, v2, 3, v52
    v_add_u32 v12, v12, v52
    v_mul_u32_u24 v13, 384, v48
    v_add_u32 v13, v13, v52
    s_mul_i32 s16, s2, 3072
    s_add_u32 s16, s16, 224362496
    v_add_u32 v13, s16, v13
    v_subrev_u32 v50, 1, v3
    v_max_i32 v50, 0, v50
    v_lshl_add_u32 v50, v50, 8, v49
    s_mul_i32 s17, s2, 384
    s_add_u32 s17, s17, 39989248
    v_add_u32 v51, 0, v50
    v_mul_u32_u24 v52, 2731, v51
    v_lshrrev_b32 v52, 16, v52
    v_mul_u32_u24 v53, 24, v52
    v_sub_u32 v53, v51, v53
    v_lshlrev_b32 v53, 4, v53
    v_mul_u32_u24 v14, 36864, v52
    v_add_u32 v14, v14, v53
    v_add_u32 v14, s17, v14
    v_mul_u32_u24 v18, 416, v52
    v_add_u32 v18, v18, v53
    v_add_u32 v18, 107264, v18
    v_add_u32 v51, 64, v50
    v_mul_u32_u24 v52, 2731, v51
    v_lshrrev_b32 v52, 16, v52
    v_mul_u32_u24 v53, 24, v52
    v_sub_u32 v53, v51, v53
    v_lshlrev_b32 v53, 4, v53
    v_mul_u32_u24 v15, 36864, v52
    v_add_u32 v15, v15, v53
    v_add_u32 v15, s17, v15
    v_mul_u32_u24 v19, 416, v52
    v_add_u32 v19, v19, v53
    v_add_u32 v19, 107264, v19
    v_add_u32 v51, 128, v50
    v_mul_u32_u24 v52, 2731, v51
    v_lshrrev_b32 v52, 16, v52
    v_mul_u32_u24 v53, 24, v52
    v_sub_u32 v53, v51, v53
    v_lshlrev_b32 v53, 4, v53
    v_mul_u32_u24 v16, 36864, v52
    v_add_u32 v16, v16, v53
    v_add_u32 v16, s17, v16
    v_mul_u32_u24 v20, 416, v52
    v_add_u32 v20, v20, v53
    v_add_u32 v20, 107264, v20
    v_add_u32 v51, 192, v50
    v_mul_u32_u24 v52, 2731, v51
    v_lshrrev_b32 v52, 16, v52
    v_mul_u32_u24 v53, 24, v52
    v_sub_u32 v53, v51, v53
    v_lshlrev_b32 v53, 4, v53
    v_mul_u32_u24 v17, 36864, v52
    v_add_u32 v17, v17, v53
    v_add_u32 v17, s17, v17
    v_mul_u32_u24 v21, 416, v52
    v_add_u32 v21, v21, v53
    v_add_u32 v21, 107264, v21
    v_add_u32 v51, -8, v1
    v_max_i32 v51, 0, v51
    v_min_i32 v51, 31, v51
    v_mul_u32_u24 v24, 416, v51
    v_lshl_add_u32 v24, v2, 4, v24
    v_add_u32 v24, 107264, v24
    v_add_u32 v51, 8, v1
    v_max_i32 v51, 0, v51
    v_min_i32 v51, 31, v51
    v_mul_u32_u24 v25, 416, v51
    v_lshl_add_u32 v25, v2, 4, v25
    v_add_u32 v25, 107264, v25
    v_add_u32 v51, 24, v1
    v_max_i32 v51, 0, v51
    v_min_i32 v51, 31, v51
    v_mul_u32_u24 v26, 416, v51
    v_lshl_add_u32 v26, v2, 4, v26
    v_add_u32 v26, 107264, v26
    v_mul_u32_u24 v51, 416, v1
    v_lshl_add_u32 v51, v2, 4, v51
    v_add_u32 v51, 103936, v51
    v_mov_b32 v29, v51
    v_mul_u32_u24 v27, 416, v48
    v_lshl_add_u32 v27, v2, 4, v27
    v_add_u32 v27, 100608, v27
    s_lshr_b32 s16, s2, 3
    s_and_b32 s17, s2, 7
    s_mul_i32 s16, s16, 5120
    s_add_u32 s16, s16, 202036224
    s_lshr_b32 s18, s17, 2
    s_lshl_b32 s18, s18, 9
    s_and_b32 s19, s17, 3
    s_lshl_b32 s19, s19, 7
    s_add_u32 s18, s18, s19
    s_add_u32 s18, s18, s16
    s_add_u32 s19, s17, 2
    s_lshl_b32 s19, s19, 9
    s_add_u32 s19, s19, s16
    v_and_b32 v50, 1, v2
    v_lshlrev_b32 v50, 3, v50
    v_lshl_add_u32 v50, v1, 4, v50
    v_lshrrev_b32 v51, 1, v2
    v_lshl_add_u32 v28, v51, 7, v50
    v_add_u32 v28, 128, v28
    v_add_u32 v28, s19, v28
    v_add_u32 v52, s18, v50
    v_add_u32 v53, s19, v50
    v_cmp_gt_u32 vcc, 2, v2
    s_nop 1
    v_cndmask_b32 v31, v53, v52, vcc
    v_lshrrev_b32 v50, 1, v3
    v_mul_u32_u24 v50, 6144, v50
    v_and_b32 v51, 1, v3
    v_mul_u32_u24 v51, 96, v51
    v_add3_u32 v50, v50, v51, v1
    s_mul_i32 s16, s2, 192
    v_add_u32 v50, s16, v50
    v_mul_u32_u24 v30, 1280, v50
    v_lshl_add_u32 v30, v2, 4, v30
    s_mov_b32 s20, 2621440
    s_mov_b32 s21, 2641920
    s_mov_b32 s22, 2662400
    s_mov_b32 s23, 2682880
    s_mov_b32 s24, 2703360
    s_mov_b32 s25, 2723840
    buffer_load_dwordx4 a[0:3], v30, s[4:7], s20 offen offset:0
    buffer_load_dwordx4 a[4:7], v30, s[4:7], s21 offen offset:0
    buffer_load_dwordx4 v[32:35], v30, s[4:7], s22 offen offset:0
    s_waitcnt vmcnt(0)
    ds_write_b128 v11, v[32:35] offset:0
    s_waitcnt lgkmcnt(0)
    buffer_load_dwordx4 a[8:11], v30, s[4:7], s23 offen offset:0
    buffer_load_dwordx4 a[12:15], v30, s[4:7], s24 offen offset:0
    buffer_load_dwordx4 a[16:19], v30, s[4:7], s25 offen offset:0
    buffer_load_dwordx4 a[20:23], v30, s[4:7], s20 offen offset:64
    buffer_load_dwordx4 a[24:27], v30, s[4:7], s21 offen offset:64
    buffer_load_dwordx4 v[32:35], v30, s[4:7], s22 offen offset:64
    s_waitcnt vmcnt(0)
    ds_write_b128 v11, v[32:35] offset:1024
    s_waitcnt lgkmcnt(0)
    buffer_load_dwordx4 a[28:31], v30, s[4:7], s23 offen offset:64
    buffer_load_dwordx4 a[32:35], v30, s[4:7], s24 offen offset:64
    buffer_load_dwordx4 a[36:39], v30, s[4:7], s25 offen offset:64
    buffer_load_dwordx4 a[40:43], v30, s[4:7], s20 offen offset:128
    buffer_load_dwordx4 v[32:35], v30, s[4:7], s21 offen offset:128
    s_waitcnt vmcnt(0)
    ds_write_b128 v11, v[32:35] offset:2048
    s_waitcnt lgkmcnt(0)
    buffer_load_dwordx4 a[44:47], v30, s[4:7], s22 offen offset:128
    buffer_load_dwordx4 a[48:51], v30, s[4:7], s23 offen offset:128
    buffer_load_dwordx4 a[52:55], v30, s[4:7], s24 offen offset:128
    buffer_load_dwordx4 a[56:59], v30, s[4:7], s25 offen offset:128
    buffer_load_dwordx4 a[60:63], v30, s[4:7], s20 offen offset:192
    buffer_load_dwordx4 v[32:35], v30, s[4:7], s21 offen offset:192
    s_waitcnt vmcnt(0)
    ds_write_b128 v11, v[32:35] offset:3072
    s_waitcnt lgkmcnt(0)
    buffer_load_dwordx4 a[64:67], v30, s[4:7], s22 offen offset:192
    buffer_load_dwordx4 a[68:71], v30, s[4:7], s23 offen offset:192
    buffer_load_dwordx4 a[72:75], v30, s[4:7], s24 offen offset:192
    buffer_load_dwordx4 a[76:79], v30, s[4:7], s25 offen offset:192
    buffer_load_dwordx4 v[32:35], v30, s[4:7], s20 offen offset:256
    s_waitcnt vmcnt(0)
    ds_write_b128 v11, v[32:35] offset:4096
    s_waitcnt lgkmcnt(0)
    buffer_load_dwordx4 a[80:83], v30, s[4:7], s21 offen offset:256
    buffer_load_dwordx4 a[84:87], v30, s[4:7], s22 offen offset:256
    buffer_load_dwordx4 a[88:91], v30, s[4:7], s23 offen offset:256
    buffer_load_dwordx4 a[92:95], v30, s[4:7], s24 offen offset:256
    buffer_load_dwordx4 v[32:35], v30, s[4:7], s25 offen offset:256
    s_waitcnt vmcnt(0)
    ds_write_b128 v11, v[32:35] offset:5120
    s_waitcnt lgkmcnt(0)
    buffer_load_dwordx4 a[96:99], v30, s[4:7], s20 offen offset:320
    buffer_load_dwordx4 a[100:103], v30, s[4:7], s21 offen offset:320
    buffer_load_dwordx4 a[104:107], v30, s[4:7], s22 offen offset:320
    buffer_load_dwordx4 a[108:111], v30, s[4:7], s23 offen offset:320
    buffer_load_dwordx4 a[112:115], v30, s[4:7], s24 offen offset:320
    buffer_load_dwordx4 v[32:35], v30, s[4:7], s25 offen offset:320
    s_waitcnt vmcnt(0)
    ds_write_b128 v11, v[32:35] offset:6144
    s_waitcnt lgkmcnt(0)
    buffer_load_dwordx4 a[116:119], v30, s[4:7], s20 offen offset:384
    buffer_load_dwordx4 a[120:123], v30, s[4:7], s21 offen offset:384
    buffer_load_dwordx4 a[124:127], v30, s[4:7], s22 offen offset:384
    buffer_load_dwordx4 a[128:131], v30, s[4:7], s23 offen offset:384
    buffer_load_dwordx4 v[32:35], v30, s[4:7], s24 offen offset:384
    s_waitcnt vmcnt(0)
    ds_write_b128 v11, v[32:35] offset:7168
    s_waitcnt lgkmcnt(0)
    buffer_load_dwordx4 a[132:135], v30, s[4:7], s25 offen offset:384
    buffer_load_dwordx4 a[136:139], v30, s[4:7], s20 offen offset:448
    buffer_load_dwordx4 a[140:143], v30, s[4:7], s21 offen offset:448
    buffer_load_dwordx4 a[144:147], v30, s[4:7], s22 offen offset:448
    buffer_load_dwordx4 a[148:151], v30, s[4:7], s23 offen offset:448
    buffer_load_dwordx4 v[32:35], v30, s[4:7], s24 offen offset:448
    s_waitcnt vmcnt(0)
    ds_write_b128 v11, v[32:35] offset:8192
    s_waitcnt lgkmcnt(0)
    buffer_load_dwordx4 a[152:155], v30, s[4:7], s25 offen offset:448
    buffer_load_dwordx4 a[156:159], v30, s[4:7], s20 offen offset:512
    buffer_load_dwordx4 a[160:163], v30, s[4:7], s21 offen offset:512
    buffer_load_dwordx4 a[164:167], v30, s[4:7], s22 offen offset:512
    buffer_load_dwordx4 v[32:35], v30, s[4:7], s23 offen offset:512
    s_waitcnt vmcnt(0)
    ds_write_b128 v11, v[32:35] offset:9216
    s_waitcnt lgkmcnt(0)
    buffer_load_dwordx4 a[168:171], v30, s[4:7], s24 offen offset:512
    buffer_load_dwordx4 a[172:175], v30, s[4:7], s25 offen offset:512
    buffer_load_dwordx4 a[176:179], v30, s[4:7], s20 offen offset:576
    buffer_load_dwordx4 a[180:183], v30, s[4:7], s21 offen offset:576
    buffer_load_dwordx4 a[184:187], v30, s[4:7], s22 offen offset:576
    buffer_load_dwordx4 v[32:35], v30, s[4:7], s23 offen offset:576
    s_waitcnt vmcnt(0)
    ds_write_b128 v11, v[32:35] offset:10240
    s_waitcnt lgkmcnt(0)
    buffer_load_dwordx4 a[188:191], v30, s[4:7], s24 offen offset:576
    buffer_load_dwordx4 a[192:195], v30, s[4:7], s25 offen offset:576
    buffer_load_dwordx4 a[196:199], v30, s[4:7], s20 offen offset:640
    buffer_load_dwordx4 a[200:203], v30, s[4:7], s21 offen offset:640
    buffer_load_dwordx4 v[32:35], v30, s[4:7], s22 offen offset:640
    s_waitcnt vmcnt(0)
    ds_write_b128 v11, v[32:35] offset:11264
    s_waitcnt lgkmcnt(0)
    buffer_load_dwordx4 a[204:207], v30, s[4:7], s23 offen offset:640
    buffer_load_dwordx4 a[208:211], v30, s[4:7], s24 offen offset:640
    buffer_load_dwordx4 a[212:215], v30, s[4:7], s25 offen offset:640
    buffer_load_dwordx4 a[216:219], v30, s[4:7], s20 offen offset:704
    buffer_load_dwordx4 a[220:223], v30, s[4:7], s21 offen offset:704
    buffer_load_dwordx4 v[32:35], v30, s[4:7], s22 offen offset:704
    s_waitcnt vmcnt(0)
    ds_write_b128 v11, v[32:35] offset:12288
    s_waitcnt lgkmcnt(0)
    buffer_load_dwordx4 a[224:227], v30, s[4:7], s23 offen offset:704
    buffer_load_dwordx4 a[228:231], v30, s[4:7], s24 offen offset:704
    buffer_load_dwordx4 a[232:235], v30, s[4:7], s25 offen offset:704
    buffer_load_dwordx4 a[236:239], v30, s[4:7], s20 offen offset:768
    buffer_load_dwordx4 v[32:35], v30, s[4:7], s21 offen offset:768
    s_waitcnt vmcnt(0)
    ds_write_b128 v11, v[32:35] offset:13312
    s_waitcnt lgkmcnt(0)
    buffer_load_dwordx4 a[240:243], v30, s[4:7], s22 offen offset:768
    buffer_load_dwordx4 a[244:247], v30, s[4:7], s23 offen offset:768
    buffer_load_dwordx4 a[248:251], v30, s[4:7], s24 offen offset:768
    buffer_load_dwordx4 a[252:255], v30, s[4:7], s25 offen offset:768
    buffer_load_dwordx4 v[120:123], v30, s[4:7], s20 offen offset:832
    buffer_load_dwordx4 v[32:35], v30, s[4:7], s21 offen offset:832
    s_waitcnt vmcnt(0)
    ds_write_b128 v11, v[32:35] offset:14336
    s_waitcnt lgkmcnt(0)
    buffer_load_dwordx4 v[124:127], v30, s[4:7], s22 offen offset:832
    buffer_load_dwordx4 v[128:131], v30, s[4:7], s23 offen offset:832
    buffer_load_dwordx4 v[132:135], v30, s[4:7], s24 offen offset:832
    buffer_load_dwordx4 v[136:139], v30, s[4:7], s25 offen offset:832
    buffer_load_dwordx4 v[32:35], v30, s[4:7], s20 offen offset:896
    s_waitcnt vmcnt(0)
    ds_write_b128 v11, v[32:35] offset:15360
    s_waitcnt lgkmcnt(0)
    buffer_load_dwordx4 v[140:143], v30, s[4:7], s21 offen offset:896
    buffer_load_dwordx4 v[144:147], v30, s[4:7], s22 offen offset:896
    buffer_load_dwordx4 v[148:151], v30, s[4:7], s23 offen offset:896
    buffer_load_dwordx4 v[152:155], v30, s[4:7], s24 offen offset:896
    buffer_load_dwordx4 v[156:159], v30, s[4:7], s25 offen offset:896
    buffer_load_dwordx4 v[32:35], v30, s[4:7], s20 offen offset:960
    s_waitcnt vmcnt(0)
    ds_write_b128 v11, v[32:35] offset:16384
    s_waitcnt lgkmcnt(0)
    buffer_load_dwordx4 v[160:163], v30, s[4:7], s21 offen offset:960
    buffer_load_dwordx4 v[164:167], v30, s[4:7], s22 offen offset:960
    buffer_load_dwordx4 v[168:171], v30, s[4:7], s23 offen offset:960
    buffer_load_dwordx4 v[172:175], v30, s[4:7], s24 offen offset:960
    buffer_load_dwordx4 v[32:35], v30, s[4:7], s25 offen offset:960
    s_waitcnt vmcnt(0)
    ds_write_b128 v11, v[32:35] offset:17408
    s_waitcnt lgkmcnt(0)
    buffer_load_dwordx4 v[176:179], v30, s[4:7], s20 offen offset:1024
    buffer_load_dwordx4 v[180:183], v30, s[4:7], s21 offen offset:1024
    buffer_load_dwordx4 v[184:187], v30, s[4:7], s22 offen offset:1024
    buffer_load_dwordx4 v[188:191], v30, s[4:7], s23 offen offset:1024
    buffer_load_dwordx4 v[32:35], v30, s[4:7], s24 offen offset:1024
    s_waitcnt vmcnt(0)
    ds_write_b128 v11, v[32:35] offset:18432
    s_waitcnt lgkmcnt(0)
    buffer_load_dwordx4 v[192:195], v30, s[4:7], s25 offen offset:1024
    buffer_load_dwordx4 v[196:199], v30, s[4:7], s20 offen offset:1088
    buffer_load_dwordx4 v[200:203], v30, s[4:7], s21 offen offset:1088
    buffer_load_dwordx4 v[204:207], v30, s[4:7], s22 offen offset:1088
    buffer_load_dwordx4 v[208:211], v30, s[4:7], s23 offen offset:1088
    buffer_load_dwordx4 v[32:35], v30, s[4:7], s24 offen offset:1088
    s_waitcnt vmcnt(0)
    ds_write_b128 v11, v[32:35] offset:19456
    s_waitcnt lgkmcnt(0)
    buffer_load_dwordx4 v[212:215], v30, s[4:7], s25 offen offset:1088
    buffer_load_dwordx4 v[216:219], v30, s[4:7], s20 offen offset:1152
    buffer_load_dwordx4 v[220:223], v30, s[4:7], s21 offen offset:1152
    buffer_load_dwordx4 v[224:227], v30, s[4:7], s22 offen offset:1152
    buffer_load_dwordx4 v[32:35], v30, s[4:7], s23 offen offset:1152
    s_waitcnt vmcnt(0)
    ds_write_b128 v11, v[32:35] offset:20480
    s_waitcnt lgkmcnt(0)
    buffer_load_dwordx4 v[228:231], v30, s[4:7], s24 offen offset:1152
    buffer_load_dwordx4 v[232:235], v30, s[4:7], s25 offen offset:1152
    buffer_load_dwordx4 v[236:239], v30, s[4:7], s20 offen offset:1216
    buffer_load_dwordx4 v[240:243], v30, s[4:7], s21 offen offset:1216
    buffer_load_dwordx4 v[244:247], v30, s[4:7], s22 offen offset:1216
    buffer_load_dwordx4 v[32:35], v30, s[4:7], s23 offen offset:1216
    s_waitcnt vmcnt(0)
    ds_write_b128 v11, v[32:35] offset:21504
    s_waitcnt lgkmcnt(0)
    buffer_load_dwordx4 v[248:251], v30, s[4:7], s24 offen offset:1216
    buffer_load_dwordx4 v[252:255], v30, s[4:7], s25 offen offset:1216
    s_waitcnt vmcnt(0)
    s_mov_b32 s29, 0
    s_cmp_eq_u32 s28, 0
    s_cbranch_scc1 qk_pre_skip
    s_mov_b32 s38, 224330752
    s_mov_b32 s36, 0
qk_wk0:
    buffer_load_dword v32, off, s[4:7], s38 sc1
    s_waitcnt vmcnt(0)
    v_readfirstlane_b32 s35, v32
    s_add_u32 s36, s36, 1
    s_cmp_ge_u32 s36, 262144
    s_cbranch_scc1 chain_done
    s_cmp_ge_u32 s35, 24
    s_cbranch_scc1 qk_wk0_ok
    s_sleep 4
    s_branch qk_wk0
qk_wk0_ok:
    buffer_load_dwordx4 v[32:35], v14, s[4:7], 0 offen sc1
    buffer_load_dwordx4 v[36:39], v15, s[4:7], 0 offen sc1
    buffer_load_dwordx4 v[40:43], v16, s[4:7], 0 offen sc1
    buffer_load_dwordx4 v[44:47], v17, s[4:7], 0 offen sc1
    s_waitcnt vmcnt(0)
    ds_write_b128 v18, v[32:35]
    ds_write_b128 v19, v[36:39]
    ds_write_b128 v20, v[40:43]
    ds_write_b128 v21, v[44:47]
    s_waitcnt lgkmcnt(0)
qk_pre_skip:
qk_loop:
    s_and_b32 s30, s2, 3
    s_mul_i32 s30, s30, 666368
    s_mul_i32 s31, s29, 10240
    s_add_u32 s30, s30, s31
    s_add_u32 s30, s30, 199370752
    s_cmp_eq_u32 s29, 0
    s_cselect_b32 s30, 199360512, s30
    s_mov_b32 s31, 0
qk_poll:
    buffer_load_dwordx4 v[104:107], v4, s[4:7], s30 offen sc1
    buffer_load_dwordx4 v[108:111], v5, s[4:7], s30 offen sc1
    buffer_load_dwordx4 v[112:115], v6, s[4:7], s30 offen sc1
    s_waitcnt vmcnt(0)
    v_max3_u32 v116, v104, v105, v106
    v_max3_u32 v116, v116, v107, v108
    v_max3_u32 v116, v116, v109, v110
    v_max3_u32 v116, v116, v111, v112
    v_max3_u32 v116, v116, v113, v114
    v_max_u32 v116, v116, v115
    v_cmp_eq_u32 vcc, -1, v116
    s_nop 3
    s_cbranch_vccz qk_poll_ok0
    s_add_u32 s31, s31, 1
    s_cmp_ge_u32 s31, 262144
    s_cbranch_scc1 chain_done
    s_branch qk_poll
qk_poll_ok0:
    ds_write_b128 v7, v[104:107]
    ds_write_b128 v8, v[108:111]
    ds_write_b128 v9, v[112:115]
qk_poll_fin:
    s_waitcnt lgkmcnt(0)
    s_barrier
    s_cmp_lg_u32 s28, 1
    s_cbranch_scc1 qk_sigp
    s_cmp_eq_u32 s29, 0
    s_cbranch_scc1 qk_sigp
    s_lshl_b32 s38, s29, 6
    s_add_u32 s38, s38, 224337856
    s_mov_b64 exec, 1
    v_mov_b32 v117, 1
    buffer_atomic_add v117, off, s[4:7], s38 sc1
    s_mov_b64 exec, -1
qk_sigp:
    ds_read_b128 v[32:35], v10 offset:0
    ds_read_b128 v[36:39], v10 offset:64
    ds_read_b128 v[40:43], v10 offset:128
    ds_read_b128 v[48:51], v11 offset:0
    ds_read_b128 v[52:55], v11 offset:1024
    ds_read_b128 v[56:59], v11 offset:2048
    s_waitcnt lgkmcnt(5)
    v_mfma_f32_16x16x32_bf16 v[64:67], a[0:3], v[32:35], 0
    ds_read_b128 v[44:47], v10 offset:192
    v_mfma_f32_16x16x32_bf16 v[68:71], a[4:7], v[32:35], 0
    s_waitcnt lgkmcnt(3)
    v_mfma_f32_16x16x32_bf16 v[72:75], v[48:51], v[32:35], 0
    ds_read_b128 v[60:63], v11 offset:3072
    v_mfma_f32_16x16x32_bf16 v[76:79], a[8:11], v[32:35], 0
    v_mfma_f32_16x16x32_bf16 v[80:83], a[12:15], v[32:35], 0
    v_mfma_f32_16x16x32_bf16 v[84:87], a[16:19], v[32:35], 0
    v_mfma_f32_16x16x32_bf16 v[64:67], a[20:23], v[36:39], v[64:67]
    ds_read_b128 v[32:35], v10 offset:256
    v_mfma_f32_16x16x32_bf16 v[68:71], a[24:27], v[36:39], v[68:71]
    s_waitcnt lgkmcnt(4)
    v_mfma_f32_16x16x32_bf16 v[72:75], v[52:55], v[36:39], v[72:75]
    ds_read_b128 v[48:51], v11 offset:4096
    v_mfma_f32_16x16x32_bf16 v[76:79], a[28:31], v[36:39], v[76:79]
    v_mfma_f32_16x16x32_bf16 v[80:83], a[32:35], v[36:39], v[80:83]
    v_mfma_f32_16x16x32_bf16 v[84:87], a[36:39], v[36:39], v[84:87]
    v_mfma_f32_16x16x32_bf16 v[64:67], a[40:43], v[40:43], v[64:67]
    ds_read_b128 v[36:39], v10 offset:320
    s_waitcnt lgkmcnt(5)
    v_mfma_f32_16x16x32_bf16 v[68:71], v[56:59], v[40:43], v[68:71]
    ds_read_b128 v[52:55], v11 offset:5120
    v_mfma_f32_16x16x32_bf16 v[72:75], a[44:47], v[40:43], v[72:75]
    v_mfma_f32_16x16x32_bf16 v[76:79], a[48:51], v[40:43], v[76:79]
    v_mfma_f32_16x16x32_bf16 v[80:83], a[52:55], v[40:43], v[80:83]
    v_mfma_f32_16x16x32_bf16 v[84:87], a[56:59], v[40:43], v[84:87]
    s_waitcnt lgkmcnt(5)
    v_mfma_f32_16x16x32_bf16 v[64:67], a[60:63], v[44:47], v[64:67]
    ds_read_b128 v[40:43], v10 offset:384
    s_waitcnt lgkmcnt(5)
    v_mfma_f32_16x16x32_bf16 v[68:71], v[60:63], v[44:47], v[68:71]
    ds_read_b128 v[56:59], v11 offset:6144
    v_mfma_f32_16x16x32_bf16 v[72:75], a[64:67], v[44:47], v[72:75]
    v_mfma_f32_16x16x32_bf16 v[76:79], a[68:71], v[44:47], v[76:79]
    v_mfma_f32_16x16x32_bf16 v[80:83], a[72:75], v[44:47], v[80:83]
    v_mfma_f32_16x16x32_bf16 v[84:87], a[76:79], v[44:47], v[84:87]
    s_waitcnt lgkmcnt(5)
    s_waitcnt lgkmcnt(4)
    v_mfma_f32_16x16x32_bf16 v[64:67], v[48:51], v[32:35], v[64:67]
    ds_read_b128 v[60:63], v11 offset:7168
    ds_read_b128 v[44:47], v10 offset:448
    v_mfma_f32_16x16x32_bf16 v[68:71], a[80:83], v[32:35], v[68:71]
    v_mfma_f32_16x16x32_bf16 v[72:75], a[84:87], v[32:35], v[72:75]
    v_mfma_f32_16x16x32_bf16 v[76:79], a[88:91], v[32:35], v[76:79]
    v_mfma_f32_16x16x32_bf16 v[80:83], a[92:95], v[32:35], v[80:83]
    s_waitcnt lgkmcnt(4)
    v_mfma_f32_16x16x32_bf16 v[84:87], v[52:55], v[32:35], v[84:87]
    ds_read_b128 v[48:51], v11 offset:8192
    v_mfma_f32_16x16x32_bf16 v[64:67], a[96:99], v[36:39], v[64:67]
    ds_read_b128 v[32:35], v10 offset:512
    v_mfma_f32_16x16x32_bf16 v[68:71], a[100:103], v[36:39], v[68:71]
    v_mfma_f32_16x16x32_bf16 v[72:75], a[104:107], v[36:39], v[72:75]
    v_mfma_f32_16x16x32_bf16 v[76:79], a[108:111], v[36:39], v[76:79]
    v_mfma_f32_16x16x32_bf16 v[80:83], a[112:115], v[36:39], v[80:83]
    s_waitcnt lgkmcnt(4)
    v_mfma_f32_16x16x32_bf16 v[84:87], v[56:59], v[36:39], v[84:87]
    ds_read_b128 v[52:55], v11 offset:9216
    v_mfma_f32_16x16x32_bf16 v[64:67], a[116:119], v[40:43], v[64:67]
    ds_read_b128 v[36:39], v10 offset:576
    v_mfma_f32_16x16x32_bf16 v[68:71], a[120:123], v[40:43], v[68:71]
    v_mfma_f32_16x16x32_bf16 v[72:75], a[124:127], v[40:43], v[72:75]
    v_mfma_f32_16x16x32_bf16 v[76:79], a[128:131], v[40:43], v[76:79]
    s_waitcnt lgkmcnt(5)
    v_mfma_f32_16x16x32_bf16 v[80:83], v[60:63], v[40:43], v[80:83]
    ds_read_b128 v[56:59], v11 offset:10240
    v_mfma_f32_16x16x32_bf16 v[84:87], a[132:135], v[40:43], v[84:87]
    s_waitcnt lgkmcnt(5)
    v_mfma_f32_16x16x32_bf16 v[64:67], a[136:139], v[44:47], v[64:67]
    ds_read_b128 v[40:43], v10 offset:640
    v_mfma_f32_16x16x32_bf16 v[68:71], a[140:143], v[44:47], v[68:71]
    v_mfma_f32_16x16x32_bf16 v[72:75], a[144:147], v[44:47], v[72:75]
    v_mfma_f32_16x16x32_bf16 v[76:79], a[148:151], v[44:47], v[76:79]
    s_waitcnt lgkmcnt(5)
    v_mfma_f32_16x16x32_bf16 v[80:83], v[48:51], v[44:47], v[80:83]
    ds_read_b128 v[60:63], v11 offset:11264
    v_mfma_f32_16x16x32_bf16 v[84:87], a[152:155], v[44:47], v[84:87]
    s_waitcnt lgkmcnt(5)
    v_mfma_f32_16x16x32_bf16 v[64:67], a[156:159], v[32:35], v[64:67]
    ds_read_b128 v[44:47], v10 offset:704
    v_mfma_f32_16x16x32_bf16 v[68:71], a[160:163], v[32:35], v[68:71]
    v_mfma_f32_16x16x32_bf16 v[72:75], a[164:167], v[32:35], v[72:75]
    s_waitcnt lgkmcnt(5)
    v_mfma_f32_16x16x32_bf16 v[76:79], v[52:55], v[32:35], v[76:79]
    ds_read_b128 v[48:51], v11 offset:12288
    v_mfma_f32_16x16x32_bf16 v[80:83], a[168:171], v[32:35], v[80:83]
    v_mfma_f32_16x16x32_bf16 v[84:87], a[172:175], v[32:35], v[84:87]
    s_waitcnt lgkmcnt(5)
    v_mfma_f32_16x16x32_bf16 v[64:67], a[176:179], v[36:39], v[64:67]
    ds_read_b128 v[32:35], v10 offset:768
    v_mfma_f32_16x16x32_bf16 v[68:71], a[180:183], v[36:39], v[68:71]
    v_mfma_f32_16x16x32_bf16 v[72:75], a[184:187], v[36:39], v[72:75]
    s_waitcnt lgkmcnt(5)
    v_mfma_f32_16x16x32_bf16 v[76:79], v[56:59], v[36:39], v[76:79]
    ds_read_b128 v[52:55], v11 offset:13312
    v_mfma_f32_16x16x32_bf16 v[80:83], a[188:191], v[36:39], v[80:83]
    v_mfma_f32_16x16x32_bf16 v[84:87], a[192:195], v[36:39], v[84:87]
    s_waitcnt lgkmcnt(5)
    v_mfma_f32_16x16x32_bf16 v[64:67], a[196:199], v[40:43], v[64:67]
    ds_read_b128 v[36:39], v10 offset:832
    v_mfma_f32_16x16x32_bf16 v[68:71], a[200:203], v[40:43], v[68:71]
    s_waitcnt lgkmcnt(5)
    v_mfma_f32_16x16x32_bf16 v[72:75], v[60:63], v[40:43], v[72:75]
    ds_read_b128 v[56:59], v11 offset:14336
    v_mfma_f32_16x16x32_bf16 v[76:79], a[204:207], v[40:43], v[76:79]
    v_mfma_f32_16x16x32_bf16 v[80:83], a[208:211], v[40:43], v[80:83]
    v_mfma_f32_16x16x32_bf16 v[84:87], a[212:215], v[40:43], v[84:87]
    s_waitcnt lgkmcnt(5)
    v_mfma_f32_16x16x32_bf16 v[64:67], a[216:219], v[44:47], v[64:67]
    ds_read_b128 v[40:43], v10 offset:896
    v_mfma_f32_16x16x32_bf16 v[68:71], a[220:223], v[44:47], v[68:71]
    s_waitcnt lgkmcnt(5)
    v_mfma_f32_16x16x32_bf16 v[72:75], v[48:51], v[44:47], v[72:75]
    ds_read_b128 v[60:63], v11 offset:15360
    v_mfma_f32_16x16x32_bf16 v[76:79], a[224:227], v[44:47], v[76:79]
    v_mfma_f32_16x16x32_bf16 v[80:83], a[228:231], v[44:47], v[80:83]
    v_mfma_f32_16x16x32_bf16 v[84:87], a[232:235], v[44:47], v[84:87]
    s_waitcnt lgkmcnt(5)
    v_mfma_f32_16x16x32_bf16 v[64:67], a[236:239], v[32:35], v[64:67]
    ds_read_b128 v[44:47], v10 offset:960
    s_waitcnt lgkmcnt(5)
    v_mfma_f32_16x16x32_bf16 v[68:71], v[52:55], v[32:35], v[68:71]
    ds_read_b128 v[48:51], v11 offset:16384
    v_mfma_f32_16x16x32_bf16 v[72:75], a[240:243], v[32:35], v[72:75]
    v_mfma_f32_16x16x32_bf16 v[76:79], a[244:247], v[32:35], v[76:79]
    v_mfma_f32_16x16x32_bf16 v[80:83], a[248:251], v[32:35], v[80:83]
    v_mfma_f32_16x16x32_bf16 v[84:87], a[252:255], v[32:35], v[84:87]
    s_waitcnt lgkmcnt(5)
    v_mfma_f32_16x16x32_bf16 v[64:67], v[120:123], v[36:39], v[64:67]
    ds_read_b128 v[32:35], v10 offset:1024
    s_waitcnt lgkmcnt(5)
    v_mfma_f32_16x16x32_bf16 v[68:71], v[56:59], v[36:39], v[68:71]
    ds_read_b128 v[52:55], v11 offset:17408
    v_mfma_f32_16x16x32_bf16 v[72:75], v[124:127], v[36:39], v[72:75]
    v_mfma_f32_16x16x32_bf16 v[76:79], v[128:131], v[36:39], v[76:79]
    v_mfma_f32_16x16x32_bf16 v[80:83], v[132:135], v[36:39], v[80:83]
    v_mfma_f32_16x16x32_bf16 v[84:87], v[136:139], v[36:39], v[84:87]
    s_waitcnt lgkmcnt(5)
    s_waitcnt lgkmcnt(4)
    v_mfma_f32_16x16x32_bf16 v[64:67], v[60:63], v[40:43], v[64:67]
    ds_read_b128 v[56:59], v11 offset:18432
    ds_read_b128 v[36:39], v10 offset:1088
    v_mfma_f32_16x16x32_bf16 v[68:71], v[140:143], v[40:43], v[68:71]
    v_mfma_f32_16x16x32_bf16 v[72:75], v[144:147], v[40:43], v[72:75]
    v_mfma_f32_16x16x32_bf16 v[76:79], v[148:151], v[40:43], v[76:79]
    v_mfma_f32_16x16x32_bf16 v[80:83], v[152:155], v[40:43], v[80:83]
    v_mfma_f32_16x16x32_bf16 v[84:87], v[156:159], v[40:43], v[84:87]
    s_waitcnt lgkmcnt(5)
    s_waitcnt lgkmcnt(4)
    v_mfma_f32_16x16x32_bf16 v[64:67], v[48:51], v[44:47], v[64:67]
    ds_read_b128 v[60:63], v11 offset:19456
    ds_read_b128 v[40:43], v10 offset:1152
    v_mfma_f32_16x16x32_bf16 v[68:71], v[160:163], v[44:47], v[68:71]
    v_mfma_f32_16x16x32_bf16 v[72:75], v[164:167], v[44:47], v[72:75]
    v_mfma_f32_16x16x32_bf16 v[76:79], v[168:171], v[44:47], v[76:79]
    v_mfma_f32_16x16x32_bf16 v[80:83], v[172:175], v[44:47], v[80:83]
    s_waitcnt lgkmcnt(4)
    v_mfma_f32_16x16x32_bf16 v[84:87], v[52:55], v[44:47], v[84:87]
    ds_read_b128 v[48:51], v11 offset:20480
    v_mfma_f32_16x16x32_bf16 v[64:67], v[176:179], v[32:35], v[64:67]
    ds_read_b128 v[44:47], v10 offset:1216
    v_mfma_f32_16x16x32_bf16 v[68:71], v[180:183], v[32:35], v[68:71]
    v_mfma_f32_16x16x32_bf16 v[72:75], v[184:187], v[32:35], v[72:75]
    v_mfma_f32_16x16x32_bf16 v[76:79], v[188:191], v[32:35], v[76:79]
    s_waitcnt lgkmcnt(5)
    v_mfma_f32_16x16x32_bf16 v[80:83], v[56:59], v[32:35], v[80:83]
    ds_read_b128 v[52:55], v11 offset:21504
    v_mfma_f32_16x16x32_bf16 v[84:87], v[192:195], v[32:35], v[84:87]
    s_waitcnt lgkmcnt(5)
    v_mfma_f32_16x16x32_bf16 v[64:67], v[196:199], v[36:39], v[64:67]
    v_mfma_f32_16x16x32_bf16 v[68:71], v[200:203], v[36:39], v[68:71]
    v_mfma_f32_16x16x32_bf16 v[72:75], v[204:207], v[36:39], v[72:75]
    v_mfma_f32_16x16x32_bf16 v[76:79], v[208:211], v[36:39], v[76:79]
    s_waitcnt lgkmcnt(4)
    v_mfma_f32_16x16x32_bf16 v[80:83], v[60:63], v[36:39], v[80:83]
    v_mfma_f32_16x16x32_bf16 v[84:87], v[212:215], v[36:39], v[84:87]
    s_waitcnt lgkmcnt(3)
    v_mfma_f32_16x16x32_bf16 v[64:67], v[216:219], v[40:43], v[64:67]
    v_mfma_f32_16x16x32_bf16 v[68:71], v[220:223], v[40:43], v[68:71]
    v_mfma_f32_16x16x32_bf16 v[72:75], v[224:227], v[40:43], v[72:75]
    s_waitcnt lgkmcnt(2)
    v_mfma_f32_16x16x32_bf16 v[76:79], v[48:51], v[40:43], v[76:79]
    v_mfma_f32_16x16x32_bf16 v[80:83], v[228:231], v[40:43], v[80:83]
    v_mfma_f32_16x16x32_bf16 v[84:87], v[232:235], v[40:43], v[84:87]
    s_waitcnt lgkmcnt(1)
    v_mfma_f32_16x16x32_bf16 v[64:67], v[236:239], v[44:47], v[64:67]
    v_mfma_f32_16x16x32_bf16 v[68:71], v[240:243], v[44:47], v[68:71]
    v_mfma_f32_16x16x32_bf16 v[72:75], v[244:247], v[44:47], v[72:75]
    s_waitcnt lgkmcnt(0)
    v_mfma_f32_16x16x32_bf16 v[76:79], v[52:55], v[44:47], v[76:79]
    v_mfma_f32_16x16x32_bf16 v[80:83], v[248:251], v[44:47], v[80:83]
    v_mfma_f32_16x16x32_bf16 v[84:87], v[252:255], v[44:47], v[84:87]
    s_nop 7
    v_cvt_pk_bf16_f32 v64, v64, v65
    v_cvt_pk_bf16_f32 v65, v66, v67
    ds_write_b64 v12, v[64:65] offset:0
    v_cvt_pk_bf16_f32 v68, v68, v69
    v_cvt_pk_bf16_f32 v69, v70, v71
    ds_write_b64 v12, v[68:69] offset:32
    v_cvt_pk_bf16_f32 v72, v72, v73
    v_cvt_pk_bf16_f32 v73, v74, v75
    ds_write_b64 v12, v[72:73] offset:64
    v_cvt_pk_bf16_f32 v76, v76, v77
    v_cvt_pk_bf16_f32 v77, v78, v79
    ds_write_b64 v12, v[76:77] offset:96
    v_cvt_pk_bf16_f32 v80, v80, v81
    v_cvt_pk_bf16_f32 v81, v82, v83
    ds_write_b64 v12, v[80:81] offset:128
    v_cvt_pk_bf16_f32 v84, v84, v85
    v_cvt_pk_bf16_f32 v85, v86, v87
    ds_write_b64 v12, v[84:85] offset:160
    s_cmp_lt_u32 s28, 2
    s_cbranch_scc1 qk_nokm
    s_mul_i32 s16, s29, 98304
    s_mov_b64 exec, s[40:41]
    buffer_store_dwordx2 v[64:65], v13, s[4:7], s16 offen offset:0 sc1
    buffer_store_dwordx2 v[68:69], v13, s[4:7], s16 offen offset:32 sc1
    buffer_store_dwordx2 v[72:73], v13, s[4:7], s16 offen offset:64 sc1
    buffer_store_dwordx2 v[76:77], v13, s[4:7], s16 offen offset:96 sc1
    buffer_store_dwordx2 v[80:81], v13, s[4:7], s16 offen offset:128 sc1
    buffer_store_dwordx2 v[84:85], v13, s[4:7], s16 offen offset:160 sc1
    s_mov_b64 exec, -1
qk_nokm:
    s_waitcnt lgkmcnt(0)
    s_barrier
    s_cmp_eq_u32 s28, 0
    s_cbranch_scc1 qk_phase2
    s_add_u32 s16, s29, 1
    s_cmp_ge_u32 s16, 64
    s_cbranch_scc1 qk_next
    s_lshl_b32 s38, s16, 6
    s_add_u32 s38, s38, 224329984
    s_and_b32 s17, s16, 3
    s_cmp_lg_u32 s17, 0
    s_cbranch_scc1 qk_wk_skip
    s_lshr_b32 s38, s16, 2
    s_lshl_b32 s38, s38, 6
    s_add_u32 s38, s38, 224330752
qk_wk_go:
    s_mov_b32 s36, 0
qk_wk:
    buffer_load_dword v32, off, s[4:7], s38 sc1
    s_waitcnt vmcnt(0)
    v_readfirstlane_b32 s35, v32
    s_add_u32 s36, s36, 1
    s_cmp_ge_u32 s36, 262144
    s_cbranch_scc1 chain_done
    s_cmp_ge_u32 s35, 24
    s_cbranch_scc1 qk_wk_ok
    s_sleep 4
    s_branch qk_wk
qk_wk_ok:
qk_wk_skip:
    s_mul_i32 s17, s16, 1179648
    s_and_b32 s18, s16, 1
    s_mul_i32 s18, s18, 13312
    buffer_load_dwordx4 v[32:35], v14, s[4:7], s17 offen sc1
    buffer_load_dwordx4 v[36:39], v15, s[4:7], s17 offen sc1
    buffer_load_dwordx4 v[40:43], v16, s[4:7], s17 offen sc1
    buffer_load_dwordx4 v[44:47], v17, s[4:7], s17 offen sc1
    v_add_u32 v48, s18, v18
    v_add_u32 v49, s18, v19
    v_add_u32 v50, s18, v20
    v_add_u32 v51, s18, v21
    s_waitcnt vmcnt(0)
    ds_write_b128 v48, v[32:35]
    ds_write_b128 v49, v[36:39]
    ds_write_b128 v50, v[40:43]
    ds_write_b128 v51, v[44:47]
    s_waitcnt lgkmcnt(0)
    s_branch qk_next
qk_phase2:
    s_and_b32 s18, s29, 1
    s_mul_i32 s18, s18, 13312
    v_add_u32 v88, s18, v24
    v_add_u32 v89, s18, v25
    v_add_u32 v90, s18, v26
    v_cmp_gt_u32 vcc, 8, v1
    s_nop 1
    v_cndmask_b32 v88, v88, v29, vcc
    ds_read_b128 v[32:35], v27 offset:0
    ds_read_b128 v[36:39], v88 offset:0
    ds_read_b128 v[40:43], v89 offset:0
    ds_read_b128 v[44:47], v90 offset:0
    ds_read_b128 v[48:51], v27 offset:64
    ds_read_b128 v[52:55], v88 offset:64
    ds_read_b128 v[56:59], v89 offset:64
    ds_read_b128 v[60:63], v90 offset:64
    s_waitcnt lgkmcnt(4)
    v_mfma_f32_16x16x32_bf16 v[64:67], v[36:39], v[32:35], 0
    v_mfma_f32_16x16x32_bf16 v[68:71], v[40:43], v[32:35], 0
    v_mfma_f32_16x16x32_bf16 v[72:75], v[44:47], v[32:35], 0
    s_nop 3
    ds_read_b128 v[32:35], v27 offset:128
    ds_read_b128 v[36:39], v88 offset:128
    ds_read_b128 v[40:43], v89 offset:128
    ds_read_b128 v[44:47], v90 offset:128
    s_waitcnt lgkmcnt(4)
    v_mfma_f32_16x16x32_bf16 v[64:67], v[52:55], v[48:51], v[64:67]
    v_mfma_f32_16x16x32_bf16 v[68:71], v[56:59], v[48:51], v[68:71]
    v_mfma_f32_16x16x32_bf16 v[72:75], v[60:63], v[48:51], v[72:75]
    s_nop 3
    ds_read_b128 v[48:51], v27 offset:192
    ds_read_b128 v[52:55], v88 offset:192
    ds_read_b128 v[56:59], v89 offset:192
    ds_read_b128 v[60:63], v90 offset:192
    s_waitcnt lgkmcnt(4)
    v_mfma_f32_16x16x32_bf16 v[64:67], v[36:39], v[32:35], v[64:67]
    v_mfma_f32_16x16x32_bf16 v[68:71], v[40:43], v[32:35], v[68:71]
    v_mfma_f32_16x16x32_bf16 v[72:75], v[44:47], v[32:35], v[72:75]
    s_nop 3
    ds_read_b128 v[32:35], v27 offset:256
    ds_read_b128 v[36:39], v88 offset:256
    ds_read_b128 v[40:43], v89 offset:256
    ds_read_b128 v[44:47], v90 offset:256
    s_waitcnt lgkmcnt(4)
    v_mfma_f32_16x16x32_bf16 v[64:67], v[52:55], v[48:51], v[64:67]
    v_mfma_f32_16x16x32_bf16 v[68:71], v[56:59], v[48:51], v[68:71]
    v_mfma_f32_16x16x32_bf16 v[72:75], v[60:63], v[48:51], v[72:75]
    s_nop 3
    ds_read_b128 v[48:51], v27 offset:320
    ds_read_b128 v[52:55], v88 offset:320
    ds_read_b128 v[56:59], v89 offset:320
    ds_read_b128 v[60:63], v90 offset:320
    s_waitcnt lgkmcnt(4)
    v_mfma_f32_16x16x32_bf16 v[64:67], v[36:39], v[32:35], v[64:67]
    v_mfma_f32_16x16x32_bf16 v[68:71], v[40:43], v[32:35], v[68:71]
    v_mfma_f32_16x16x32_bf16 v[72:75], v[44:47], v[32:35], v[72:75]
    s_waitcnt lgkmcnt(0)
    v_mfma_f32_16x16x32_bf16 v[64:67], v[52:55], v[48:51], v[64:67]
    v_mfma_f32_16x16x32_bf16 v[68:71], v[56:59], v[48:51], v[68:71]
    v_mfma_f32_16x16x32_bf16 v[72:75], v[60:63], v[48:51], v[72:75]
    s_nop 7
    v_cmp_gt_u32 s[44:45], 2, v2
    s_nop 1
    v_cvt_pk_bf16_f32 v92, v64, v65
    v_cvt_pk_bf16_f32 v93, v66, v67
    v_lshlrev_b32 v64, 16, v92
    v_and_b32 v65, 0xffff0000, v92
    v_lshlrev_b32 v66, 16, v93
    v_and_b32 v67, 0xffff0000, v93
    v_mul_f32 v64, 0x3d93cd3a, v64
    v_mul_f32 v65, 0x3d93cd3a, v65
    v_mul_f32 v66, 0x3d93cd3a, v66
    v_mul_f32 v67, 0x3d93cd3a, v67
    v_cvt_pk_bf16_f32 v92, v64, v65
    v_cvt_pk_bf16_f32 v93, v66, v67
    v_lshlrev_b32 v64, 16, v92
    v_and_b32 v65, 0xffff0000, v92
    v_lshlrev_b32 v66, 16, v93
    v_and_b32 v67, 0xffff0000, v93
    v_cvt_pk_bf16_f32 v92, v68, v69
    v_cvt_pk_bf16_f32 v93, v70, v71
    v_lshlrev_b32 v68, 16, v92
    v_and_b32 v69, 0xffff0000, v92
    v_lshlrev_b32 v70, 16, v93
    v_and_b32 v71, 0xffff0000, v93
    v_mul_f32 v68, 0x3d93cd3a, v68
    v_mul_f32 v69, 0x3d93cd3a, v69
    v_mul_f32 v70, 0x3d93cd3a, v70
    v_mul_f32 v71, 0x3d93cd3a, v71
    v_cvt_pk_bf16_f32 v92, v68, v69
    v_cvt_pk_bf16_f32 v93, v70, v71
    v_lshlrev_b32 v68, 16, v92
    v_and_b32 v69, 0xffff0000, v92
    v_lshlrev_b32 v70, 16, v93
    v_and_b32 v71, 0xffff0000, v93
    v_cvt_pk_bf16_f32 v92, v72, v73
    v_cvt_pk_bf16_f32 v93, v74, v75
    v_lshlrev_b32 v72, 16, v92
    v_and_b32 v73, 0xffff0000, v92
    v_lshlrev_b32 v74, 16, v93
    v_and_b32 v75, 0xffff0000, v93
    v_mul_f32 v72, 0x3d93cd3a, v72
    v_mul_f32 v73, 0x3d93cd3a, v73
    v_mul_f32 v74, 0x3d93cd3a, v74
    v_mul_f32 v75, 0x3d93cd3a, v75
    v_cvt_pk_bf16_f32 v92, v72, v73
    v_cvt_pk_bf16_f32 v93, v74, v75
    v_lshlrev_b32 v72, 16, v92
    v_and_b32 v73, 0xffff0000, v92
    v_lshlrev_b32 v74, 16, v93
    v_and_b32 v75, 0xffff0000, v93
    v_mov_b32 v94, 0xce6e6b28
    v_cndmask_b32 v72, v94, v72, s[44:45]
    v_cndmask_b32 v73, v94, v73, s[44:45]
    v_cndmask_b32 v74, v94, v74, s[44:45]
    v_cndmask_b32 v75, v94, v75, s[44:45]
    v_max_f32 v92, v64, v65
    v_max_f32 v92, v92, v66
    v_max_f32 v92, v92, v67
    v_max_f32 v92, v92, v68
    v_max_f32 v92, v92, v69
    v_max_f32 v92, v92, v70
    v_max_f32 v92, v92, v71
    v_max_f32 v92, v92, v72
    v_max_f32 v92, v92, v73
    v_max_f32 v92, v92, v74
    v_max_f32 v92, v92, v75
    v_mov_b32 v93, v92
    s_nop 1
    v_permlane16_swap_b32 v92, v93
    s_nop 0
    v_max_f32 v92, v92, v93
    v_mov_b32 v93, v92
    s_nop 1
    v_permlane32_swap_b32 v92, v93
    s_nop 0
    v_max_f32 v92, v92, v93
    v_sub_f32 v64, v64, v92
    v_mul_f32 v64, 0x3fb8aa3b, v64
    v_sub_f32 v65, v65, v92
    v_mul_f32 v65, 0x3fb8aa3b, v65
    v_sub_f32 v66, v66, v92
    v_mul_f32 v66, 0x3fb8aa3b, v66
    v_sub_f32 v67, v67, v92
    v_mul_f32 v67, 0x3fb8aa3b, v67
    v_sub_f32 v68, v68, v92
    v_mul_f32 v68, 0x3fb8aa3b, v68
    v_sub_f32 v69, v69, v92
    v_mul_f32 v69, 0x3fb8aa3b, v69
    v_sub_f32 v70, v70, v92
    v_mul_f32 v70, 0x3fb8aa3b, v70
    v_sub_f32 v71, v71, v92
    v_mul_f32 v71, 0x3fb8aa3b, v71
    v_sub_f32 v72, v72, v92
    v_mul_f32 v72, 0x3fb8aa3b, v72
    v_sub_f32 v73, v73, v92
    v_mul_f32 v73, 0x3fb8aa3b, v73
    v_sub_f32 v74, v74, v92
    v_mul_f32 v74, 0x3fb8aa3b, v74
    v_sub_f32 v75, v75, v92
    v_mul_f32 v75, 0x3fb8aa3b, v75
    v_exp_f32 v64, v64
    v_exp_f32 v65, v65
    v_exp_f32 v66, v66
    v_exp_f32 v67, v67
    v_exp_f32 v68, v68
    v_exp_f32 v69, v69
    v_exp_f32 v70, v70
    v_exp_f32 v71, v71
    v_exp_f32 v72, v72
    v_exp_f32 v73, v73
    v_exp_f32 v74, v74
    v_exp_f32 v75, v75
    s_nop 0
    v_add_f32 v92, v64, v65
    v_add_f32 v92, v92, v66
    v_add_f32 v92, v92, v67
    v_add_f32 v92, v92, v68
    v_add_f32 v92, v92, v69
    v_add_f32 v92, v92, v70
    v_add_f32 v92, v92, v71
    v_add_f32 v92, v92, v72
    v_add_f32 v92, v92, v73
    v_add_f32 v92, v92, v74
    v_add_f32 v92, v92, v75
    v_mov_b32 v93, v92
    s_nop 1
    v_permlane16_swap_b32 v92, v93
    s_nop 0
    v_add_f32 v92, v92, v93
    v_mov_b32 v93, v92
    s_nop 1
    v_permlane32_swap_b32 v92, v93
    s_nop 0
    v_add_f32 v92, v92, v93
    v_rcp_f32 v92, v92
    s_nop 0
    v_mul_f32 v64, v64, v92
    v_mul_f32 v65, v65, v92
    v_mul_f32 v66, v66, v92
    v_mul_f32 v67, v67, v92
    v_mul_f32 v68, v68, v92
    v_mul_f32 v69, v69, v92
    v_mul_f32 v70, v70, v92
    v_mul_f32 v71, v71, v92
    v_mul_f32 v72, v72, v92
    v_mul_f32 v73, v73, v92
    v_mul_f32 v74, v74, v92
    v_mul_f32 v75, v75, v92
    s_mul_i32 s16, s29, 20480
    s_mov_b64 exec, s[40:41]
    v_cvt_pk_bf16_f32 v64, v64, v65
    v_cvt_pk_bf16_f32 v65, v66, v67
    v_min_u32 v64, -2, v64
    v_min_u32 v65, -2, v65
    s_add_u32 s17, s16, 0
    buffer_store_dwordx2 v[64:65], v31, s[4:7], s17 offen sc1
    v_cvt_pk_bf16_f32 v68, v68, v69
    v_cvt_pk_bf16_f32 v69, v70, v71
    v_min_u32 v68, -2, v68
    v_min_u32 v69, -2, v69
    s_add_u32 s17, s16, 0
    buffer_store_dwordx2 v[68:69], v28, s[4:7], s17 offen offset:0 sc1
    v_cvt_pk_bf16_f32 v72, v72, v73
    v_cvt_pk_bf16_f32 v73, v74, v75
    v_min_u32 v72, -2, v72
    v_min_u32 v73, -2, v73
    s_and_b64 exec, exec, s[44:45]
    s_add_u32 s17, s16, 0
    buffer_store_dwordx2 v[72:73], v28, s[4:7], s17 offen offset:256 sc1
    s_mov_b64 exec, -1
qk_next:
    s_add_u32 s29, s29, 1
    s_cmp_lt_u32 s29, 64
    s_cbranch_scc1 qk_loop
    s_waitcnt vmcnt(0)
    s_barrier
    s_cmp_lg_u32 s28, 1
    s_cbranch_scc1 qk_sigl
    s_mov_b32 s38, 224341952
    s_mov_b64 exec, 1
    v_mov_b32 v117, 1
    buffer_atomic_add v117, off, s[4:7], s38 sc1
    s_mov_b64 exec, -1
qk_sigl:
    s_branch chain_worker
chain_vo:
    s_sub_u32 s3, s2, 32
    v_and_b32 v1, 15, v0
    v_bfe_u32 v2, v0, 4, 2
    v_lshrrev_b32 v3, 6, v0
    s_nop 0
    v_readfirstlane_b32 s28, v3
    v_and_b32 v48, 63, v0
    v_add_u32 v49, 0, v48
    v_min_u32 v49, 159, v49
    v_mul_u32_u24 v52, 2560, v3
    v_lshl_add_u32 v4, v49, 4, v52
    v_lshrrev_b32 v50, 4, v49
    v_mul_u32_u24 v52, 10, v3
    v_add_u32 v50, v50, v52
    v_bfe_u32 v51, v49, 1, 3
    v_mul_u32_u24 v7, 1312, v51
    v_lshl_add_u32 v7, v50, 5, v7
    v_and_b32 v51, 1, v49
    v_lshl_add_u32 v7, v51, 4, v7
    v_add_u32 v7, 90112, v7
    v_add_u32 v49, 64, v48
    v_min_u32 v49, 159, v49
    v_mul_u32_u24 v52, 2560, v3
    v_lshl_add_u32 v5, v49, 4, v52
    v_lshrrev_b32 v50, 4, v49
    v_mul_u32_u24 v52, 10, v3
    v_add_u32 v50, v50, v52
    v_bfe_u32 v51, v49, 1, 3
    v_mul_u32_u24 v8, 1312, v51
    v_lshl_add_u32 v8, v50, 5, v8
    v_and_b32 v51, 1, v49
    v_lshl_add_u32 v8, v51, 4, v8
    v_add_u32 v8, 90112, v8
    v_add_u32 v49, 128, v48
    v_min_u32 v49, 159, v49
    v_mul_u32_u24 v52, 2560, v3
    v_lshl_add_u32 v6, v49, 4, v52
    v_lshrrev_b32 v50, 4, v49
    v_mul_u32_u24 v52, 10, v3
    v_add_u32 v50, v50, v52
    v_bfe_u32 v51, v49, 1, 3
    v_mul_u32_u24 v9, 1312, v51
    v_lshl_add_u32 v9, v50, 5, v9
    v_and_b32 v51, 1, v49
    v_lshl_add_u32 v9, v51, 4, v9
    v_add_u32 v9, 90112, v9
    v_and_b32 v48, 7, v1
    v_mul_u32_u24 v10, 1312, v48
    v_lshl_add_u32 v10, v2, 4, v10
    v_add_u32 v10, 90112, v10
    v_and_b32 v49, 63, v0
    v_mul_u32_u24 v11, 22528, v3
    v_lshl_add_u32 v11, v49, 4, v11
    v_mul_u32_u24 v12, 416, v48
    v_mul_u32_u24 v50, 96, v3
    v_lshl_add_u32 v50, v2, 3, v50
    v_add3_u32 v12, v12, v50, 0
    v_add_u32 v12, 100608, v12
    v_mul_u32_u24 v13, 416, v48
    v_lshl_add_u32 v13, v2, 4, v13
    v_add_u32 v13, 100608, v13
    v_mul_u32_u24 v50, 160, v3
    v_add_u32 v50, v50, v1
    v_mul_u32_u24 v14, 81920, v3
    v_lshl_add_u32 v14, v1, 4, v14
    v_lshl_add_u32 v14, v2, 3, v14
    s_lshl_b32 s16, s3, 8
    s_add_u32 s16, s16, 203348224
    v_add_u32 v14, s16, v14
    v_mul_u32_u24 v51, 48, v3
    v_add_u32 v51, v51, v1
    s_mul_i32 s16, s3, 192
    s_add_u32 s16, s16, 12288
    v_add_u32 v51, s16, v51
    v_mul_u32_u24 v15, 1280, v51
    v_lshl_add_u32 v15, v2, 4, v15
    s_mov_b32 s20, 2621440
    s_mov_b32 s21, 2641920
    s_mov_b32 s22, 2662400
    v_mul_u32_u24 v16, 384, v50
    v_lshl_add_u32 v16, v2, 4, v16
    s_mul_i32 s16, s3, 245760
    s_add_u32 s16, s16, 26214400
    s_add_u32 s48, s16, 0
    s_add_u32 s49, s16, 6144
    s_add_u32 s50, s16, 12288
    s_add_u32 s51, s16, 18432
    s_add_u32 s52, s16, 24576
    s_add_u32 s53, s16, 30720
    s_add_u32 s54, s16, 36864
    s_add_u32 s55, s16, 43008
    s_add_u32 s56, s16, 49152
    s_add_u32 s57, s16, 55296
    buffer_load_dwordx4 a[0:3], v15, s[4:7], s20 offen offset:0
    buffer_load_dwordx4 a[4:7], v15, s[4:7], s21 offen offset:0
    buffer_load_dwordx4 v[32:35], v15, s[4:7], s22 offen offset:0
    s_waitcnt vmcnt(0)
    ds_write_b128 v11, v[32:35] offset:0
    s_waitcnt lgkmcnt(0)
    buffer_load_dwordx4 a[8:11], v15, s[4:7], s20 offen offset:64
    buffer_load_dwordx4 a[12:15], v15, s[4:7], s21 offen offset:64
    buffer_load_dwordx4 a[16:19], v15, s[4:7], s22 offen offset:64
    buffer_load_dwordx4 a[20:23], v15, s[4:7], s20 offen offset:128
    buffer_load_dwordx4 a[24:27], v15, s[4:7], s21 offen offset:128
    buffer_load_dwordx4 v[32:35], v15, s[4:7], s22 offen offset:128
    s_waitcnt vmcnt(0)
    ds_write_b128 v11, v[32:35] offset:1024
    s_waitcnt lgkmcnt(0)
    buffer_load_dwordx4 a[28:31], v15, s[4:7], s20 offen offset:192
    buffer_load_dwordx4 a[32:35], v15, s[4:7], s21 offen offset:192
    buffer_load_dwordx4 a[36:39], v15, s[4:7], s22 offen offset:192
    buffer_load_dwordx4 a[40:43], v15, s[4:7], s20 offen offset:256
    buffer_load_dwordx4 v[32:35], v15, s[4:7], s21 offen offset:256
    s_waitcnt vmcnt(0)
    ds_write_b128 v11, v[32:35] offset:2048
    s_waitcnt lgkmcnt(0)
    buffer_load_dwordx4 a[44:47], v15, s[4:7], s22 offen offset:256
    buffer_load_dwordx4 a[48:51], v15, s[4:7], s20 offen offset:320
    buffer_load_dwordx4 a[52:55], v15, s[4:7], s21 offen offset:320
    buffer_load_dwordx4 a[56:59], v15, s[4:7], s22 offen offset:320
    buffer_load_dwordx4 a[60:63], v15, s[4:7], s20 offen offset:384
    buffer_load_dwordx4 v[32:35], v15, s[4:7], s21 offen offset:384
    s_waitcnt vmcnt(0)
    ds_write_b128 v11, v[32:35] offset:3072
    s_waitcnt lgkmcnt(0)
    buffer_load_dwordx4 a[64:67], v15, s[4:7], s22 offen offset:384
    buffer_load_dwordx4 a[68:71], v15, s[4:7], s20 offen offset:448
    buffer_load_dwordx4 a[72:75], v15, s[4:7], s21 offen offset:448
    buffer_load_dwordx4 a[76:79], v15, s[4:7], s22 offen offset:448
    buffer_load_dwordx4 v[32:35], v15, s[4:7], s20 offen offset:512
    s_waitcnt vmcnt(0)
    ds_write_b128 v11, v[32:35] offset:4096
    s_waitcnt lgkmcnt(0)
    buffer_load_dwordx4 a[80:83], v15, s[4:7], s21 offen offset:512
    buffer_load_dwordx4 a[84:87], v15, s[4:7], s22 offen offset:512
    buffer_load_dwordx4 a[88:91], v15, s[4:7], s20 offen offset:576
    buffer_load_dwordx4 a[92:95], v15, s[4:7], s21 offen offset:576
    buffer_load_dwordx4 v[32:35], v15, s[4:7], s22 offen offset:576
    s_waitcnt vmcnt(0)
    ds_write_b128 v11, v[32:35] offset:5120
    s_waitcnt lgkmcnt(0)
    buffer_load_dwordx4 a[96:99], v15, s[4:7], s20 offen offset:640
    buffer_load_dwordx4 a[100:103], v15, s[4:7], s21 offen offset:640
    buffer_load_dwordx4 a[104:107], v15, s[4:7], s22 offen offset:640
    buffer_load_dwordx4 a[108:111], v15, s[4:7], s20 offen offset:704
    buffer_load_dwordx4 a[112:115], v15, s[4:7], s21 offen offset:704
    buffer_load_dwordx4 v[32:35], v15, s[4:7], s22 offen offset:704
    s_waitcnt vmcnt(0)
    ds_write_b128 v11, v[32:35] offset:6144
    s_waitcnt lgkmcnt(0)
    buffer_load_dwordx4 a[116:119], v15, s[4:7], s20 offen offset:768
    buffer_load_dwordx4 a[120:123], v15, s[4:7], s21 offen offset:768
    buffer_load_dwordx4 a[124:127], v15, s[4:7], s22 offen offset:768
    buffer_load_dwordx4 a[128:131], v15, s[4:7], s20 offen offset:832
    buffer_load_dwordx4 v[32:35], v15, s[4:7], s21 offen offset:832
    s_waitcnt vmcnt(0)
    ds_write_b128 v11, v[32:35] offset:7168
    s_waitcnt lgkmcnt(0)
    buffer_load_dwordx4 a[132:135], v15, s[4:7], s22 offen offset:832
    buffer_load_dwordx4 a[136:139], v15, s[4:7], s20 offen offset:896
    buffer_load_dwordx4 a[140:143], v15, s[4:7], s21 offen offset:896
    buffer_load_dwordx4 a[144:147], v15, s[4:7], s22 offen offset:896
    buffer_load_dwordx4 a[148:151], v15, s[4:7], s20 offen offset:960
    buffer_load_dwordx4 v[32:35], v15, s[4:7], s21 offen offset:960
    s_waitcnt vmcnt(0)
    ds_write_b128 v11, v[32:35] offset:8192
    s_waitcnt lgkmcnt(0)
    buffer_load_dwordx4 a[152:155], v15, s[4:7], s22 offen offset:960
    buffer_load_dwordx4 a[156:159], v15, s[4:7], s20 offen offset:1024
    buffer_load_dwordx4 a[160:163], v15, s[4:7], s21 offen offset:1024
    buffer_load_dwordx4 a[164:167], v15, s[4:7], s22 offen offset:1024
    buffer_load_dwordx4 v[32:35], v15, s[4:7], s20 offen offset:1088
    s_waitcnt vmcnt(0)
    ds_write_b128 v11, v[32:35] offset:9216
    s_waitcnt lgkmcnt(0)
    buffer_load_dwordx4 a[168:171], v15, s[4:7], s21 offen offset:1088
    buffer_load_dwordx4 a[172:175], v15, s[4:7], s22 offen offset:1088
    buffer_load_dwordx4 a[176:179], v15, s[4:7], s20 offen offset:1152
    buffer_load_dwordx4 a[180:183], v15, s[4:7], s21 offen offset:1152
    buffer_load_dwordx4 a[184:187], v15, s[4:7], s22 offen offset:1152
    buffer_load_dwordx4 v[32:35], v15, s[4:7], s20 offen offset:1216
    s_waitcnt vmcnt(0)
    ds_write_b128 v11, v[32:35] offset:10240
    s_waitcnt lgkmcnt(0)
    buffer_load_dwordx4 a[188:191], v15, s[4:7], s21 offen offset:1216
    buffer_load_dwordx4 a[192:195], v15, s[4:7], s22 offen offset:1216
    buffer_load_dwordx4 a[196:199], v16, s[4:7], s48 offen offset:0
    buffer_load_dwordx4 a[200:203], v16, s[4:7], s49 offen offset:0
    buffer_load_dwordx4 v[32:35], v16, s[4:7], s50 offen offset:0
    s_waitcnt vmcnt(0)
    ds_write_b128 v11, v[32:35] offset:11264
    s_waitcnt lgkmcnt(0)
    buffer_load_dwordx4 a[204:207], v16, s[4:7], s51 offen offset:0
    buffer_load_dwordx4 a[208:211], v16, s[4:7], s52 offen offset:0
    buffer_load_dwordx4 a[212:215], v16, s[4:7], s53 offen offset:0
    buffer_load_dwordx4 a[216:219], v16, s[4:7], s54 offen offset:0
    buffer_load_dwordx4 a[220:223], v16, s[4:7], s55 offen offset:0
    buffer_load_dwordx4 v[32:35], v16, s[4:7], s56 offen offset:0
    s_waitcnt vmcnt(0)
    ds_write_b128 v11, v[32:35] offset:12288
    s_waitcnt lgkmcnt(0)
    buffer_load_dwordx4 a[224:227], v16, s[4:7], s57 offen offset:0
    buffer_load_dwordx4 a[228:231], v16, s[4:7], s48 offen offset:64
    buffer_load_dwordx4 a[232:235], v16, s[4:7], s49 offen offset:64
    buffer_load_dwordx4 a[236:239], v16, s[4:7], s50 offen offset:64
    buffer_load_dwordx4 v[32:35], v16, s[4:7], s51 offen offset:64
    s_waitcnt vmcnt(0)
    ds_write_b128 v11, v[32:35] offset:13312
    s_waitcnt lgkmcnt(0)
    buffer_load_dwordx4 a[240:243], v16, s[4:7], s52 offen offset:64
    buffer_load_dwordx4 a[244:247], v16, s[4:7], s53 offen offset:64
    buffer_load_dwordx4 a[248:251], v16, s[4:7], s54 offen offset:64
    buffer_load_dwordx4 a[252:255], v16, s[4:7], s55 offen offset:64
    buffer_load_dwordx4 v[120:123], v16, s[4:7], s56 offen offset:64
    buffer_load_dwordx4 v[32:35], v16, s[4:7], s57 offen offset:64
    s_waitcnt vmcnt(0)
    ds_write_b128 v11, v[32:35] offset:14336
    s_waitcnt lgkmcnt(0)
    buffer_load_dwordx4 v[124:127], v16, s[4:7], s48 offen offset:128
    buffer_load_dwordx4 v[128:131], v16, s[4:7], s49 offen offset:128
    buffer_load_dwordx4 v[132:135], v16, s[4:7], s50 offen offset:128
    buffer_load_dwordx4 v[136:139], v16, s[4:7], s51 offen offset:128
    buffer_load_dwordx4 v[32:35], v16, s[4:7], s52 offen offset:128
    s_waitcnt vmcnt(0)
    ds_write_b128 v11, v[32:35] offset:15360
    s_waitcnt lgkmcnt(0)
    buffer_load_dwordx4 v[140:143], v16, s[4:7], s53 offen offset:128
    buffer_load_dwordx4 v[144:147], v16, s[4:7], s54 offen offset:128
    buffer_load_dwordx4 v[148:151], v16, s[4:7], s55 offen offset:128
    buffer_load_dwordx4 v[152:155], v16, s[4:7], s56 offen offset:128
    buffer_load_dwordx4 v[156:159], v16, s[4:7], s57 offen offset:128
    buffer_load_dwordx4 v[32:35], v16, s[4:7], s48 offen offset:192
    s_waitcnt vmcnt(0)
    ds_write_b128 v11, v[32:35] offset:16384
    s_waitcnt lgkmcnt(0)
    buffer_load_dwordx4 v[160:163], v16, s[4:7], s49 offen offset:192
    buffer_load_dwordx4 v[164:167], v16, s[4:7], s50 offen offset:192
    buffer_load_dwordx4 v[168:171], v16, s[4:7], s51 offen offset:192
    buffer_load_dwordx4 v[172:175], v16, s[4:7], s52 offen offset:192
    buffer_load_dwordx4 v[32:35], v16, s[4:7], s53 offen offset:192
    s_waitcnt vmcnt(0)
    ds_write_b128 v11, v[32:35] offset:17408
    s_waitcnt lgkmcnt(0)
    buffer_load_dwordx4 v[176:179], v16, s[4:7], s54 offen offset:192
    buffer_load_dwordx4 v[180:183], v16, s[4:7], s55 offen offset:192
    buffer_load_dwordx4 v[184:187], v16, s[4:7], s56 offen offset:192
    buffer_load_dwordx4 v[188:191], v16, s[4:7], s57 offen offset:192
    buffer_load_dwordx4 v[32:35], v16, s[4:7], s48 offen offset:256
    s_waitcnt vmcnt(0)
    ds_write_b128 v11, v[32:35] offset:18432
    s_waitcnt lgkmcnt(0)
    buffer_load_dwordx4 v[192:195], v16, s[4:7], s49 offen offset:256
    buffer_load_dwordx4 v[196:199], v16, s[4:7], s50 offen offset:256
    buffer_load_dwordx4 v[200:203], v16, s[4:7], s51 offen offset:256
    buffer_load_dwordx4 v[204:207], v16, s[4:7], s52 offen offset:256
    buffer_load_dwordx4 v[208:211], v16, s[4:7], s53 offen offset:256
    buffer_load_dwordx4 v[32:35], v16, s[4:7], s54 offen offset:256
    s_waitcnt vmcnt(0)
    ds_write_b128 v11, v[32:35] offset:19456
    s_waitcnt lgkmcnt(0)
    buffer_load_dwordx4 v[212:215], v16, s[4:7], s55 offen offset:256
    buffer_load_dwordx4 v[216:219], v16, s[4:7], s56 offen offset:256
    buffer_load_dwordx4 v[220:223], v16, s[4:7], s57 offen offset:256
    buffer_load_dwordx4 v[224:227], v16, s[4:7], s48 offen offset:320
    buffer_load_dwordx4 v[32:35], v16, s[4:7], s49 offen offset:320
    s_waitcnt vmcnt(0)
    ds_write_b128 v11, v[32:35] offset:20480
    s_waitcnt lgkmcnt(0)
    buffer_load_dwordx4 v[228:231], v16, s[4:7], s50 offen offset:320
    buffer_load_dwordx4 v[232:235], v16, s[4:7], s51 offen offset:320
    buffer_load_dwordx4 v[236:239], v16, s[4:7], s52 offen offset:320
    buffer_load_dwordx4 v[240:243], v16, s[4:7], s53 offen offset:320
    buffer_load_dwordx4 v[244:247], v16, s[4:7], s54 offen offset:320
    buffer_load_dwordx4 v[32:35], v16, s[4:7], s55 offen offset:320
    s_waitcnt vmcnt(0)
    ds_write_b128 v11, v[32:35] offset:21504
    s_waitcnt lgkmcnt(0)
    buffer_load_dwordx4 v[248:251], v16, s[4:7], s56 offen offset:320
    buffer_load_dwordx4 v[252:255], v16, s[4:7], s57 offen offset:320
    s_waitcnt vmcnt(0)
    s_mov_b32 s29, 0
vo_loop:
    s_and_b32 s30, s2, 3
    s_mul_i32 s30, s30, 666368
    s_mul_i32 s31, s29, 10240
    s_add_u32 s30, s30, s31
    s_add_u32 s30, s30, 199370752
    s_cmp_eq_u32 s29, 0
    s_cselect_b32 s30, 199360512, s30
    s_mov_b32 s31, 0
vo_poll:
    buffer_load_dwordx4 v[104:107], v4, s[4:7], s30 offen sc1
    buffer_load_dwordx4 v[108:111], v5, s[4:7], s30 offen sc1
    buffer_load_dwordx4 v[112:115], v6, s[4:7], s30 offen sc1
    s_waitcnt vmcnt(0)
    v_max3_u32 v116, v104, v105, v106
    v_max3_u32 v116, v116, v107, v108
    v_max3_u32 v116, v116, v109, v110
    v_max3_u32 v116, v116, v111, v112
    v_max3_u32 v116, v116, v113, v114
    v_max_u32 v116, v116, v115
    v_cmp_eq_u32 vcc, -1, v116
    s_nop 3
    s_cbranch_vccz vo_poll_ok0
    s_add_u32 s31, s31, 1
    s_cmp_ge_u32 s31, 262144
    s_cbranch_scc1 chain_done
    s_branch vo_poll
vo_poll_ok0:
    ds_write_b128 v7, v[104:107]
    ds_write_b128 v8, v[108:111]
    ds_write_b128 v9, v[112:115]
vo_poll_fin:
    s_waitcnt lgkmcnt(0)
    s_barrier
    s_cmp_lg_u32 s28, 1
    s_cbranch_scc1 vo_sigp
    s_cmp_eq_u32 s29, 0
    s_cbranch_scc1 vo_sigp
    s_lshl_b32 s38, s29, 6
    s_add_u32 s38, s38, 224341952
    s_mov_b64 exec, 1
    v_mov_b32 v117, 1
    buffer_atomic_add v117, off, s[4:7], s38 sc1
    s_mov_b64 exec, -1
vo_sigp:
    ds_read_b128 v[32:35], v10 offset:0
    ds_read_b128 v[36:39], v10 offset:64
    ds_read_b128 v[40:43], v10 offset:128
    ds_read_b128 v[48:51], v11 offset:0
    ds_read_b128 v[52:55], v11 offset:1024
    ds_read_b128 v[56:59], v11 offset:2048
    s_waitcnt lgkmcnt(5)
    v_mfma_f32_16x16x32_bf16 v[64:67], a[0:3], v[32:35], 0
    ds_read_b128 v[44:47], v10 offset:192
    v_mfma_f32_16x16x32_bf16 v[68:71], a[4:7], v[32:35], 0
    s_waitcnt lgkmcnt(3)
    v_mfma_f32_16x16x32_bf16 v[72:75], v[48:51], v[32:35], 0
    ds_read_b128 v[60:63], v11 offset:3072
    v_mfma_f32_16x16x32_bf16 v[64:67], a[8:11], v[36:39], v[64:67]
    ds_read_b128 v[32:35], v10 offset:256
    v_mfma_f32_16x16x32_bf16 v[68:71], a[12:15], v[36:39], v[68:71]
    v_mfma_f32_16x16x32_bf16 v[72:75], a[16:19], v[36:39], v[72:75]
    v_mfma_f32_16x16x32_bf16 v[64:67], a[20:23], v[40:43], v[64:67]
    ds_read_b128 v[36:39], v10 offset:320
    v_mfma_f32_16x16x32_bf16 v[68:71], a[24:27], v[40:43], v[68:71]
    s_waitcnt lgkmcnt(5)
    v_mfma_f32_16x16x32_bf16 v[72:75], v[52:55], v[40:43], v[72:75]
    ds_read_b128 v[48:51], v11 offset:4096
    s_waitcnt lgkmcnt(4)
    v_mfma_f32_16x16x32_bf16 v[64:67], a[28:31], v[44:47], v[64:67]
    ds_read_b128 v[40:43], v10 offset:384
    v_mfma_f32_16x16x32_bf16 v[68:71], a[32:35], v[44:47], v[68:71]
    v_mfma_f32_16x16x32_bf16 v[72:75], a[36:39], v[44:47], v[72:75]
    s_waitcnt lgkmcnt(3)
    v_mfma_f32_16x16x32_bf16 v[64:67], a[40:43], v[32:35], v[64:67]
    ds_read_b128 v[44:47], v10 offset:448
    v_mfma_f32_16x16x32_bf16 v[68:71], v[56:59], v[32:35], v[68:71]
    ds_read_b128 v[52:55], v11 offset:5120
    v_mfma_f32_16x16x32_bf16 v[72:75], a[44:47], v[32:35], v[72:75]
    s_waitcnt lgkmcnt(4)
    v_mfma_f32_16x16x32_bf16 v[64:67], a[48:51], v[36:39], v[64:67]
    ds_read_b128 v[32:35], v10 offset:512
    v_mfma_f32_16x16x32_bf16 v[68:71], a[52:55], v[36:39], v[68:71]
    v_mfma_f32_16x16x32_bf16 v[72:75], a[56:59], v[36:39], v[72:75]
    s_waitcnt lgkmcnt(3)
    v_mfma_f32_16x16x32_bf16 v[64:67], a[60:63], v[40:43], v[64:67]
    ds_read_b128 v[36:39], v10 offset:576
    v_mfma_f32_16x16x32_bf16 v[68:71], v[60:63], v[40:43], v[68:71]
    ds_read_b128 v[56:59], v11 offset:6144
    v_mfma_f32_16x16x32_bf16 v[72:75], a[64:67], v[40:43], v[72:75]
    s_waitcnt lgkmcnt(4)
    v_mfma_f32_16x16x32_bf16 v[64:67], a[68:71], v[44:47], v[64:67]
    ds_read_b128 v[40:43], v10 offset:640
    v_mfma_f32_16x16x32_bf16 v[68:71], a[72:75], v[44:47], v[68:71]
    v_mfma_f32_16x16x32_bf16 v[72:75], a[76:79], v[44:47], v[72:75]
    s_waitcnt lgkmcnt(3)
    v_mfma_f32_16x16x32_bf16 v[64:67], v[48:51], v[32:35], v[64:67]
    ds_read_b128 v[60:63], v11 offset:7168
    ds_read_b128 v[44:47], v10 offset:704
    v_mfma_f32_16x16x32_bf16 v[68:71], a[80:83], v[32:35], v[68:71]
    v_mfma_f32_16x16x32_bf16 v[72:75], a[84:87], v[32:35], v[72:75]
    s_waitcnt lgkmcnt(4)
    v_mfma_f32_16x16x32_bf16 v[64:67], a[88:91], v[36:39], v[64:67]
    ds_read_b128 v[32:35], v10 offset:768
    v_mfma_f32_16x16x32_bf16 v[68:71], a[92:95], v[36:39], v[68:71]
    v_mfma_f32_16x16x32_bf16 v[72:75], v[52:55], v[36:39], v[72:75]
    ds_read_b128 v[48:51], v11 offset:8192
    s_waitcnt lgkmcnt(4)
    v_mfma_f32_16x16x32_bf16 v[64:67], a[96:99], v[40:43], v[64:67]
    ds_read_b128 v[36:39], v10 offset:832
    v_mfma_f32_16x16x32_bf16 v[68:71], a[100:103], v[40:43], v[68:71]
    v_mfma_f32_16x16x32_bf16 v[72:75], a[104:107], v[40:43], v[72:75]
    s_waitcnt lgkmcnt(3)
    v_mfma_f32_16x16x32_bf16 v[64:67], a[108:111], v[44:47], v[64:67]
    ds_read_b128 v[40:43], v10 offset:896
    v_mfma_f32_16x16x32_bf16 v[68:71], a[112:115], v[44:47], v[68:71]
    v_mfma_f32_16x16x32_bf16 v[72:75], v[56:59], v[44:47], v[72:75]
    ds_read_b128 v[52:55], v11 offset:9216
    s_waitcnt lgkmcnt(4)
    v_mfma_f32_16x16x32_bf16 v[64:67], a[116:119], v[32:35], v[64:67]
    ds_read_b128 v[44:47], v10 offset:960
    v_mfma_f32_16x16x32_bf16 v[68:71], a[120:123], v[32:35], v[68:71]
    v_mfma_f32_16x16x32_bf16 v[72:75], a[124:127], v[32:35], v[72:75]
    s_waitcnt lgkmcnt(3)
    v_mfma_f32_16x16x32_bf16 v[64:67], a[128:131], v[36:39], v[64:67]
    ds_read_b128 v[32:35], v10 offset:1024
    v_mfma_f32_16x16x32_bf16 v[68:71], v[60:63], v[36:39], v[68:71]
    ds_read_b128 v[56:59], v11 offset:10240
    v_mfma_f32_16x16x32_bf16 v[72:75], a[132:135], v[36:39], v[72:75]
    s_waitcnt lgkmcnt(4)
    v_mfma_f32_16x16x32_bf16 v[64:67], a[136:139], v[40:43], v[64:67]
    ds_read_b128 v[36:39], v10 offset:1088
    v_mfma_f32_16x16x32_bf16 v[68:71], a[140:143], v[40:43], v[68:71]
    v_mfma_f32_16x16x32_bf16 v[72:75], a[144:147], v[40:43], v[72:75]
    s_waitcnt lgkmcnt(3)
    v_mfma_f32_16x16x32_bf16 v[64:67], a[148:151], v[44:47], v[64:67]
    ds_read_b128 v[40:43], v10 offset:1152
    v_mfma_f32_16x16x32_bf16 v[68:71], v[48:51], v[44:47], v[68:71]
    v_mfma_f32_16x16x32_bf16 v[72:75], a[152:155], v[44:47], v[72:75]
    s_waitcnt lgkmcnt(3)
    v_mfma_f32_16x16x32_bf16 v[64:67], a[156:159], v[32:35], v[64:67]
    ds_read_b128 v[44:47], v10 offset:1216
    v_mfma_f32_16x16x32_bf16 v[68:71], a[160:163], v[32:35], v[68:71]
    v_mfma_f32_16x16x32_bf16 v[72:75], a[164:167], v[32:35], v[72:75]
    s_waitcnt lgkmcnt(2)
    v_mfma_f32_16x16x32_bf16 v[64:67], v[52:55], v[36:39], v[64:67]
    v_mfma_f32_16x16x32_bf16 v[68:71], a[168:171], v[36:39], v[68:71]
    v_mfma_f32_16x16x32_bf16 v[72:75], a[172:175], v[36:39], v[72:75]
    s_waitcnt lgkmcnt(1)
    v_mfma_f32_16x16x32_bf16 v[64:67], a[176:179], v[40:43], v[64:67]
    v_mfma_f32_16x16x32_bf16 v[68:71], a[180:183], v[40:43], v[68:71]
    v_mfma_f32_16x16x32_bf16 v[72:75], a[184:187], v[40:43], v[72:75]
    s_waitcnt lgkmcnt(0)
    v_mfma_f32_16x16x32_bf16 v[64:67], v[56:59], v[44:47], v[64:67]
    v_mfma_f32_16x16x32_bf16 v[68:71], a[188:191], v[44:47], v[68:71]
    v_mfma_f32_16x16x32_bf16 v[72:75], a[192:195], v[44:47], v[72:75]
    s_nop 7
    v_cvt_pk_bf16_f32 v64, v64, v65
    v_cvt_pk_bf16_f32 v65, v66, v67
    ds_write_b64 v12, v[64:65] offset:0
    v_cvt_pk_bf16_f32 v68, v68, v69
    v_cvt_pk_bf16_f32 v69, v70, v71
    ds_write_b64 v12, v[68:69] offset:32
    v_cvt_pk_bf16_f32 v72, v72, v73
    v_cvt_pk_bf16_f32 v73, v74, v75
    ds_write_b64 v12, v[72:73] offset:64
    s_waitcnt lgkmcnt(0)
    s_barrier
    ds_read_b128 v[32:35], v13 offset:0
    ds_read_b128 v[36:39], v13 offset:64
    ds_read_b128 v[40:43], v13 offset:128
    ds_read_b128 v[48:51], v11 offset:11264
    ds_read_b128 v[52:55], v11 offset:12288
    ds_read_b128 v[56:59], v11 offset:13312
    s_waitcnt lgkmcnt(5)
    v_mfma_f32_16x16x32_bf16 v[64:67], v[32:35], a[196:199], 0
    ds_read_b128 v[44:47], v13 offset:192
    v_mfma_f32_16x16x32_bf16 v[68:71], v[32:35], a[200:203], 0
    s_waitcnt lgkmcnt(3)
    v_mfma_f32_16x16x32_bf16 v[72:75], v[32:35], v[48:51], 0
    ds_read_b128 v[60:63], v11 offset:14336
    v_mfma_f32_16x16x32_bf16 v[76:79], v[32:35], a[204:207], 0
    v_mfma_f32_16x16x32_bf16 v[80:83], v[32:35], a[208:211], 0
    v_mfma_f32_16x16x32_bf16 v[84:87], v[32:35], a[212:215], 0
    v_mfma_f32_16x16x32_bf16 v[88:91], v[32:35], a[216:219], 0
    v_mfma_f32_16x16x32_bf16 v[92:95], v[32:35], a[220:223], 0
    s_waitcnt lgkmcnt(3)
    v_mfma_f32_16x16x32_bf16 v[96:99], v[32:35], v[52:55], 0
    ds_read_b128 v[48:51], v11 offset:15360
    v_mfma_f32_16x16x32_bf16 v[100:103], v[32:35], a[224:227], 0
    v_mfma_f32_16x16x32_bf16 v[64:67], v[36:39], a[228:231], v[64:67]
    ds_read_b128 v[32:35], v13 offset:256
    v_mfma_f32_16x16x32_bf16 v[68:71], v[36:39], a[232:235], v[68:71]
    v_mfma_f32_16x16x32_bf16 v[72:75], v[36:39], a[236:239], v[72:75]
    s_waitcnt lgkmcnt(4)
    v_mfma_f32_16x16x32_bf16 v[76:79], v[36:39], v[56:59], v[76:79]
    ds_read_b128 v[52:55], v11 offset:16384
    v_mfma_f32_16x16x32_bf16 v[80:83], v[36:39], a[240:243], v[80:83]
    v_mfma_f32_16x16x32_bf16 v[84:87], v[36:39], a[244:247], v[84:87]
    v_mfma_f32_16x16x32_bf16 v[88:91], v[36:39], a[248:251], v[88:91]
    v_mfma_f32_16x16x32_bf16 v[92:95], v[36:39], a[252:255], v[92:95]
    v_mfma_f32_16x16x32_bf16 v[96:99], v[36:39], v[120:123], v[96:99]
    s_waitcnt lgkmcnt(3)
    v_mfma_f32_16x16x32_bf16 v[100:103], v[36:39], v[60:63], v[100:103]
    ds_read_b128 v[56:59], v11 offset:17408
    v_mfma_f32_16x16x32_bf16 v[64:67], v[40:43], v[124:127], v[64:67]
    ds_read_b128 v[36:39], v13 offset:320
    v_mfma_f32_16x16x32_bf16 v[68:71], v[40:43], v[128:131], v[68:71]
    v_mfma_f32_16x16x32_bf16 v[72:75], v[40:43], v[132:135], v[72:75]
    v_mfma_f32_16x16x32_bf16 v[76:79], v[40:43], v[136:139], v[76:79]
    s_waitcnt lgkmcnt(4)
    v_mfma_f32_16x16x32_bf16 v[80:83], v[40:43], v[48:51], v[80:83]
    ds_read_b128 v[60:63], v11 offset:18432
    v_mfma_f32_16x16x32_bf16 v[84:87], v[40:43], v[140:143], v[84:87]
    v_mfma_f32_16x16x32_bf16 v[88:91], v[40:43], v[144:147], v[88:91]
    v_mfma_f32_16x16x32_bf16 v[92:95], v[40:43], v[148:151], v[92:95]
    v_mfma_f32_16x16x32_bf16 v[96:99], v[40:43], v[152:155], v[96:99]
    v_mfma_f32_16x16x32_bf16 v[100:103], v[40:43], v[156:159], v[100:103]
    s_waitcnt lgkmcnt(3)
    v_mfma_f32_16x16x32_bf16 v[64:67], v[44:47], v[52:55], v[64:67]
    ds_read_b128 v[48:51], v11 offset:19456
    v_mfma_f32_16x16x32_bf16 v[68:71], v[44:47], v[160:163], v[68:71]
    v_mfma_f32_16x16x32_bf16 v[72:75], v[44:47], v[164:167], v[72:75]
    v_mfma_f32_16x16x32_bf16 v[76:79], v[44:47], v[168:171], v[76:79]
    v_mfma_f32_16x16x32_bf16 v[80:83], v[44:47], v[172:175], v[80:83]
    s_waitcnt lgkmcnt(3)
    v_mfma_f32_16x16x32_bf16 v[84:87], v[44:47], v[56:59], v[84:87]
    ds_read_b128 v[52:55], v11 offset:20480
    v_mfma_f32_16x16x32_bf16 v[88:91], v[44:47], v[176:179], v[88:91]
    v_mfma_f32_16x16x32_bf16 v[92:95], v[44:47], v[180:183], v[92:95]
    v_mfma_f32_16x16x32_bf16 v[96:99], v[44:47], v[184:187], v[96:99]
    v_mfma_f32_16x16x32_bf16 v[100:103], v[44:47], v[188:191], v[100:103]
    s_waitcnt lgkmcnt(2)
    v_mfma_f32_16x16x32_bf16 v[64:67], v[32:35], v[60:63], v[64:67]
    ds_read_b128 v[56:59], v11 offset:21504
    v_mfma_f32_16x16x32_bf16 v[68:71], v[32:35], v[192:195], v[68:71]
    v_mfma_f32_16x16x32_bf16 v[72:75], v[32:35], v[196:199], v[72:75]
    v_mfma_f32_16x16x32_bf16 v[76:79], v[32:35], v[200:203], v[76:79]
    v_mfma_f32_16x16x32_bf16 v[80:83], v[32:35], v[204:207], v[80:83]
    v_mfma_f32_16x16x32_bf16 v[84:87], v[32:35], v[208:211], v[84:87]
    s_waitcnt lgkmcnt(2)
    v_mfma_f32_16x16x32_bf16 v[88:91], v[32:35], v[48:51], v[88:91]
    v_mfma_f32_16x16x32_bf16 v[92:95], v[32:35], v[212:215], v[92:95]
    v_mfma_f32_16x16x32_bf16 v[96:99], v[32:35], v[216:219], v[96:99]
    v_mfma_f32_16x16x32_bf16 v[100:103], v[32:35], v[220:223], v[100:103]
    v_mfma_f32_16x16x32_bf16 v[64:67], v[36:39], v[224:227], v[64:67]
    s_waitcnt lgkmcnt(1)
    v_mfma_f32_16x16x32_bf16 v[68:71], v[36:39], v[52:55], v[68:71]
    v_mfma_f32_16x16x32_bf16 v[72:75], v[36:39], v[228:231], v[72:75]
    v_mfma_f32_16x16x32_bf16 v[76:79], v[36:39], v[232:235], v[76:79]
    v_mfma_f32_16x16x32_bf16 v[80:83], v[36:39], v[236:239], v[80:83]
    v_mfma_f32_16x16x32_bf16 v[84:87], v[36:39], v[240:243], v[84:87]
    v_mfma_f32_16x16x32_bf16 v[88:91], v[36:39], v[244:247], v[88:91]
    s_waitcnt lgkmcnt(0)
    v_mfma_f32_16x16x32_bf16 v[92:95], v[36:39], v[56:59], v[92:95]
    v_mfma_f32_16x16x32_bf16 v[96:99], v[36:39], v[248:251], v[96:99]
    v_mfma_f32_16x16x32_bf16 v[100:103], v[36:39], v[252:255], v[100:103]
    s_nop 7
    s_mul_i32 s16, s29, 327680
    s_mov_b64 exec, s[42:43]
    v_cvt_pk_bf16_f32 v64, v64, v65
    v_cvt_pk_bf16_f32 v65, v66, v67
    v_min_u32 v64, -2, v64
    v_min_u32 v65, -2, v65
    s_add_u32 s17, s16, 0
    buffer_store_dwordx2 v[64:65], v14, s[4:7], s17 offen sc1
    v_cvt_pk_bf16_f32 v68, v68, v69
    v_cvt_pk_bf16_f32 v69, v70, v71
    v_min_u32 v68, -2, v68
    v_min_u32 v69, -2, v69
    s_add_u32 s17, s16, 8192
    buffer_store_dwordx2 v[68:69], v14, s[4:7], s17 offen sc1
    v_cvt_pk_bf16_f32 v72, v72, v73
    v_cvt_pk_bf16_f32 v73, v74, v75
    v_min_u32 v72, -2, v72
    v_min_u32 v73, -2, v73
    s_add_u32 s17, s16, 16384
    buffer_store_dwordx2 v[72:73], v14, s[4:7], s17 offen sc1
    v_cvt_pk_bf16_f32 v76, v76, v77
    v_cvt_pk_bf16_f32 v77, v78, v79
    v_min_u32 v76, -2, v76
    v_min_u32 v77, -2, v77
    s_add_u32 s17, s16, 24576
    buffer_store_dwordx2 v[76:77], v14, s[4:7], s17 offen sc1
    v_cvt_pk_bf16_f32 v80, v80, v81
    v_cvt_pk_bf16_f32 v81, v82, v83
    v_min_u32 v80, -2, v80
    v_min_u32 v81, -2, v81
    s_add_u32 s17, s16, 32768
    buffer_store_dwordx2 v[80:81], v14, s[4:7], s17 offen sc1
    v_cvt_pk_bf16_f32 v84, v84, v85
    v_cvt_pk_bf16_f32 v85, v86, v87
    v_min_u32 v84, -2, v84
    v_min_u32 v85, -2, v85
    s_add_u32 s17, s16, 40960
    buffer_store_dwordx2 v[84:85], v14, s[4:7], s17 offen sc1
    v_cvt_pk_bf16_f32 v88, v88, v89
    v_cvt_pk_bf16_f32 v89, v90, v91
    v_min_u32 v88, -2, v88
    v_min_u32 v89, -2, v89
    s_add_u32 s17, s16, 49152
    buffer_store_dwordx2 v[88:89], v14, s[4:7], s17 offen sc1
    v_cvt_pk_bf16_f32 v92, v92, v93
    v_cvt_pk_bf16_f32 v93, v94, v95
    v_min_u32 v92, -2, v92
    v_min_u32 v93, -2, v93
    s_add_u32 s17, s16, 57344
    buffer_store_dwordx2 v[92:93], v14, s[4:7], s17 offen sc1
    v_cvt_pk_bf16_f32 v96, v96, v97
    v_cvt_pk_bf16_f32 v97, v98, v99
    v_min_u32 v96, -2, v96
    v_min_u32 v97, -2, v97
    s_add_u32 s17, s16, 65536
    buffer_store_dwordx2 v[96:97], v14, s[4:7], s17 offen sc1
    v_cvt_pk_bf16_f32 v100, v100, v101
    v_cvt_pk_bf16_f32 v101, v102, v103
    v_min_u32 v100, -2, v100
    v_min_u32 v101, -2, v101
    s_add_u32 s17, s16, 73728
    buffer_store_dwordx2 v[100:101], v14, s[4:7], s17 offen sc1
    s_mov_b64 exec, -1
    s_add_u32 s29, s29, 1
    s_cmp_lt_u32 s29, 64
    s_cbranch_scc1 vo_loop
    s_waitcnt vmcnt(0)
    s_barrier
    s_cmp_lg_u32 s28, 1
    s_cbranch_scc1 vo_sigl
    s_mov_b32 s38, 224346048
    s_mov_b64 exec, 1
    v_mov_b32 v117, 1
    buffer_atomic_add v117, off, s[4:7], s38 sc1
    s_mov_b64 exec, -1
vo_sigl:
    s_branch chain_worker
chain_red:
    s_sub_u32 s3, s2, 64
    v_and_b32 v1, 15, v0
    v_bfe_u32 v2, v0, 4, 2
    v_lshrrev_b32 v3, 6, v0
    s_nop 0
    v_readfirstlane_b32 s28, v3
    v_lshl_add_u32 v10, v3, 3, v2
    v_lshlrev_b32 v10, 8, v10
    v_lshl_add_u32 v4, v1, 4, v10
    s_lshl_b32 s16, s3, 13
    s_add_u32 s20, s16, 203348224
    v_mul_u32_u24 v10, 327680, v3
    v_lshl_add_u32 v10, v1, 6, v10
    v_lshl_add_u32 v5, v2, 4, v10
    s_lshl_b32 s16, s3, 10
    s_add_u32 s21, s16, 115474432
    v_mul_u32_u24 v10, 5120, v3
    v_and_b32 v11, 7, v1
    v_lshl_add_u32 v11, v2, 3, v11
    v_lshl_add_u32 v6, v11, 4, v10
    s_and_b32 s16, s2, 0
    s_mul_i32 s22, s16, 1312000
    s_add_u32 s22, s22, 202036224
    v_lshlrev_b32 v7, 5, v1
    v_lshl_add_u32 v7, v2, 3, v7
    s_lshl_b32 s16, s3, 8
    v_add_u32 v7, s16, v7
    v_and_b32 v10, 63, v0
    v_lshlrev_b32 v9, 4, v10
    v_lshl_add_u32 v8, v3, 10, v9
    s_mov_b32 s29, 0
red_loop:
    s_mul_i32 s16, s29, 327680
    s_add_u32 s16, s16, s20
    s_mul_i32 s17, s29, 20480
    s_add_u32 s17, s17, s22
    s_add_u32 s23, s17, 4096
    s_mul_i32 s18, s29, 1310720
    s_add_u32 s18, s18, s21
    s_lshl_b32 s38, s29, 6
    s_add_u32 s38, s38, 224330496
    s_and_b32 s19, s29, 3
    s_cmp_lg_u32 s19, 0
    s_cbranch_scc1 red_wb_skip
    s_lshr_b32 s38, s29, 2
    s_lshl_b32 s38, s38, 6
    s_add_u32 s38, s38, 224332800
red_wb_go:
    s_mov_b32 s36, 0
red_wb:
    buffer_load_dword v15, off, s[4:7], s38 sc1
    s_waitcnt vmcnt(0)
    v_readfirstlane_b32 s35, v15
    s_add_u32 s36, s36, 1
    s_cmp_ge_u32 s36, 262144
    s_cbranch_scc1 chain_done
    s_cmp_ge_u32 s35, 64
    s_cbranch_scc1 red_wb_ok
    s_sleep 4
    s_branch red_wb
red_wb_ok:
red_wb_skip:
    s_add_u32 s19, s18, 0
    buffer_load_dwordx4 v[20:23], v5, s[4:7], s19 offen sc1
    s_add_u32 s19, s18, 40960
    buffer_load_dwordx4 v[24:27], v5, s[4:7], s19 offen sc1
    s_add_u32 s19, s18, 81920
    buffer_load_dwordx4 v[28:31], v5, s[4:7], s19 offen sc1
    s_add_u32 s19, s18, 122880
    buffer_load_dwordx4 v[32:35], v5, s[4:7], s19 offen sc1
    s_add_u32 s19, s18, 163840
    buffer_load_dwordx4 v[36:39], v5, s[4:7], s19 offen sc1
    s_add_u32 s19, s18, 204800
    buffer_load_dwordx4 v[40:43], v5, s[4:7], s19 offen sc1
    s_add_u32 s19, s18, 245760
    buffer_load_dwordx4 v[44:47], v5, s[4:7], s19 offen sc1
    s_add_u32 s19, s18, 286720
    buffer_load_dwordx4 v[48:51], v5, s[4:7], s19 offen sc1
    s_mov_b32 s31, 0
red_pollu:
    buffer_load_dwordx4 v[148:151], v4, s[4:7], s16 offen sc1
    buffer_load_dwordx4 v[152:155], v4, s[4:7], s16 offen offset:1024 sc1
    s_waitcnt vmcnt(0)
    v_max3_u32 v10, v148, v149, v150
    v_max3_u32 v10, v10, v151, v152
    v_max3_u32 v10, v10, v153, v154
    v_max_u32 v10, v10, v155
    v_cmp_eq_u32 vcc, -1, v10
    s_add_u32 s31, s31, 1
    s_cmp_ge_u32 s31, 262144
    s_cbranch_scc1 chain_done
    s_cbranch_vccz red_pollu_ok
    s_branch red_pollu
red_pollu_ok:
    s_mov_b32 s31, 0
    s_mov_b64 exec, s[40:41]
red_poll:
    buffer_load_dwordx4 v[52:55], v6, s[4:7], s17 offen offset:0 sc1
    buffer_load_dwordx4 v[56:59], v6, s[4:7], s17 offen offset:512 sc1
    buffer_load_dwordx4 v[60:63], v6, s[4:7], s17 offen offset:1024 sc1
    buffer_load_dwordx4 v[64:67], v6, s[4:7], s17 offen offset:1536 sc1
    buffer_load_dwordx4 v[68:71], v6, s[4:7], s17 offen offset:2048 sc1
    buffer_load_dwordx4 v[72:75], v6, s[4:7], s17 offen offset:2560 sc1
    buffer_load_dwordx4 v[76:79], v6, s[4:7], s17 offen offset:3072 sc1
    buffer_load_dwordx4 v[80:83], v6, s[4:7], s17 offen offset:3584 sc1
    buffer_load_dwordx4 v[84:87], v6, s[4:7], s23 offen offset:0 sc1
    buffer_load_dwordx4 v[88:91], v6, s[4:7], s23 offen offset:512 sc1
    s_waitcnt vmcnt(0)
    v_max3_u32 v10, v52, v53, v54
    v_max3_u32 v10, v10, v55, v56
    v_max3_u32 v10, v10, v57, v58
    v_max3_u32 v10, v10, v59, v60
    v_max3_u32 v10, v10, v61, v62
    v_max3_u32 v10, v10, v63, v64
    v_max3_u32 v10, v10, v65, v66
    v_max3_u32 v10, v10, v67, v68
    v_max3_u32 v10, v10, v69, v70
    v_max3_u32 v10, v10, v71, v72
    v_max3_u32 v10, v10, v73, v74
    v_max3_u32 v10, v10, v75, v76
    v_max3_u32 v10, v10, v77, v78
    v_max3_u32 v10, v10, v79, v80
    v_max3_u32 v10, v10, v81, v82
    v_max3_u32 v10, v10, v83, v84
    v_max3_u32 v10, v10, v85, v86
    v_max3_u32 v10, v10, v87, v88
    v_max3_u32 v10, v10, v89, v90
    v_max_u32 v10, v10, v91
    v_cmp_eq_u32 vcc, -1, v10
    s_nop 3
    s_cbranch_vccz red_ok0
    s_add_u32 s31, s31, 1
    s_cmp_ge_u32 s31, 262144
    s_cbranch_scc1 chain_done
    s_branch red_poll
red_ok0:
    s_mov_b64 exec, -1
    v_mfma_f32_16x16x32_bf16 v[16:19], v[148:151], v[52:55], 0
    v_mfma_f32_16x16x32_bf16 v[16:19], v[152:155], v[56:59], v[16:19]
    v_mfma_f32_16x16x32_bf16 v[16:19], v[20:23], v[60:63], v[16:19]
    v_mfma_f32_16x16x32_bf16 v[16:19], v[24:27], v[64:67], v[16:19]
    v_mfma_f32_16x16x32_bf16 v[16:19], v[28:31], v[68:71], v[16:19]
    v_mfma_f32_16x16x32_bf16 v[16:19], v[32:35], v[72:75], v[16:19]
    v_mfma_f32_16x16x32_bf16 v[16:19], v[36:39], v[76:79], v[16:19]
    v_mfma_f32_16x16x32_bf16 v[16:19], v[40:43], v[80:83], v[16:19]
    v_mfma_f32_16x16x32_bf16 v[16:19], v[44:47], v[84:87], v[16:19]
    v_mfma_f32_16x16x32_bf16 v[16:19], v[48:51], v[88:91], v[16:19]
red_fin:
    s_nop 7
    s_cmp_eq_u32 s28, 0
    s_cbranch_scc1 red_w0a
    ds_write_b128 v8, v[16:19]
    s_waitcnt lgkmcnt(0)
red_w0a:
    s_barrier
    s_cmp_eq_u32 s28, 0
    s_cbranch_scc0 red_next
    ds_read_b128 v[24:27], v9 offset:1024
    ds_read_b128 v[28:31], v9 offset:2048
    ds_read_b128 v[32:35], v9 offset:3072
    s_waitcnt lgkmcnt(0)
    v_add_f32 v16, v16, v24
    v_add_f32 v17, v17, v25
    v_add_f32 v18, v18, v26
    v_add_f32 v19, v19, v27
    v_add_f32 v16, v16, v28
    v_add_f32 v17, v17, v29
    v_add_f32 v18, v18, v30
    v_add_f32 v19, v19, v31
    v_add_f32 v16, v16, v32
    v_add_f32 v17, v17, v33
    v_add_f32 v18, v18, v34
    v_add_f32 v19, v19, v35
    v_cvt_pk_bf16_f32 v16, v16, v17
    v_cvt_pk_bf16_f32 v17, v18, v19
    v_min_u32 v16, -2, v16
    v_min_u32 v17, -2, v17
    s_add_u32 s16, s29, 1
    s_mul_i32 s16, s16, 10240
    s_add_u32 s16, s16, 199370752
    s_mov_b64 exec, s[40:41]
    s_add_u32 s17, s16, 0
    buffer_store_dwordx2 v[16:17], v7, s[4:7], s17 offen sc1
    s_add_u32 s17, s16, 666368
    buffer_store_dwordx2 v[16:17], v7, s[4:7], s17 offen sc1
    s_add_u32 s17, s16, 1332736
    buffer_store_dwordx2 v[16:17], v7, s[4:7], s17 offen sc1
    s_add_u32 s17, s16, 1999104
    buffer_store_dwordx2 v[16:17], v7, s[4:7], s17 offen sc1
    s_mov_b64 exec, -1
red_next:
    s_waitcnt vmcnt(0)
    s_add_u32 s29, s29, 1
    s_cmp_lt_u32 s29, 63
    s_cbranch_scc1 red_loop
    s_branch chain_worker
chain_worker:
    s_mov_b64 exec, -1
    v_mov_b32 v250, v0
    v_lshrrev_b32 v1, 6, v0
    s_nop 0
    v_readfirstlane_b32 s52, v1
    v_mov_b32 v251, 163776
wk_loop:
    v_mov_b32 v0, v250
    s_cmp_lg_u32 s52, 0
    s_cbranch_scc1 wk_nofetch
    s_mov_b64 exec, 1
    v_mov_b32 v1, 1
    s_mov_b32 s33, 224329728
    buffer_atomic_add v1, off, s[4:7], s33 sc0 sc1
    s_waitcnt vmcnt(0)
    ds_write_b32 v251, v1
    s_waitcnt lgkmcnt(0)
    s_mov_b64 exec, -1
wk_nofetch:
    s_barrier
    ds_read_b32 v1, v251
    s_waitcnt lgkmcnt(0)
    v_readfirstlane_b32 s32, v1
    s_barrier
    s_mov_b32 s56, 0
    s_cmp_ge_u32 s32, 48
    s_cbranch_scc1 wk_seg1
    s_sub_u32 s34, s32, 0
    s_add_u32 s54, s34, 24
    s_mov_b32 s55, 0
    s_mov_b32 s56, 32
    s_mov_b32 s57, 224331776
    s_mov_b32 s67, 224330240
    s_cmp_lt_u32 s34, 24
    s_cselect_b32 s57, 224330752, s57
    s_cselect_b32 s67, 224329984, s67
    s_branch wk_wsjob
wk_seg1:
    s_cmp_ge_u32 s32, 72
    s_cbranch_scc1 wk_seg2
    s_sub_u32 s34, s32, 48
    s_add_u32 s54, s34, 0
    s_mov_b32 s55, 0
    s_mov_b32 s56, 32
    s_mov_b32 s57, 224333824
    s_mov_b32 s67, 224350464
    s_branch wk_wsjob
wk_seg2:
    s_cmp_ge_u32 s32, 328
    s_cbranch_scc1 wk_seg3
    s_sub_u32 s34, s32, 72
    s_lshr_b32 s16, s34, 6
    s_add_u32 s16, s16, 0
    s_bfe_u32 s18, s34, 0x50001
    s_and_b32 s19, s34, 1
    s_lshl_b32 s38, s16, 6
    s_add_u32 s53, s38, 224332800
    s_add_u32 s38, s38, 224331776
    s_branch wk_b_go
wk_seg3:
    s_cmp_ge_u32 s32, 376
    s_cbranch_scc1 wk_seg4
    s_sub_u32 s34, s32, 328
    s_add_u32 s54, s34, 24
    s_mov_b32 s55, 32
    s_mov_b32 s56, 32
    s_mov_b32 s57, 224331776
    s_mov_b32 s67, 224330240
    s_cmp_lt_u32 s34, 24
    s_cselect_b32 s57, 224330752, s57
    s_cselect_b32 s67, 224329984, s67
    s_branch wk_wsjob
wk_seg4:
    s_cmp_ge_u32 s32, 632
    s_cbranch_scc1 wk_seg5
    s_sub_u32 s34, s32, 376
    s_lshr_b32 s16, s34, 6
    s_add_u32 s16, s16, 4
    s_bfe_u32 s18, s34, 0x50001
    s_and_b32 s19, s34, 1
    s_lshl_b32 s38, s16, 6
    s_add_u32 s53, s38, 224332800
    s_add_u32 s38, s38, 224331776
    s_branch wk_b_go
wk_seg5:
    s_cmp_ge_u32 s32, 656
    s_cbranch_scc1 wk_seg6
    s_sub_u32 s34, s32, 632
    s_add_u32 s54, s34, 0
    s_mov_b32 s55, 32
    s_mov_b32 s56, 32
    s_mov_b32 s57, 224333824
    s_mov_b32 s67, 224350464
    s_branch wk_wsjob
wk_seg6:
    s_cmp_ge_u32 s32, 912
    s_cbranch_scc1 wk_seg7
    s_sub_u32 s34, s32, 656
    s_lshr_b32 s16, s34, 6
    s_add_u32 s16, s16, 8
    s_bfe_u32 s18, s34, 0x50001
    s_and_b32 s19, s34, 1
    s_lshl_b32 s38, s16, 6
    s_add_u32 s53, s38, 224332800
    s_add_u32 s38, s38, 224331776
    s_branch wk_b_go
wk_seg7:
    s_cmp_ge_u32 s32, 1168
    s_cbranch_scc1 wk_seg8
    s_sub_u32 s34, s32, 912
    s_lshr_b32 s16, s34, 6
    s_add_u32 s16, s16, 12
    s_bfe_u32 s18, s34, 0x50001
    s_and_b32 s19, s34, 1
    s_lshl_b32 s38, s16, 6
    s_add_u32 s53, s38, 224332800
    s_add_u32 s38, s38, 224331776
    s_branch wk_b_go
wk_seg8:
    s_sub_u32 s32, s32, 1168
    s_cmp_ge_u32 s32, 5920
    s_cbranch_scc1 wk_exit
    s_mul_hi_u32 s39, s32, 14510025
    s_mul_i32 s34, s39, 296
    s_sub_u32 s34, s32, s34
    s_cmp_ge_u32 s34, 32
    s_cbranch_scc1 wk_pj_o
    s_mov_b32 s37, s39
    s_cmp_ge_u32 s37, 16
    s_cbranch_scc1 wk_loop
    s_lshr_b32 s58, s34, 3
    s_lshl_b32 s59, s37, 2
    s_add_u32 s58, s58, s59
    s_and_b32 s59, s34, 7
    s_lshl_b32 s38, s37, 6
    s_add_u32 s38, s38, 224333824
    s_mov_b32 s36, 0
wk_wq:
    buffer_load_dword v1, off, s[4:7], s38 sc1
    s_waitcnt vmcnt(0)
    v_readfirstlane_b32 s35, v1
    s_add_u32 s36, s36, 1
    s_cmp_ge_u32 s36, 262144
    s_cbranch_scc1 chain_done
    s_cmp_ge_u32 s35, 24
    s_cbranch_scc1 wk_wq_ok
    s_sleep 16
    s_branch wk_wq
wk_wq_ok:
    s_lshl_b32 s38, s58, 6
    s_add_u32 s53, s38, 224346112
    s_add_u32 s66, s38, 224337920
    s_lshl_b32 s38, s37, 6
    s_add_u32 s38, s38, 224330752
    s_mov_b32 s36, 0
wk_wck:
    buffer_load_dword v1, off, s[4:7], s38 sc1
    s_waitcnt vmcnt(0)
    v_readfirstlane_b32 s35, v1
    s_add_u32 s36, s36, 1
    s_cmp_ge_u32 s36, 262144
    s_cbranch_scc1 chain_done
    s_cmp_ge_u32 s35, 24
    s_cbranch_scc1 wk_wck_ok
    s_sleep 16
    s_branch wk_wck
wk_wck_ok:
    s_mov_b32 s16, s58
    s_mov_b32 s17, s59
    s_branch wk_attnp
wk_pj_o:
    s_cmp_ge_u32 s34, 112
    s_cbranch_scc1 wk_pj_l
    s_sub_u32 s37, s39, 1
    s_cmp_ge_u32 s37, 16
    s_cbranch_scc1 wk_loop
    s_sub_u32 s34, s34, 32
    s_cmp_ge_u32 s37, 12
    s_cbranch_scc1 wk_o_small
    s_cmp_ge_u32 s34, 20
    s_cbranch_scc1 wk_loop
    s_mul_hi_u32 s58, s34, 858993460
    s_mul_i32 s59, s58, 5
    s_sub_u32 s59, s34, s59
    s_branch wk_o_common
wk_o_small:
    s_mul_hi_u32 s58, s34, 214748365
    s_mul_i32 s59, s58, 20
    s_sub_u32 s59, s34, s59
wk_o_common:
    s_lshl_b32 s34, s37, 2
    s_add_u32 s58, s58, s34
    s_lshl_b32 s38, s58, 6
    s_add_u32 s66, s38, 224346112
    s_add_u32 s67, s38, 224342016
    s_lshl_b32 s38, s37, 6
    s_add_u32 s53, s38, 224334848
    s_add_u32 s38, s38, 224332800
    s_mov_b32 s16, s58
    s_mov_b32 s17, s59
    s_cmp_lt_u32 s37, 12
    s_cbranch_scc1 wk_o_bigw
    s_mov_b32 s36, 0
wk_wcb:
    buffer_load_dword v1, off, s[4:7], s38 sc1
    s_waitcnt vmcnt(0)
    v_readfirstlane_b32 s35, v1
    s_add_u32 s36, s36, 1
    s_cmp_ge_u32 s36, 262144
    s_cbranch_scc1 chain_done
    s_cmp_ge_u32 s35, 64
    s_cbranch_scc1 wk_wcb_ok
    s_sleep 4
    s_branch wk_wcb
wk_wcb_ok:
    s_branch wk_attno
wk_o_bigw:
    s_mov_b32 s36, 0
wk_wp:
    buffer_load_dword v1, off, s[4:7], s66 sc1
    s_waitcnt vmcnt(0)
    v_readfirstlane_b32 s35, v1
    s_add_u32 s36, s36, 1
    s_cmp_ge_u32 s36, 262144
    s_cbranch_scc1 chain_done
    s_cmp_ge_u32 s35, 8
    s_cbranch_scc1 wk_wp_ok
    s_sleep 4
    s_branch wk_wp
wk_wp_ok:
    s_mov_b32 s36, 0
wk_wu:
    buffer_load_dword v1, off, s[4:7], s67 sc1
    s_waitcnt vmcnt(0)
    v_readfirstlane_b32 s35, v1
    s_add_u32 s36, s36, 1
    s_cmp_ge_u32 s36, 262144
    s_cbranch_scc1 chain_done
    s_cmp_ge_u32 s35, 32
    s_cbranch_scc1 wk_wu_ok
    s_sleep 16
    s_branch wk_wu
wk_wu_ok:
    s_branch wk_attno_big
wk_pj_l:
    s_cmp_ge_u32 s34, 120
    s_cbranch_scc1 wk_pj_f1
    s_sub_u32 s37, s39, 2
    s_cmp_ge_u32 s37, 16
    s_cbranch_scc1 wk_loop
    s_sub_u32 s58, s34, 112
    s_lshl_b32 s38, s37, 6
    s_add_u32 s53, s38, 224335872
    s_add_u32 s38, s38, 224334848
    s_cmp_ge_u32 s37, 12
    s_cbranch_scc1 wk_l_small
    s_mov_b32 s36, 0
wk_wo_b:
    buffer_load_dword v1, off, s[4:7], s38 sc1
    s_waitcnt vmcnt(0)
    v_readfirstlane_b32 s35, v1
    s_add_u32 s36, s36, 1
    s_cmp_ge_u32 s36, 262144
    s_cbranch_scc1 chain_done
    s_cmp_ge_u32 s35, 20
    s_cbranch_scc1 wk_wo_b_ok
    s_sleep 4
    s_branch wk_wo_b
wk_wo_b_ok:
    s_branch wk_l_go
wk_l_small:
    s_mov_b32 s36, 0
wk_wo:
    buffer_load_dword v1, off, s[4:7], s38 sc1
    s_waitcnt vmcnt(0)
    v_readfirstlane_b32 s35, v1
    s_add_u32 s36, s36, 1
    s_cmp_ge_u32 s36, 262144
    s_cbranch_scc1 chain_done
    s_cmp_ge_u32 s35, 80
    s_cbranch_scc1 wk_wo_ok
    s_sleep 4
    s_branch wk_wo
wk_wo_ok:
wk_l_go:
    s_lshl_b32 s16, s37, 7
    s_lshl_b32 s58, s58, 4
    s_add_u32 s16, s16, s58
    s_branch wk_ln2
wk_pj_f1:
    s_cmp_ge_u32 s34, 216
    s_cbranch_scc1 wk_pj_f2
    s_sub_u32 s37, s39, 3
    s_cmp_ge_u32 s37, 16
    s_cbranch_scc1 wk_loop
    s_sub_u32 s58, s34, 120
    s_lshl_b32 s38, s37, 6
    s_add_u32 s53, s38, 224336896
    s_add_u32 s38, s38, 224335872
    s_cmp_ge_u32 s37, 12
    s_cbranch_scc1 wk_f1_small
    s_cmp_ge_u32 s58, 24
    s_cbranch_scc1 wk_loop
    s_mov_b32 s36, 0
wk_wl_b:
    buffer_load_dword v1, off, s[4:7], s38 sc1
    s_waitcnt vmcnt(0)
    v_readfirstlane_b32 s35, v1
    s_add_u32 s36, s36, 1
    s_cmp_ge_u32 s36, 262144
    s_cbranch_scc1 chain_done
    s_cmp_ge_u32 s35, 8
    s_cbranch_scc1 wk_wl_b_ok
    s_sleep 4
    s_branch wk_wl_b
wk_wl_b_ok:
    s_mov_b32 s16, s58
    s_mov_b32 s17, s37
    s_mov_b32 s18, 0
    s_branch wk_ffn1_big
wk_f1_small:
    s_mov_b32 s66, s38
    s_lshr_b32 s16, s58, 1
    s_and_b32 s17, s58, 1
    s_lshl_b32 s58, s37, 1
    s_add_u32 s17, s17, s58
    s_mov_b32 s18, 0
    s_branch wk_ffn1
wk_pj_f2:
    s_sub_u32 s37, s39, 4
    s_cmp_ge_u32 s37, 16
    s_cbranch_scc1 wk_loop
    s_sub_u32 s58, s34, 216
    s_lshl_b32 s38, s37, 6
    s_add_u32 s38, s38, 224336896
    s_mov_b32 s53, 224350208
    s_cmp_ge_u32 s37, 12
    s_cbranch_scc1 wk_f2_small
    s_cmp_ge_u32 s58, 20
    s_cbranch_scc1 wk_loop
    s_mov_b32 s36, 0
wk_wf_b:
    buffer_load_dword v1, off, s[4:7], s38 sc1
    s_waitcnt vmcnt(0)
    v_readfirstlane_b32 s35, v1
    s_add_u32 s36, s36, 1
    s_cmp_ge_u32 s36, 262144
    s_cbranch_scc1 chain_done
    s_cmp_ge_u32 s35, 24
    s_cbranch_scc1 wk_wf_b_ok
    s_sleep 4
    s_branch wk_wf_b
wk_wf_b_ok:
    s_lshr_b32 s16, s58, 1
    s_and_b32 s17, s58, 1
    s_lshl_b32 s58, s37, 1
    s_add_u32 s17, s17, s58
    s_mov_b32 s18, 0
    s_branch wk_ffn2_big
wk_f2_small:
    s_mov_b32 s66, s38
    s_lshr_b32 s16, s58, 2
    s_and_b32 s17, s58, 3
    s_lshl_b32 s58, s37, 2
    s_add_u32 s17, s17, s58
    s_mov_b32 s18, 0
    s_branch wk_ffn2
wk_exit:
    s_branch chain_done
wk_b_go:
    s_mov_b32 s66, s38
    s_branch wk_bjob
wk_wsjob:
    v_and_b32 v1, 15, v0
    v_bfe_u32 v2, v0, 4, 2
    v_lshrrev_b32 v3, 6, v0
    v_lshl_add_u32 v28, v3, 6, v1
    v_mul_u32_u24 v27, 1280, v28
    v_lshl_add_u32 v27, v2, 4, v27
    s_mul_i32 s16, s54, 327680
    s_add_u32 s16, s16, 2621440
    s_add_u32 s17, s16, 0
    buffer_load_dwordx4 a[0:3], v27, s[4:7], s17 offen offset:0
    buffer_load_dwordx4 a[4:7], v27, s[4:7], s17 offen offset:64
    buffer_load_dwordx4 a[8:11], v27, s[4:7], s17 offen offset:128
    buffer_load_dwordx4 a[12:15], v27, s[4:7], s17 offen offset:192
    buffer_load_dwordx4 a[16:19], v27, s[4:7], s17 offen offset:256
    buffer_load_dwordx4 a[20:23], v27, s[4:7], s17 offen offset:320
    buffer_load_dwordx4 a[24:27], v27, s[4:7], s17 offen offset:384
    buffer_load_dwordx4 a[28:31], v27, s[4:7], s17 offen offset:448
    buffer_load_dwordx4 a[32:35], v27, s[4:7], s17 offen offset:512
    buffer_load_dwordx4 a[36:39], v27, s[4:7], s17 offen offset:576
    buffer_load_dwordx4 a[40:43], v27, s[4:7], s17 offen offset:640
    buffer_load_dwordx4 a[44:47], v27, s[4:7], s17 offen offset:704
    buffer_load_dwordx4 a[48:51], v27, s[4:7], s17 offen offset:768
    buffer_load_dwordx4 a[52:55], v27, s[4:7], s17 offen offset:832
    buffer_load_dwordx4 a[56:59], v27, s[4:7], s17 offen offset:896
    buffer_load_dwordx4 a[60:63], v27, s[4:7], s17 offen offset:960
    buffer_load_dwordx4 a[64:67], v27, s[4:7], s17 offen offset:1024
    buffer_load_dwordx4 a[68:71], v27, s[4:7], s17 offen offset:1088
    buffer_load_dwordx4 a[72:75], v27, s[4:7], s17 offen offset:1152
    buffer_load_dwordx4 a[76:79], v27, s[4:7], s17 offen offset:1216
    s_add_u32 s17, s16, 20480
    buffer_load_dwordx4 a[80:83], v27, s[4:7], s17 offen offset:0
    buffer_load_dwordx4 a[84:87], v27, s[4:7], s17 offen offset:64
    buffer_load_dwordx4 a[88:91], v27, s[4:7], s17 offen offset:128
    buffer_load_dwordx4 a[92:95], v27, s[4:7], s17 offen offset:192
    buffer_load_dwordx4 a[96:99], v27, s[4:7], s17 offen offset:256
    buffer_load_dwordx4 a[100:103], v27, s[4:7], s17 offen offset:320
    buffer_load_dwordx4 a[104:107], v27, s[4:7], s17 offen offset:384
    buffer_load_dwordx4 a[108:111], v27, s[4:7], s17 offen offset:448
    buffer_load_dwordx4 a[112:115], v27, s[4:7], s17 offen offset:512
    buffer_load_dwordx4 a[116:119], v27, s[4:7], s17 offen offset:576
    buffer_load_dwordx4 a[120:123], v27, s[4:7], s17 offen offset:640
    buffer_load_dwordx4 a[124:127], v27, s[4:7], s17 offen offset:704
    buffer_load_dwordx4 a[128:131], v27, s[4:7], s17 offen offset:768
    buffer_load_dwordx4 a[132:135], v27, s[4:7], s17 offen offset:832
    buffer_load_dwordx4 a[136:139], v27, s[4:7], s17 offen offset:896
    buffer_load_dwordx4 a[140:143], v27, s[4:7], s17 offen offset:960
    buffer_load_dwordx4 a[144:147], v27, s[4:7], s17 offen offset:1024
    buffer_load_dwordx4 a[148:151], v27, s[4:7], s17 offen offset:1088
    buffer_load_dwordx4 a[152:155], v27, s[4:7], s17 offen offset:1152
    buffer_load_dwordx4 a[156:159], v27, s[4:7], s17 offen offset:1216
    s_add_u32 s17, s16, 40960
    buffer_load_dwordx4 a[160:163], v27, s[4:7], s17 offen offset:0
    buffer_load_dwordx4 a[164:167], v27, s[4:7], s17 offen offset:64
    buffer_load_dwordx4 a[168:171], v27, s[4:7], s17 offen offset:128
    buffer_load_dwordx4 a[172:175], v27, s[4:7], s17 offen offset:192
    buffer_load_dwordx4 a[176:179], v27, s[4:7], s17 offen offset:256
    buffer_load_dwordx4 a[180:183], v27, s[4:7], s17 offen offset:320
    buffer_load_dwordx4 a[184:187], v27, s[4:7], s17 offen offset:384
    buffer_load_dwordx4 a[188:191], v27, s[4:7], s17 offen offset:448
    buffer_load_dwordx4 a[192:195], v27, s[4:7], s17 offen offset:512
    buffer_load_dwordx4 a[196:199], v27, s[4:7], s17 offen offset:576
    buffer_load_dwordx4 a[200:203], v27, s[4:7], s17 offen offset:640
    buffer_load_dwordx4 a[204:207], v27, s[4:7], s17 offen offset:704
    buffer_load_dwordx4 a[208:211], v27, s[4:7], s17 offen offset:768
    buffer_load_dwordx4 a[212:215], v27, s[4:7], s17 offen offset:832
    buffer_load_dwordx4 a[216:219], v27, s[4:7], s17 offen offset:896
    buffer_load_dwordx4 a[220:223], v27, s[4:7], s17 offen offset:960
    buffer_load_dwordx4 a[224:227], v27, s[4:7], s17 offen offset:1024
    buffer_load_dwordx4 a[228:231], v27, s[4:7], s17 offen offset:1088
    buffer_load_dwordx4 a[232:235], v27, s[4:7], s17 offen offset:1152
    buffer_load_dwordx4 a[236:239], v27, s[4:7], s17 offen offset:1216
    s_add_u32 s17, s16, 61440
    buffer_load_dwordx4 a[240:243], v27, s[4:7], s17 offen offset:0
    buffer_load_dwordx4 a[244:247], v27, s[4:7], s17 offen offset:64
    buffer_load_dwordx4 a[248:251], v27, s[4:7], s17 offen offset:128
    buffer_load_dwordx4 a[252:255], v27, s[4:7], s17 offen offset:192
    buffer_load_dwordx4 v[160:163], v27, s[4:7], s17 offen offset:256
    buffer_load_dwordx4 v[164:167], v27, s[4:7], s17 offen offset:320
    buffer_load_dwordx4 v[168:171], v27, s[4:7], s17 offen offset:384
    buffer_load_dwordx4 v[172:175], v27, s[4:7], s17 offen offset:448
    buffer_load_dwordx4 v[176:179], v27, s[4:7], s17 offen offset:512
    buffer_load_dwordx4 v[180:183], v27, s[4:7], s17 offen offset:576
    buffer_load_dwordx4 v[184:187], v27, s[4:7], s17 offen offset:640
    buffer_load_dwordx4 v[188:191], v27, s[4:7], s17 offen offset:704
    buffer_load_dwordx4 v[192:195], v27, s[4:7], s17 offen offset:768
    buffer_load_dwordx4 v[196:199], v27, s[4:7], s17 offen offset:832
    buffer_load_dwordx4 v[200:203], v27, s[4:7], s17 offen offset:896
    buffer_load_dwordx4 v[204:207], v27, s[4:7], s17 offen offset:960
    buffer_load_dwordx4 v[208:211], v27, s[4:7], s17 offen offset:1024
    buffer_load_dwordx4 v[212:215], v27, s[4:7], s17 offen offset:1088
    buffer_load_dwordx4 v[216:219], v27, s[4:7], s17 offen offset:1152
    buffer_load_dwordx4 v[220:223], v27, s[4:7], s17 offen offset:1216
    v_add_u32 v28, 0, v0
    v_mul_u32_u24 v29, 3277, v28
    v_lshrrev_b32 v29, 18, v29
    v_mul_u32_u24 v30, 80, v29
    v_sub_u32 v30, v28, v30
    v_lshlrev_b32 v30, 4, v30
    v_mul_u32_u24 v4, 1280, v29
    v_add_u32 v4, v4, v30
    v_mul_u32_u24 v14, 1312, v29
    v_add_u32 v14, v14, v30
    v_add_u32 v28, 256, v0
    v_mul_u32_u24 v29, 3277, v28
    v_lshrrev_b32 v29, 18, v29
    v_mul_u32_u24 v30, 80, v29
    v_sub_u32 v30, v28, v30
    v_lshlrev_b32 v30, 4, v30
    v_mul_u32_u24 v5, 1280, v29
    v_add_u32 v5, v5, v30
    v_mul_u32_u24 v15, 1312, v29
    v_add_u32 v15, v15, v30
    v_add_u32 v28, 512, v0
    v_mul_u32_u24 v29, 3277, v28
    v_lshrrev_b32 v29, 18, v29
    v_mul_u32_u24 v30, 80, v29
    v_sub_u32 v30, v28, v30
    v_lshlrev_b32 v30, 4, v30
    v_mul_u32_u24 v6, 1280, v29
    v_add_u32 v6, v6, v30
    v_mul_u32_u24 v16, 1312, v29
    v_add_u32 v16, v16, v30
    v_add_u32 v28, 768, v0
    v_mul_u32_u24 v29, 3277, v28
    v_lshrrev_b32 v29, 18, v29
    v_mul_u32_u24 v30, 80, v29
    v_sub_u32 v30, v28, v30
    v_lshlrev_b32 v30, 4, v30
    v_mul_u32_u24 v7, 1280, v29
    v_add_u32 v7, v7, v30
    v_mul_u32_u24 v17, 1312, v29
    v_add_u32 v17, v17, v30
    v_add_u32 v28, 1024, v0
    v_mul_u32_u24 v29, 3277, v28
    v_lshrrev_b32 v29, 18, v29
    v_mul_u32_u24 v30, 80, v29
    v_sub_u32 v30, v28, v30
    v_lshlrev_b32 v30, 4, v30
    v_mul_u32_u24 v8, 1280, v29
    v_add_u32 v8, v8, v30
    v_mul_u32_u24 v18, 1312, v29
    v_add_u32 v18, v18, v30
    v_add_u32 v28, 1280, v0
    v_mul_u32_u24 v29, 3277, v28
    v_lshrrev_b32 v29, 18, v29
    v_mul_u32_u24 v30, 80, v29
    v_sub_u32 v30, v28, v30
    v_lshlrev_b32 v30, 4, v30
    v_mul_u32_u24 v9, 1280, v29
    v_add_u32 v9, v9, v30
    v_mul_u32_u24 v19, 1312, v29
    v_add_u32 v19, v19, v30
    v_add_u32 v28, 1536, v0
    v_mul_u32_u24 v29, 3277, v28
    v_lshrrev_b32 v29, 18, v29
    v_mul_u32_u24 v30, 80, v29
    v_sub_u32 v30, v28, v30
    v_lshlrev_b32 v30, 4, v30
    v_mul_u32_u24 v10, 1280, v29
    v_add_u32 v10, v10, v30
    v_mul_u32_u24 v20, 1312, v29
    v_add_u32 v20, v20, v30
    v_add_u32 v28, 1792, v0
    v_mul_u32_u24 v29, 3277, v28
    v_lshrrev_b32 v29, 18, v29
    v_mul_u32_u24 v30, 80, v29
    v_sub_u32 v30, v28, v30
    v_lshlrev_b32 v30, 4, v30
    v_mul_u32_u24 v11, 1280, v29
    v_add_u32 v11, v11, v30
    v_mul_u32_u24 v21, 1312, v29
    v_add_u32 v21, v21, v30
    v_add_u32 v28, 2048, v0
    v_mul_u32_u24 v29, 3277, v28
    v_lshrrev_b32 v29, 18, v29
    v_mul_u32_u24 v30, 80, v29
    v_sub_u32 v30, v28, v30
    v_lshlrev_b32 v30, 4, v30
    v_mul_u32_u24 v12, 1280, v29
    v_add_u32 v12, v12, v30
    v_mul_u32_u24 v22, 1312, v29
    v_add_u32 v22, v22, v30
    v_add_u32 v28, 2304, v0
    v_mul_u32_u24 v29, 3277, v28
    v_lshrrev_b32 v29, 18, v29
    v_mul_u32_u24 v30, 80, v29
    v_sub_u32 v30, v28, v30
    v_lshlrev_b32 v30, 4, v30
    v_mul_u32_u24 v13, 1280, v29
    v_add_u32 v13, v13, v30
    v_mul_u32_u24 v23, 1312, v29
    v_add_u32 v23, v23, v30
    v_mul_u32_u24 v24, 1312, v1
    v_lshl_add_u32 v24, v2, 4, v24
    v_mul_u32_u24 v26, 36864, v1
    v_lshl_add_u32 v26, v3, 7, v26
    v_and_b32 v28, 1, v2
    v_lshl_add_u32 v26, v28, 5, v26
    v_lshrrev_b32 v28, 1, v2
    v_lshl_add_u32 v26, v28, 4, v26
    s_lshl_b32 s24, s54, 9
    s_add_u32 s24, s24, 39976960
    s_mov_b32 s20, s55
    s_mov_b32 s21, s56
    s_mul_i32 s23, s20, 40960
    s_add_u32 s23, s23, 0
    buffer_load_dwordx4 v[112:115], v4, s[4:7], s23 offen
    buffer_load_dwordx4 v[116:119], v5, s[4:7], s23 offen
    buffer_load_dwordx4 v[120:123], v6, s[4:7], s23 offen
    buffer_load_dwordx4 v[124:127], v7, s[4:7], s23 offen
    buffer_load_dwordx4 v[128:131], v8, s[4:7], s23 offen
    buffer_load_dwordx4 v[132:135], v9, s[4:7], s23 offen
    buffer_load_dwordx4 v[136:139], v10, s[4:7], s23 offen
    buffer_load_dwordx4 v[140:143], v11, s[4:7], s23 offen
    buffer_load_dwordx4 v[144:147], v12, s[4:7], s23 offen
    buffer_load_dwordx4 v[148:151], v13, s[4:7], s23 offen
    s_waitcnt vmcnt(0)
    s_mov_b32 s25, 0
    v_add_u32 v36, s25, v14
    v_add_u32 v37, s25, v15
    v_add_u32 v38, s25, v16
    v_add_u32 v39, s25, v17
    v_add_u32 v40, s25, v18
    v_add_u32 v41, s25, v19
    v_add_u32 v42, s25, v20
    v_add_u32 v43, s25, v21
    v_add_u32 v44, s25, v22
    v_add_u32 v45, s25, v23
    ds_write_b128 v36, v[112:115]
    ds_write_b128 v37, v[116:119]
    ds_write_b128 v38, v[120:123]
    ds_write_b128 v39, v[124:127]
    ds_write_b128 v40, v[128:131]
    ds_write_b128 v41, v[132:135]
    ds_write_b128 v42, v[136:139]
    ds_write_b128 v43, v[140:143]
    ds_write_b128 v44, v[144:147]
    ds_write_b128 v45, v[148:151]
    s_add_u32 s26, s20, 1
    s_mul_i32 s23, s26, 40960
    s_add_u32 s23, s23, 0
    buffer_load_dwordx4 v[112:115], v4, s[4:7], s23 offen
    buffer_load_dwordx4 v[116:119], v5, s[4:7], s23 offen
    buffer_load_dwordx4 v[120:123], v6, s[4:7], s23 offen
    buffer_load_dwordx4 v[124:127], v7, s[4:7], s23 offen
    buffer_load_dwordx4 v[128:131], v8, s[4:7], s23 offen
    buffer_load_dwordx4 v[132:135], v9, s[4:7], s23 offen
    buffer_load_dwordx4 v[136:139], v10, s[4:7], s23 offen
    buffer_load_dwordx4 v[140:143], v11, s[4:7], s23 offen
    buffer_load_dwordx4 v[144:147], v12, s[4:7], s23 offen
    buffer_load_dwordx4 v[148:151], v13, s[4:7], s23 offen
    s_waitcnt vmcnt(0)
    s_mov_b32 s25, 41984
    v_add_u32 v36, s25, v14
    v_add_u32 v37, s25, v15
    v_add_u32 v38, s25, v16
    v_add_u32 v39, s25, v17
    v_add_u32 v40, s25, v18
    v_add_u32 v41, s25, v19
    v_add_u32 v42, s25, v20
    v_add_u32 v43, s25, v21
    v_add_u32 v44, s25, v22
    v_add_u32 v45, s25, v23
    ds_write_b128 v36, v[112:115]
    ds_write_b128 v37, v[116:119]
    ds_write_b128 v38, v[120:123]
    ds_write_b128 v39, v[124:127]
    ds_write_b128 v40, v[128:131]
    ds_write_b128 v41, v[132:135]
    ds_write_b128 v42, v[136:139]
    ds_write_b128 v43, v[140:143]
    ds_write_b128 v44, v[144:147]
    ds_write_b128 v45, v[148:151]
    s_waitcnt lgkmcnt(0)
    s_barrier
    s_mov_b32 s22, 0
wk_wsjob_loop:
    s_add_u32 s26, s20, 2
    s_min_u32 s26, s26, 63
    s_mul_i32 s23, s26, 40960
    s_add_u32 s23, s23, 0
    buffer_load_dwordx4 v[112:115], v4, s[4:7], s23 offen
    buffer_load_dwordx4 v[116:119], v5, s[4:7], s23 offen
    buffer_load_dwordx4 v[120:123], v6, s[4:7], s23 offen
    buffer_load_dwordx4 v[124:127], v7, s[4:7], s23 offen
    buffer_load_dwordx4 v[128:131], v8, s[4:7], s23 offen
    buffer_load_dwordx4 v[132:135], v9, s[4:7], s23 offen
    buffer_load_dwordx4 v[136:139], v10, s[4:7], s23 offen
    buffer_load_dwordx4 v[140:143], v11, s[4:7], s23 offen
    buffer_load_dwordx4 v[144:147], v12, s[4:7], s23 offen
    buffer_load_dwordx4 v[148:151], v13, s[4:7], s23 offen
    v_add_u32 v25, s22, v24
    v_mov_b32 v48, 0
    v_mov_b32 v49, 0
    v_mov_b32 v50, 0
    v_mov_b32 v51, 0
    v_mov_b32 v52, 0
    v_mov_b32 v53, 0
    v_mov_b32 v54, 0
    v_mov_b32 v55, 0
    v_mov_b32 v56, 0
    v_mov_b32 v57, 0
    v_mov_b32 v58, 0
    v_mov_b32 v59, 0
    v_mov_b32 v60, 0
    v_mov_b32 v61, 0
    v_mov_b32 v62, 0
    v_mov_b32 v63, 0
    v_mov_b32 v64, 0
    v_mov_b32 v65, 0
    v_mov_b32 v66, 0
    v_mov_b32 v67, 0
    v_mov_b32 v68, 0
    v_mov_b32 v69, 0
    v_mov_b32 v70, 0
    v_mov_b32 v71, 0
    v_mov_b32 v72, 0
    v_mov_b32 v73, 0
    v_mov_b32 v74, 0
    v_mov_b32 v75, 0
    v_mov_b32 v76, 0
    v_mov_b32 v77, 0
    v_mov_b32 v78, 0
    v_mov_b32 v79, 0
    ds_read_b128 v[80:83], v25 offset:0
    ds_read_b128 v[84:87], v25 offset:20992
    ds_read_b128 v[88:91], v25 offset:64
    ds_read_b128 v[92:95], v25 offset:21056
    ds_read_b128 v[96:99], v25 offset:128
    ds_read_b128 v[100:103], v25 offset:21120
    ds_read_b128 v[104:107], v25 offset:192
    ds_read_b128 v[108:111], v25 offset:21184
    s_waitcnt lgkmcnt(6)
    v_mfma_f32_16x16x32_bf16 v[48:51], a[0:3], v[80:83], v[48:51]
    v_mfma_f32_16x16x32_bf16 v[52:55], a[0:3], v[84:87], v[52:55]
    v_mfma_f32_16x16x32_bf16 v[56:59], a[80:83], v[80:83], v[56:59]
    v_mfma_f32_16x16x32_bf16 v[60:63], a[80:83], v[84:87], v[60:63]
    v_mfma_f32_16x16x32_bf16 v[64:67], a[160:163], v[80:83], v[64:67]
    v_mfma_f32_16x16x32_bf16 v[68:71], a[160:163], v[84:87], v[68:71]
    v_mfma_f32_16x16x32_bf16 v[72:75], a[240:243], v[80:83], v[72:75]
    v_mfma_f32_16x16x32_bf16 v[76:79], a[240:243], v[84:87], v[76:79]
    ds_read_b128 v[80:83], v25 offset:256
    ds_read_b128 v[84:87], v25 offset:21248
    s_waitcnt lgkmcnt(6)
    v_mfma_f32_16x16x32_bf16 v[48:51], a[4:7], v[88:91], v[48:51]
    v_mfma_f32_16x16x32_bf16 v[52:55], a[4:7], v[92:95], v[52:55]
    v_mfma_f32_16x16x32_bf16 v[56:59], a[84:87], v[88:91], v[56:59]
    v_mfma_f32_16x16x32_bf16 v[60:63], a[84:87], v[92:95], v[60:63]
    v_mfma_f32_16x16x32_bf16 v[64:67], a[164:167], v[88:91], v[64:67]
    v_mfma_f32_16x16x32_bf16 v[68:71], a[164:167], v[92:95], v[68:71]
    v_mfma_f32_16x16x32_bf16 v[72:75], a[244:247], v[88:91], v[72:75]
    v_mfma_f32_16x16x32_bf16 v[76:79], a[244:247], v[92:95], v[76:79]
    ds_read_b128 v[88:91], v25 offset:320
    ds_read_b128 v[92:95], v25 offset:21312
    s_waitcnt lgkmcnt(6)
    v_mfma_f32_16x16x32_bf16 v[48:51], a[8:11], v[96:99], v[48:51]
    v_mfma_f32_16x16x32_bf16 v[52:55], a[8:11], v[100:103], v[52:55]
    v_mfma_f32_16x16x32_bf16 v[56:59], a[88:91], v[96:99], v[56:59]
    v_mfma_f32_16x16x32_bf16 v[60:63], a[88:91], v[100:103], v[60:63]
    v_mfma_f32_16x16x32_bf16 v[64:67], a[168:171], v[96:99], v[64:67]
    v_mfma_f32_16x16x32_bf16 v[68:71], a[168:171], v[100:103], v[68:71]
    v_mfma_f32_16x16x32_bf16 v[72:75], a[248:251], v[96:99], v[72:75]
    v_mfma_f32_16x16x32_bf16 v[76:79], a[248:251], v[100:103], v[76:79]
    ds_read_b128 v[96:99], v25 offset:384
    ds_read_b128 v[100:103], v25 offset:21376
    s_waitcnt lgkmcnt(6)
    v_mfma_f32_16x16x32_bf16 v[48:51], a[12:15], v[104:107], v[48:51]
    v_mfma_f32_16x16x32_bf16 v[52:55], a[12:15], v[108:111], v[52:55]
    v_mfma_f32_16x16x32_bf16 v[56:59], a[92:95], v[104:107], v[56:59]
    v_mfma_f32_16x16x32_bf16 v[60:63], a[92:95], v[108:111], v[60:63]
    v_mfma_f32_16x16x32_bf16 v[64:67], a[172:175], v[104:107], v[64:67]
    v_mfma_f32_16x16x32_bf16 v[68:71], a[172:175], v[108:111], v[68:71]
    v_mfma_f32_16x16x32_bf16 v[72:75], a[252:255], v[104:107], v[72:75]
    v_mfma_f32_16x16x32_bf16 v[76:79], a[252:255], v[108:111], v[76:79]
    ds_read_b128 v[104:107], v25 offset:448
    ds_read_b128 v[108:111], v25 offset:21440
    s_waitcnt lgkmcnt(6)
    v_mfma_f32_16x16x32_bf16 v[48:51], a[16:19], v[80:83], v[48:51]
    v_mfma_f32_16x16x32_bf16 v[52:55], a[16:19], v[84:87], v[52:55]
    v_mfma_f32_16x16x32_bf16 v[56:59], a[96:99], v[80:83], v[56:59]
    v_mfma_f32_16x16x32_bf16 v[60:63], a[96:99], v[84:87], v[60:63]
    v_mfma_f32_16x16x32_bf16 v[64:67], a[176:179], v[80:83], v[64:67]
    v_mfma_f32_16x16x32_bf16 v[68:71], a[176:179], v[84:87], v[68:71]
    v_mfma_f32_16x16x32_bf16 v[72:75], v[160:163], v[80:83], v[72:75]
    v_mfma_f32_16x16x32_bf16 v[76:79], v[160:163], v[84:87], v[76:79]
    ds_read_b128 v[80:83], v25 offset:512
    ds_read_b128 v[84:87], v25 offset:21504
    s_waitcnt lgkmcnt(6)
    v_mfma_f32_16x16x32_bf16 v[48:51], a[20:23], v[88:91], v[48:51]
    v_mfma_f32_16x16x32_bf16 v[52:55], a[20:23], v[92:95], v[52:55]
    v_mfma_f32_16x16x32_bf16 v[56:59], a[100:103], v[88:91], v[56:59]
    v_mfma_f32_16x16x32_bf16 v[60:63], a[100:103], v[92:95], v[60:63]
    v_mfma_f32_16x16x32_bf16 v[64:67], a[180:183], v[88:91], v[64:67]
    v_mfma_f32_16x16x32_bf16 v[68:71], a[180:183], v[92:95], v[68:71]
    v_mfma_f32_16x16x32_bf16 v[72:75], v[164:167], v[88:91], v[72:75]
    v_mfma_f32_16x16x32_bf16 v[76:79], v[164:167], v[92:95], v[76:79]
    ds_read_b128 v[88:91], v25 offset:576
    ds_read_b128 v[92:95], v25 offset:21568
    s_waitcnt lgkmcnt(6)
    v_mfma_f32_16x16x32_bf16 v[48:51], a[24:27], v[96:99], v[48:51]
    v_mfma_f32_16x16x32_bf16 v[52:55], a[24:27], v[100:103], v[52:55]
    v_mfma_f32_16x16x32_bf16 v[56:59], a[104:107], v[96:99], v[56:59]
    v_mfma_f32_16x16x32_bf16 v[60:63], a[104:107], v[100:103], v[60:63]
    v_mfma_f32_16x16x32_bf16 v[64:67], a[184:187], v[96:99], v[64:67]
    v_mfma_f32_16x16x32_bf16 v[68:71], a[184:187], v[100:103], v[68:71]
    v_mfma_f32_16x16x32_bf16 v[72:75], v[168:171], v[96:99], v[72:75]
    v_mfma_f32_16x16x32_bf16 v[76:79], v[168:171], v[100:103], v[76:79]
    ds_read_b128 v[96:99], v25 offset:640
    ds_read_b128 v[100:103], v25 offset:21632
    s_waitcnt lgkmcnt(6)
    v_mfma_f32_16x16x32_bf16 v[48:51], a[28:31], v[104:107], v[48:51]
    v_mfma_f32_16x16x32_bf16 v[52:55], a[28:31], v[108:111], v[52:55]
    v_mfma_f32_16x16x32_bf16 v[56:59], a[108:111], v[104:107], v[56:59]
    v_mfma_f32_16x16x32_bf16 v[60:63], a[108:111], v[108:111], v[60:63]
    v_mfma_f32_16x16x32_bf16 v[64:67], a[188:191], v[104:107], v[64:67]
    v_mfma_f32_16x16x32_bf16 v[68:71], a[188:191], v[108:111], v[68:71]
    v_mfma_f32_16x16x32_bf16 v[72:75], v[172:175], v[104:107], v[72:75]
    v_mfma_f32_16x16x32_bf16 v[76:79], v[172:175], v[108:111], v[76:79]
    ds_read_b128 v[104:107], v25 offset:704
    ds_read_b128 v[108:111], v25 offset:21696
    s_waitcnt lgkmcnt(6)
    v_mfma_f32_16x16x32_bf16 v[48:51], a[32:35], v[80:83], v[48:51]
    v_mfma_f32_16x16x32_bf16 v[52:55], a[32:35], v[84:87], v[52:55]
    v_mfma_f32_16x16x32_bf16 v[56:59], a[112:115], v[80:83], v[56:59]
    v_mfma_f32_16x16x32_bf16 v[60:63], a[112:115], v[84:87], v[60:63]
    v_mfma_f32_16x16x32_bf16 v[64:67], a[192:195], v[80:83], v[64:67]
    v_mfma_f32_16x16x32_bf16 v[68:71], a[192:195], v[84:87], v[68:71]
    v_mfma_f32_16x16x32_bf16 v[72:75], v[176:179], v[80:83], v[72:75]
    v_mfma_f32_16x16x32_bf16 v[76:79], v[176:179], v[84:87], v[76:79]
    ds_read_b128 v[80:83], v25 offset:768
    ds_read_b128 v[84:87], v25 offset:21760
    s_waitcnt lgkmcnt(6)
    v_mfma_f32_16x16x32_bf16 v[48:51], a[36:39], v[88:91], v[48:51]
    v_mfma_f32_16x16x32_bf16 v[52:55], a[36:39], v[92:95], v[52:55]
    v_mfma_f32_16x16x32_bf16 v[56:59], a[116:119], v[88:91], v[56:59]
    v_mfma_f32_16x16x32_bf16 v[60:63], a[116:119], v[92:95], v[60:63]
    v_mfma_f32_16x16x32_bf16 v[64:67], a[196:199], v[88:91], v[64:67]
    v_mfma_f32_16x16x32_bf16 v[68:71], a[196:199], v[92:95], v[68:71]
    v_mfma_f32_16x16x32_bf16 v[72:75], v[180:183], v[88:91], v[72:75]
    v_mfma_f32_16x16x32_bf16 v[76:79], v[180:183], v[92:95], v[76:79]
    ds_read_b128 v[88:91], v25 offset:832
    ds_read_b128 v[92:95], v25 offset:21824
    s_waitcnt lgkmcnt(6)
    v_mfma_f32_16x16x32_bf16 v[48:51], a[40:43], v[96:99], v[48:51]
    v_mfma_f32_16x16x32_bf16 v[52:55], a[40:43], v[100:103], v[52:55]
    v_mfma_f32_16x16x32_bf16 v[56:59], a[120:123], v[96:99], v[56:59]
    v_mfma_f32_16x16x32_bf16 v[60:63], a[120:123], v[100:103], v[60:63]
    v_mfma_f32_16x16x32_bf16 v[64:67], a[200:203], v[96:99], v[64:67]
    v_mfma_f32_16x16x32_bf16 v[68:71], a[200:203], v[100:103], v[68:71]
    v_mfma_f32_16x16x32_bf16 v[72:75], v[184:187], v[96:99], v[72:75]
    v_mfma_f32_16x16x32_bf16 v[76:79], v[184:187], v[100:103], v[76:79]
    ds_read_b128 v[96:99], v25 offset:896
    ds_read_b128 v[100:103], v25 offset:21888
    s_waitcnt lgkmcnt(6)
    v_mfma_f32_16x16x32_bf16 v[48:51], a[44:47], v[104:107], v[48:51]
    v_mfma_f32_16x16x32_bf16 v[52:55], a[44:47], v[108:111], v[52:55]
    v_mfma_f32_16x16x32_bf16 v[56:59], a[124:127], v[104:107], v[56:59]
    v_mfma_f32_16x16x32_bf16 v[60:63], a[124:127], v[108:111], v[60:63]
    v_mfma_f32_16x16x32_bf16 v[64:67], a[204:207], v[104:107], v[64:67]
    v_mfma_f32_16x16x32_bf16 v[68:71], a[204:207], v[108:111], v[68:71]
    v_mfma_f32_16x16x32_bf16 v[72:75], v[188:191], v[104:107], v[72:75]
    v_mfma_f32_16x16x32_bf16 v[76:79], v[188:191], v[108:111], v[76:79]
    ds_read_b128 v[104:107], v25 offset:960
    ds_read_b128 v[108:111], v25 offset:21952
    s_waitcnt lgkmcnt(6)
    v_mfma_f32_16x16x32_bf16 v[48:51], a[48:51], v[80:83], v[48:51]
    v_mfma_f32_16x16x32_bf16 v[52:55], a[48:51], v[84:87], v[52:55]
    v_mfma_f32_16x16x32_bf16 v[56:59], a[128:131], v[80:83], v[56:59]
    v_mfma_f32_16x16x32_bf16 v[60:63], a[128:131], v[84:87], v[60:63]
    v_mfma_f32_16x16x32_bf16 v[64:67], a[208:211], v[80:83], v[64:67]
    v_mfma_f32_16x16x32_bf16 v[68:71], a[208:211], v[84:87], v[68:71]
    v_mfma_f32_16x16x32_bf16 v[72:75], v[192:195], v[80:83], v[72:75]
    v_mfma_f32_16x16x32_bf16 v[76:79], v[192:195], v[84:87], v[76:79]
    ds_read_b128 v[80:83], v25 offset:1024
    ds_read_b128 v[84:87], v25 offset:22016
    s_waitcnt lgkmcnt(6)
    v_mfma_f32_16x16x32_bf16 v[48:51], a[52:55], v[88:91], v[48:51]
    v_mfma_f32_16x16x32_bf16 v[52:55], a[52:55], v[92:95], v[52:55]
    v_mfma_f32_16x16x32_bf16 v[56:59], a[132:135], v[88:91], v[56:59]
    v_mfma_f32_16x16x32_bf16 v[60:63], a[132:135], v[92:95], v[60:63]
    v_mfma_f32_16x16x32_bf16 v[64:67], a[212:215], v[88:91], v[64:67]
    v_mfma_f32_16x16x32_bf16 v[68:71], a[212:215], v[92:95], v[68:71]
    v_mfma_f32_16x16x32_bf16 v[72:75], v[196:199], v[88:91], v[72:75]
    v_mfma_f32_16x16x32_bf16 v[76:79], v[196:199], v[92:95], v[76:79]
    ds_read_b128 v[88:91], v25 offset:1088
    ds_read_b128 v[92:95], v25 offset:22080
    s_waitcnt lgkmcnt(6)
    v_mfma_f32_16x16x32_bf16 v[48:51], a[56:59], v[96:99], v[48:51]
    v_mfma_f32_16x16x32_bf16 v[52:55], a[56:59], v[100:103], v[52:55]
    v_mfma_f32_16x16x32_bf16 v[56:59], a[136:139], v[96:99], v[56:59]
    v_mfma_f32_16x16x32_bf16 v[60:63], a[136:139], v[100:103], v[60:63]
    v_mfma_f32_16x16x32_bf16 v[64:67], a[216:219], v[96:99], v[64:67]
    v_mfma_f32_16x16x32_bf16 v[68:71], a[216:219], v[100:103], v[68:71]
    v_mfma_f32_16x16x32_bf16 v[72:75], v[200:203], v[96:99], v[72:75]
    v_mfma_f32_16x16x32_bf16 v[76:79], v[200:203], v[100:103], v[76:79]
    ds_read_b128 v[96:99], v25 offset:1152
    ds_read_b128 v[100:103], v25 offset:22144
    s_waitcnt lgkmcnt(6)
    v_mfma_f32_16x16x32_bf16 v[48:51], a[60:63], v[104:107], v[48:51]
    v_mfma_f32_16x16x32_bf16 v[52:55], a[60:63], v[108:111], v[52:55]
    v_mfma_f32_16x16x32_bf16 v[56:59], a[140:143], v[104:107], v[56:59]
    v_mfma_f32_16x16x32_bf16 v[60:63], a[140:143], v[108:111], v[60:63]
    v_mfma_f32_16x16x32_bf16 v[64:67], a[220:223], v[104:107], v[64:67]
    v_mfma_f32_16x16x32_bf16 v[68:71], a[220:223], v[108:111], v[68:71]
    v_mfma_f32_16x16x32_bf16 v[72:75], v[204:207], v[104:107], v[72:75]
    v_mfma_f32_16x16x32_bf16 v[76:79], v[204:207], v[108:111], v[76:79]
    ds_read_b128 v[104:107], v25 offset:1216
    ds_read_b128 v[108:111], v25 offset:22208
    s_waitcnt lgkmcnt(6)
    v_mfma_f32_16x16x32_bf16 v[48:51], a[64:67], v[80:83], v[48:51]
    v_mfma_f32_16x16x32_bf16 v[52:55], a[64:67], v[84:87], v[52:55]
    v_mfma_f32_16x16x32_bf16 v[56:59], a[144:147], v[80:83], v[56:59]
    v_mfma_f32_16x16x32_bf16 v[60:63], a[144:147], v[84:87], v[60:63]
    v_mfma_f32_16x16x32_bf16 v[64:67], a[224:227], v[80:83], v[64:67]
    v_mfma_f32_16x16x32_bf16 v[68:71], a[224:227], v[84:87], v[68:71]
    v_mfma_f32_16x16x32_bf16 v[72:75], v[208:211], v[80:83], v[72:75]
    v_mfma_f32_16x16x32_bf16 v[76:79], v[208:211], v[84:87], v[76:79]
    s_waitcnt lgkmcnt(4)
    v_mfma_f32_16x16x32_bf16 v[48:51], a[68:71], v[88:91], v[48:51]
    v_mfma_f32_16x16x32_bf16 v[52:55], a[68:71], v[92:95], v[52:55]
    v_mfma_f32_16x16x32_bf16 v[56:59], a[148:151], v[88:91], v[56:59]
    v_mfma_f32_16x16x32_bf16 v[60:63], a[148:151], v[92:95], v[60:63]
    v_mfma_f32_16x16x32_bf16 v[64:67], a[228:231], v[88:91], v[64:67]
    v_mfma_f32_16x16x32_bf16 v[68:71], a[228:231], v[92:95], v[68:71]
    v_mfma_f32_16x16x32_bf16 v[72:75], v[212:215], v[88:91], v[72:75]
    v_mfma_f32_16x16x32_bf16 v[76:79], v[212:215], v[92:95], v[76:79]
    s_waitcnt lgkmcnt(2)
    v_mfma_f32_16x16x32_bf16 v[48:51], a[72:75], v[96:99], v[48:51]
    v_mfma_f32_16x16x32_bf16 v[52:55], a[72:75], v[100:103], v[52:55]
    v_mfma_f32_16x16x32_bf16 v[56:59], a[152:155], v[96:99], v[56:59]
    v_mfma_f32_16x16x32_bf16 v[60:63], a[152:155], v[100:103], v[60:63]
    v_mfma_f32_16x16x32_bf16 v[64:67], a[232:235], v[96:99], v[64:67]
    v_mfma_f32_16x16x32_bf16 v[68:71], a[232:235], v[100:103], v[68:71]
    v_mfma_f32_16x16x32_bf16 v[72:75], v[216:219], v[96:99], v[72:75]
    v_mfma_f32_16x16x32_bf16 v[76:79], v[216:219], v[100:103], v[76:79]
    s_waitcnt lgkmcnt(0)
    v_mfma_f32_16x16x32_bf16 v[48:51], a[76:79], v[104:107], v[48:51]
    v_mfma_f32_16x16x32_bf16 v[52:55], a[76:79], v[108:111], v[52:55]
    v_mfma_f32_16x16x32_bf16 v[56:59], a[156:159], v[104:107], v[56:59]
    v_mfma_f32_16x16x32_bf16 v[60:63], a[156:159], v[108:111], v[60:63]
    v_mfma_f32_16x16x32_bf16 v[64:67], a[236:239], v[104:107], v[64:67]
    v_mfma_f32_16x16x32_bf16 v[68:71], a[236:239], v[108:111], v[68:71]
    v_mfma_f32_16x16x32_bf16 v[72:75], v[220:223], v[104:107], v[72:75]
    v_mfma_f32_16x16x32_bf16 v[76:79], v[220:223], v[108:111], v[76:79]
    s_nop 7
    s_mul_i32 s23, s20, 1179648
    s_add_u32 s23, s23, s24
    s_add_u32 s27, s23, 589824
    v_cvt_pk_bf16_f32 v152, v48, v49
    v_cvt_pk_bf16_f32 v153, v50, v51
    v_cvt_pk_bf16_f32 v154, v56, v57
    v_cvt_pk_bf16_f32 v155, v58, v59
    s_nop 1
    v_permlane16_swap_b32 v152, v154
    v_permlane16_swap_b32 v153, v155
    s_nop 0
    buffer_store_dwordx4 v[152:155], v26, s[4:7], s23 offen offset:0 sc1
    v_cvt_pk_bf16_f32 v156, v64, v65
    v_cvt_pk_bf16_f32 v157, v66, v67
    v_cvt_pk_bf16_f32 v158, v72, v73
    v_cvt_pk_bf16_f32 v159, v74, v75
    s_nop 1
    v_permlane16_swap_b32 v156, v158
    v_permlane16_swap_b32 v157, v159
    s_nop 0
    buffer_store_dwordx4 v[156:159], v26, s[4:7], s23 offen offset:64 sc1
    v_cvt_pk_bf16_f32 v152, v52, v53
    v_cvt_pk_bf16_f32 v153, v54, v55
    v_cvt_pk_bf16_f32 v154, v60, v61
    v_cvt_pk_bf16_f32 v155, v62, v63
    s_nop 1
    v_permlane16_swap_b32 v152, v154
    v_permlane16_swap_b32 v153, v155
    s_nop 0
    buffer_store_dwordx4 v[152:155], v26, s[4:7], s27 offen offset:0 sc1
    v_cvt_pk_bf16_f32 v156, v68, v69
    v_cvt_pk_bf16_f32 v157, v70, v71
    v_cvt_pk_bf16_f32 v158, v76, v77
    v_cvt_pk_bf16_f32 v159, v78, v79
    s_nop 1
    v_permlane16_swap_b32 v156, v158
    v_permlane16_swap_b32 v157, v159
    s_nop 0
    buffer_store_dwordx4 v[156:159], v26, s[4:7], s27 offen offset:64 sc1
    s_add_u32 s25, s22, 83968
    s_cmp_ge_u32 s25, 125952
    s_cselect_b32 s26, 125952, 0
    s_sub_u32 s25, s25, s26
    s_waitcnt vmcnt(4)
    v_add_u32 v36, s25, v14
    v_add_u32 v37, s25, v15
    v_add_u32 v38, s25, v16
    v_add_u32 v39, s25, v17
    v_add_u32 v40, s25, v18
    v_add_u32 v41, s25, v19
    v_add_u32 v42, s25, v20
    v_add_u32 v43, s25, v21
    v_add_u32 v44, s25, v22
    v_add_u32 v45, s25, v23
    ds_write_b128 v36, v[112:115]
    ds_write_b128 v37, v[116:119]
    ds_write_b128 v38, v[120:123]
    ds_write_b128 v39, v[124:127]
    ds_write_b128 v40, v[128:131]
    ds_write_b128 v41, v[132:135]
    ds_write_b128 v42, v[136:139]
    ds_write_b128 v43, v[140:143]
    ds_write_b128 v44, v[144:147]
    ds_write_b128 v45, v[148:151]
    s_waitcnt lgkmcnt(0)
    s_barrier
    s_add_u32 s22, s22, 41984
    s_cmp_ge_u32 s22, 125952
    s_cselect_b32 s22, 0, s22
    s_add_u32 s20, s20, 1
    s_sub_u32 s21, s21, 1
    s_and_b32 s23, s20, 3
    s_cmp_eq_u32 s23, 0
    s_cbranch_scc1 wk_wsjob_sig
    s_cmp_gt_u32 s20, 4
    s_cbranch_scc1 wk_wsjob_nosig
wk_wsjob_sig:
    s_waitcnt vmcnt(0)
    s_barrier
    s_cmp_lg_u32 s52, 0
    s_cbranch_scc1 wk_wsjob_nosig
    s_mov_b64 exec, 1
    v_mov_b32 v28, 1
    s_cmp_gt_u32 s20, 4
    s_cbranch_scc1 wk_wsjob_sig2
    s_sub_u32 s23, s20, 1
    s_lshl_b32 s23, s23, 6
    s_add_u32 s23, s23, s67
    buffer_atomic_add v28, off, s[4:7], s23 sc1
wk_wsjob_sig2:
    s_and_b32 s23, s20, 3
    s_cmp_lg_u32 s23, 0
    s_cbranch_scc1 wk_wsjob_sig3
    s_lshr_b32 s23, s20, 2
    s_sub_u32 s23, s23, 1
    s_lshl_b32 s23, s23, 6
    s_add_u32 s23, s23, s57
    buffer_atomic_add v28, off, s[4:7], s23 sc1
wk_wsjob_sig3:
    s_mov_b64 exec, -1
wk_wsjob_nosig:
    s_cmp_lg_u32 s21, 0
    s_cbranch_scc1 wk_wsjob_loop
    s_branch wk_ws_done
wk_ws_done:
    s_mov_b32 s56, 0
    s_mov_b32 s53, 224350208
    s_branch wk_fin
wk_bjob:
    v_and_b32 v1, 15, v0
    v_bfe_u32 v2, v0, 4, 2
    v_lshrrev_b32 v3, 6, v0
    s_mul_i32 s20, s16, 4718592
    s_mul_i32 s21, s18, 384
    s_add_u32 s20, s20, s21
    s_add_u32 s20, s20, 40001536
    v_add_u32 v31, 0, v0
    v_mul_u32_u24 v32, 2731, v31
    v_lshrrev_b32 v32, 16, v32
    v_mul_u32_u24 v33, 24, v32
    v_sub_u32 v33, v31, v33
    v_lshlrev_b32 v33, 4, v33
    v_mul_u32_u24 v4, 36864, v32
    v_add_u32 v4, v4, v33
    v_mul_u32_u24 v16, 416, v32
    v_add_u32 v16, v16, v33
    v_add_u32 v31, 256, v0
    v_mul_u32_u24 v32, 2731, v31
    v_lshrrev_b32 v32, 16, v32
    v_mul_u32_u24 v33, 24, v32
    v_sub_u32 v33, v31, v33
    v_lshlrev_b32 v33, 4, v33
    v_mul_u32_u24 v5, 36864, v32
    v_add_u32 v5, v5, v33
    v_mul_u32_u24 v17, 416, v32
    v_add_u32 v17, v17, v33
    v_add_u32 v31, 512, v0
    v_mul_u32_u24 v32, 2731, v31
    v_lshrrev_b32 v32, 16, v32
    v_mul_u32_u24 v33, 24, v32
    v_sub_u32 v33, v31, v33
    v_lshlrev_b32 v33, 4, v33
    v_mul_u32_u24 v6, 36864, v32
    v_add_u32 v6, v6, v33
    v_mul_u32_u24 v18, 416, v32
    v_add_u32 v18, v18, v33
    v_add_u32 v31, 768, v0
    v_mul_u32_u24 v32, 2731, v31
    v_lshrrev_b32 v32, 16, v32
    v_mul_u32_u24 v33, 24, v32
    v_sub_u32 v33, v31, v33
    v_lshlrev_b32 v33, 4, v33
    v_mul_u32_u24 v7, 36864, v32
    v_add_u32 v7, v7, v33
    v_mul_u32_u24 v19, 416, v32
    v_add_u32 v19, v19, v33
    v_add_u32 v31, 1024, v0
    v_mul_u32_u24 v32, 2731, v31
    v_lshrrev_b32 v32, 16, v32
    v_mul_u32_u24 v33, 24, v32
    v_sub_u32 v33, v31, v33
    v_lshlrev_b32 v33, 4, v33
    v_mul_u32_u24 v8, 36864, v32
    v_add_u32 v8, v8, v33
    v_mul_u32_u24 v20, 416, v32
    v_add_u32 v20, v20, v33
    v_add_u32 v31, 1280, v0
    v_mul_u32_u24 v32, 2731, v31
    v_lshrrev_b32 v32, 16, v32
    v_mul_u32_u24 v33, 24, v32
    v_sub_u32 v33, v31, v33
    v_lshlrev_b32 v33, 4, v33
    v_mul_u32_u24 v9, 36864, v32
    v_add_u32 v9, v9, v33
    v_mul_u32_u24 v21, 416, v32
    v_add_u32 v21, v21, v33
    v_add_u32 v31, 1536, v0
    v_mul_u32_u24 v32, 2731, v31
    v_lshrrev_b32 v32, 16, v32
    v_mul_u32_u24 v33, 24, v32
    v_sub_u32 v33, v31, v33
    v_lshlrev_b32 v33, 4, v33
    v_mul_u32_u24 v10, 36864, v32
    v_add_u32 v10, v10, v33
    v_mul_u32_u24 v22, 416, v32
    v_add_u32 v22, v22, v33
    v_add_u32 v31, 1792, v0
    v_mul_u32_u24 v32, 2731, v31
    v_lshrrev_b32 v32, 16, v32
    v_mul_u32_u24 v33, 24, v32
    v_sub_u32 v33, v31, v33
    v_lshlrev_b32 v33, 4, v33
    v_mul_u32_u24 v11, 36864, v32
    v_add_u32 v11, v11, v33
    v_mul_u32_u24 v23, 416, v32
    v_add_u32 v23, v23, v33
    v_add_u32 v31, 2048, v0
    v_mul_u32_u24 v32, 2731, v31
    v_lshrrev_b32 v32, 16, v32
    v_mul_u32_u24 v33, 24, v32
    v_sub_u32 v33, v31, v33
    v_lshlrev_b32 v33, 4, v33
    v_mul_u32_u24 v12, 36864, v32
    v_add_u32 v12, v12, v33
    v_mul_u32_u24 v24, 416, v32
    v_add_u32 v24, v24, v33
    v_add_u32 v31, 2304, v0
    v_mul_u32_u24 v32, 2731, v31
    v_lshrrev_b32 v32, 16, v32
    v_mul_u32_u24 v33, 24, v32
    v_sub_u32 v33, v31, v33
    v_lshlrev_b32 v33, 4, v33
    v_mul_u32_u24 v13, 36864, v32
    v_add_u32 v13, v13, v33
    v_mul_u32_u24 v25, 416, v32
    v_add_u32 v25, v25, v33
    v_add_u32 v31, 2560, v0
    v_mul_u32_u24 v32, 2731, v31
    v_lshrrev_b32 v32, 16, v32
    v_mul_u32_u24 v33, 24, v32
    v_sub_u32 v33, v31, v33
    v_lshlrev_b32 v33, 4, v33
    v_mul_u32_u24 v14, 36864, v32
    v_add_u32 v14, v14, v33
    v_mul_u32_u24 v26, 416, v32
    v_add_u32 v26, v26, v33
    v_add_u32 v31, 2816, v0
    v_mul_u32_u24 v32, 2731, v31
    v_lshrrev_b32 v32, 16, v32
    v_mul_u32_u24 v33, 24, v32
    v_sub_u32 v33, v31, v33
    v_lshlrev_b32 v33, 4, v33
    v_mul_u32_u24 v15, 36864, v32
    v_add_u32 v15, v15, v33
    v_mul_u32_u24 v27, 416, v32
    v_add_u32 v27, v27, v33
    v_mul_u32_u24 v28, 416, v1
    v_lshl_add_u32 v28, v2, 4, v28
    v_mul_u32_u24 v31, 80, v3
    v_add_u32 v31, v31, v1
    v_mul_u32_u24 v29, 384, v31
    v_lshl_add_u32 v29, v2, 4, v29
    s_mul_i32 s21, s18, 245760
    s_add_u32 s21, s21, 26214400
    v_lshlrev_b32 v30, 6, v31
    v_and_b32 v32, 1, v2
    v_lshl_add_u32 v30, v32, 5, v30
    v_lshrrev_b32 v32, 1, v2
    v_lshl_add_u32 v30, v32, 4, v30
    s_lshl_b32 s22, s16, 7
    s_add_u32 s22, s22, s18
    s_mul_i32 s22, s22, 40960
    s_add_u32 s22, s22, 115474432
    s_mul_i32 s23, s19, 122880
    s_add_u32 s21, s21, s23
    s_mul_i32 s23, s19, 20480
    s_add_u32 s22, s22, s23
    s_add_u32 s23, s21, 0
    buffer_load_dwordx4 v[88:91], v29, s[4:7], s23 offen offset:0
    buffer_load_dwordx4 v[92:95], v29, s[4:7], s23 offen offset:64
    buffer_load_dwordx4 v[96:99], v29, s[4:7], s23 offen offset:128
    buffer_load_dwordx4 v[100:103], v29, s[4:7], s23 offen offset:192
    buffer_load_dwordx4 v[104:107], v29, s[4:7], s23 offen offset:256
    buffer_load_dwordx4 v[108:111], v29, s[4:7], s23 offen offset:320
    s_add_u32 s23, s21, 6144
    buffer_load_dwordx4 v[112:115], v29, s[4:7], s23 offen offset:0
    buffer_load_dwordx4 v[116:119], v29, s[4:7], s23 offen offset:64
    buffer_load_dwordx4 v[120:123], v29, s[4:7], s23 offen offset:128
    buffer_load_dwordx4 v[124:127], v29, s[4:7], s23 offen offset:192
    buffer_load_dwordx4 v[128:131], v29, s[4:7], s23 offen offset:256
    buffer_load_dwordx4 v[132:135], v29, s[4:7], s23 offen offset:320
    s_add_u32 s23, s21, 12288
    buffer_load_dwordx4 v[136:139], v29, s[4:7], s23 offen offset:0
    buffer_load_dwordx4 v[140:143], v29, s[4:7], s23 offen offset:64
    buffer_load_dwordx4 v[144:147], v29, s[4:7], s23 offen offset:128
    buffer_load_dwordx4 v[148:151], v29, s[4:7], s23 offen offset:192
    buffer_load_dwordx4 v[152:155], v29, s[4:7], s23 offen offset:256
    buffer_load_dwordx4 v[156:159], v29, s[4:7], s23 offen offset:320
    s_add_u32 s23, s21, 18432
    buffer_load_dwordx4 v[160:163], v29, s[4:7], s23 offen offset:0
    buffer_load_dwordx4 v[164:167], v29, s[4:7], s23 offen offset:64
    buffer_load_dwordx4 v[168:171], v29, s[4:7], s23 offen offset:128
    buffer_load_dwordx4 v[172:175], v29, s[4:7], s23 offen offset:192
    buffer_load_dwordx4 v[176:179], v29, s[4:7], s23 offen offset:256
    buffer_load_dwordx4 v[180:183], v29, s[4:7], s23 offen offset:320
    s_add_u32 s23, s21, 24576
    buffer_load_dwordx4 v[184:187], v29, s[4:7], s23 offen offset:0
    buffer_load_dwordx4 v[188:191], v29, s[4:7], s23 offen offset:64
    buffer_load_dwordx4 v[192:195], v29, s[4:7], s23 offen offset:128
    buffer_load_dwordx4 v[196:199], v29, s[4:7], s23 offen offset:192
    buffer_load_dwordx4 v[200:203], v29, s[4:7], s23 offen offset:256
    buffer_load_dwordx4 v[204:207], v29, s[4:7], s23 offen offset:320
    s_mov_b32 s36, 0
wk_waitv:
    buffer_load_dword v31, off, s[4:7], s66 sc1
    s_waitcnt vmcnt(0)
    v_readfirstlane_b32 s35, v31
    s_add_u32 s36, s36, 1
    s_cmp_ge_u32 s36, 262144
    s_cbranch_scc1 chain_done
    s_cmp_ge_u32 s35, 24
    s_cbranch_scc1 wk_waitv_ok
    s_sleep 16
    s_branch wk_waitv
wk_waitv_ok:
    buffer_load_dwordx4 v[40:43], v4, s[4:7], s20 offen sc1
    buffer_load_dwordx4 v[44:47], v5, s[4:7], s20 offen sc1
    buffer_load_dwordx4 v[48:51], v6, s[4:7], s20 offen sc1
    buffer_load_dwordx4 v[52:55], v7, s[4:7], s20 offen sc1
    buffer_load_dwordx4 v[56:59], v8, s[4:7], s20 offen sc1
    buffer_load_dwordx4 v[60:63], v9, s[4:7], s20 offen sc1
    buffer_load_dwordx4 v[64:67], v10, s[4:7], s20 offen sc1
    buffer_load_dwordx4 v[68:71], v11, s[4:7], s20 offen sc1
    buffer_load_dwordx4 v[72:75], v12, s[4:7], s20 offen sc1
    buffer_load_dwordx4 v[76:79], v13, s[4:7], s20 offen sc1
    buffer_load_dwordx4 v[80:83], v14, s[4:7], s20 offen sc1
    buffer_load_dwordx4 v[84:87], v15, s[4:7], s20 offen sc1
    s_waitcnt vmcnt(0)
    ds_write_b128 v16, v[40:43]
    ds_write_b128 v17, v[44:47]
    ds_write_b128 v18, v[48:51]
    ds_write_b128 v19, v[52:55]
    ds_write_b128 v20, v[56:59]
    ds_write_b128 v21, v[60:63]
    ds_write_b128 v22, v[64:67]
    ds_write_b128 v23, v[68:71]
    ds_write_b128 v24, v[72:75]
    ds_write_b128 v25, v[76:79]
    ds_write_b128 v26, v[80:83]
    ds_write_b128 v27, v[84:87]
    s_waitcnt lgkmcnt(0)
    s_barrier
    v_accvgpr_write_b32 a0, 0
    v_accvgpr_write_b32 a1, 0
    v_accvgpr_write_b32 a2, 0
    v_accvgpr_write_b32 a3, 0
    v_accvgpr_write_b32 a4, 0
    v_accvgpr_write_b32 a5, 0
    v_accvgpr_write_b32 a6, 0
    v_accvgpr_write_b32 a7, 0
    v_accvgpr_write_b32 a8, 0
    v_accvgpr_write_b32 a9, 0
    v_accvgpr_write_b32 a10, 0
    v_accvgpr_write_b32 a11, 0
    v_accvgpr_write_b32 a12, 0
    v_accvgpr_write_b32 a13, 0
    v_accvgpr_write_b32 a14, 0
    v_accvgpr_write_b32 a15, 0
    v_accvgpr_write_b32 a16, 0
    v_accvgpr_write_b32 a17, 0
    v_accvgpr_write_b32 a18, 0
    v_accvgpr_write_b32 a19, 0
    v_accvgpr_write_b32 a20, 0
    v_accvgpr_write_b32 a21, 0
    v_accvgpr_write_b32 a22, 0
    v_accvgpr_write_b32 a23, 0
    v_accvgpr_write_b32 a24, 0
    v_accvgpr_write_b32 a25, 0
    v_accvgpr_write_b32 a26, 0
    v_accvgpr_write_b32 a27, 0
    v_accvgpr_write_b32 a28, 0
    v_accvgpr_write_b32 a29, 0
    v_accvgpr_write_b32 a30, 0
    v_accvgpr_write_b32 a31, 0
    v_accvgpr_write_b32 a32, 0
    v_accvgpr_write_b32 a33, 0
    v_accvgpr_write_b32 a34, 0
    v_accvgpr_write_b32 a35, 0
    v_accvgpr_write_b32 a36, 0
    v_accvgpr_write_b32 a37, 0
    v_accvgpr_write_b32 a38, 0
    v_accvgpr_write_b32 a39, 0
    v_accvgpr_write_b32 a40, 0
    v_accvgpr_write_b32 a41, 0
    v_accvgpr_write_b32 a42, 0
    v_accvgpr_write_b32 a43, 0
    v_accvgpr_write_b32 a44, 0
    v_accvgpr_write_b32 a45, 0
    v_accvgpr_write_b32 a46, 0
    v_accvgpr_write_b32 a47, 0
    v_accvgpr_write_b32 a48, 0
    v_accvgpr_write_b32 a49, 0
    v_accvgpr_write_b32 a50, 0
    v_accvgpr_write_b32 a51, 0
    v_accvgpr_write_b32 a52, 0
    v_accvgpr_write_b32 a53, 0
    v_accvgpr_write_b32 a54, 0
    v_accvgpr_write_b32 a55, 0
    v_accvgpr_write_b32 a56, 0
    v_accvgpr_write_b32 a57, 0
    v_accvgpr_write_b32 a58, 0
    v_accvgpr_write_b32 a59, 0
    v_accvgpr_write_b32 a60, 0
    v_accvgpr_write_b32 a61, 0
    v_accvgpr_write_b32 a62, 0
    v_accvgpr_write_b32 a63, 0
    v_accvgpr_write_b32 a64, 0
    v_accvgpr_write_b32 a65, 0
    v_accvgpr_write_b32 a66, 0
    v_accvgpr_write_b32 a67, 0
    v_accvgpr_write_b32 a68, 0
    v_accvgpr_write_b32 a69, 0
    v_accvgpr_write_b32 a70, 0
    v_accvgpr_write_b32 a71, 0
    v_accvgpr_write_b32 a72, 0
    v_accvgpr_write_b32 a73, 0
    v_accvgpr_write_b32 a74, 0
    v_accvgpr_write_b32 a75, 0
    v_accvgpr_write_b32 a76, 0
    v_accvgpr_write_b32 a77, 0
    v_accvgpr_write_b32 a78, 0
    v_accvgpr_write_b32 a79, 0
    v_accvgpr_write_b32 a80, 0
    v_accvgpr_write_b32 a81, 0
    v_accvgpr_write_b32 a82, 0
    v_accvgpr_write_b32 a83, 0
    v_accvgpr_write_b32 a84, 0
    v_accvgpr_write_b32 a85, 0
    v_accvgpr_write_b32 a86, 0
    v_accvgpr_write_b32 a87, 0
    v_accvgpr_write_b32 a88, 0
    v_accvgpr_write_b32 a89, 0
    v_accvgpr_write_b32 a90, 0
    v_accvgpr_write_b32 a91, 0
    v_accvgpr_write_b32 a92, 0
    v_accvgpr_write_b32 a93, 0
    v_accvgpr_write_b32 a94, 0
    v_accvgpr_write_b32 a95, 0
    v_accvgpr_write_b32 a96, 0
    v_accvgpr_write_b32 a97, 0
    v_accvgpr_write_b32 a98, 0
    v_accvgpr_write_b32 a99, 0
    v_accvgpr_write_b32 a100, 0
    v_accvgpr_write_b32 a101, 0
    v_accvgpr_write_b32 a102, 0
    v_accvgpr_write_b32 a103, 0
    v_accvgpr_write_b32 a104, 0
    v_accvgpr_write_b32 a105, 0
    v_accvgpr_write_b32 a106, 0
    v_accvgpr_write_b32 a107, 0
    v_accvgpr_write_b32 a108, 0
    v_accvgpr_write_b32 a109, 0
    v_accvgpr_write_b32 a110, 0
    v_accvgpr_write_b32 a111, 0
    v_accvgpr_write_b32 a112, 0
    v_accvgpr_write_b32 a113, 0
    v_accvgpr_write_b32 a114, 0
    v_accvgpr_write_b32 a115, 0
    v_accvgpr_write_b32 a116, 0
    v_accvgpr_write_b32 a117, 0
    v_accvgpr_write_b32 a118, 0
    v_accvgpr_write_b32 a119, 0
    v_accvgpr_write_b32 a120, 0
    v_accvgpr_write_b32 a121, 0
    v_accvgpr_write_b32 a122, 0
    v_accvgpr_write_b32 a123, 0
    v_accvgpr_write_b32 a124, 0
    v_accvgpr_write_b32 a125, 0
    v_accvgpr_write_b32 a126, 0
    v_accvgpr_write_b32 a127, 0
    v_accvgpr_write_b32 a128, 0
    v_accvgpr_write_b32 a129, 0
    v_accvgpr_write_b32 a130, 0
    v_accvgpr_write_b32 a131, 0
    v_accvgpr_write_b32 a132, 0
    v_accvgpr_write_b32 a133, 0
    v_accvgpr_write_b32 a134, 0
    v_accvgpr_write_b32 a135, 0
    v_accvgpr_write_b32 a136, 0
    v_accvgpr_write_b32 a137, 0
    v_accvgpr_write_b32 a138, 0
    v_accvgpr_write_b32 a139, 0
    v_accvgpr_write_b32 a140, 0
    v_accvgpr_write_b32 a141, 0
    v_accvgpr_write_b32 a142, 0
    v_accvgpr_write_b32 a143, 0
    v_accvgpr_write_b32 a144, 0
    v_accvgpr_write_b32 a145, 0
    v_accvgpr_write_b32 a146, 0
    v_accvgpr_write_b32 a147, 0
    v_accvgpr_write_b32 a148, 0
    v_accvgpr_write_b32 a149, 0
    v_accvgpr_write_b32 a150, 0
    v_accvgpr_write_b32 a151, 0
    v_accvgpr_write_b32 a152, 0
    v_accvgpr_write_b32 a153, 0
    v_accvgpr_write_b32 a154, 0
    v_accvgpr_write_b32 a155, 0
    v_accvgpr_write_b32 a156, 0
    v_accvgpr_write_b32 a157, 0
    v_accvgpr_write_b32 a158, 0
    v_accvgpr_write_b32 a159, 0
    s_waitcnt vmcnt(0)
    ds_read_b128 v[40:43], v28 offset:0
    ds_read_b128 v[44:47], v28 offset:6656
    ds_read_b128 v[48:51], v28 offset:13312
    ds_read_b128 v[52:55], v28 offset:19968
    ds_read_b128 v[56:59], v28 offset:26624
    ds_read_b128 v[60:63], v28 offset:33280
    ds_read_b128 v[64:67], v28 offset:39936
    ds_read_b128 v[68:71], v28 offset:46592
    s_waitcnt lgkmcnt(7)
    v_mfma_f32_16x16x32_bf16 a[0:3], v[40:43], v[88:91], a[0:3]
    v_mfma_f32_16x16x32_bf16 a[4:7], v[40:43], v[112:115], a[4:7]
    v_mfma_f32_16x16x32_bf16 a[8:11], v[40:43], v[136:139], a[8:11]
    v_mfma_f32_16x16x32_bf16 a[12:15], v[40:43], v[160:163], a[12:15]
    v_mfma_f32_16x16x32_bf16 a[16:19], v[40:43], v[184:187], a[16:19]
    s_waitcnt lgkmcnt(6)
    v_mfma_f32_16x16x32_bf16 a[20:23], v[44:47], v[88:91], a[20:23]
    v_mfma_f32_16x16x32_bf16 a[24:27], v[44:47], v[112:115], a[24:27]
    v_mfma_f32_16x16x32_bf16 a[28:31], v[44:47], v[136:139], a[28:31]
    v_mfma_f32_16x16x32_bf16 a[32:35], v[44:47], v[160:163], a[32:35]
    v_mfma_f32_16x16x32_bf16 a[36:39], v[44:47], v[184:187], a[36:39]
    s_waitcnt lgkmcnt(5)
    v_mfma_f32_16x16x32_bf16 a[40:43], v[48:51], v[88:91], a[40:43]
    v_mfma_f32_16x16x32_bf16 a[44:47], v[48:51], v[112:115], a[44:47]
    v_mfma_f32_16x16x32_bf16 a[48:51], v[48:51], v[136:139], a[48:51]
    v_mfma_f32_16x16x32_bf16 a[52:55], v[48:51], v[160:163], a[52:55]
    v_mfma_f32_16x16x32_bf16 a[56:59], v[48:51], v[184:187], a[56:59]
    s_waitcnt lgkmcnt(4)
    v_mfma_f32_16x16x32_bf16 a[60:63], v[52:55], v[88:91], a[60:63]
    v_mfma_f32_16x16x32_bf16 a[64:67], v[52:55], v[112:115], a[64:67]
    v_mfma_f32_16x16x32_bf16 a[68:71], v[52:55], v[136:139], a[68:71]
    v_mfma_f32_16x16x32_bf16 a[72:75], v[52:55], v[160:163], a[72:75]
    v_mfma_f32_16x16x32_bf16 a[76:79], v[52:55], v[184:187], a[76:79]
    s_waitcnt lgkmcnt(3)
    v_mfma_f32_16x16x32_bf16 a[80:83], v[56:59], v[88:91], a[80:83]
    v_mfma_f32_16x16x32_bf16 a[84:87], v[56:59], v[112:115], a[84:87]
    v_mfma_f32_16x16x32_bf16 a[88:91], v[56:59], v[136:139], a[88:91]
    v_mfma_f32_16x16x32_bf16 a[92:95], v[56:59], v[160:163], a[92:95]
    v_mfma_f32_16x16x32_bf16 a[96:99], v[56:59], v[184:187], a[96:99]
    s_waitcnt lgkmcnt(2)
    v_mfma_f32_16x16x32_bf16 a[100:103], v[60:63], v[88:91], a[100:103]
    v_mfma_f32_16x16x32_bf16 a[104:107], v[60:63], v[112:115], a[104:107]
    v_mfma_f32_16x16x32_bf16 a[108:111], v[60:63], v[136:139], a[108:111]
    v_mfma_f32_16x16x32_bf16 a[112:115], v[60:63], v[160:163], a[112:115]
    v_mfma_f32_16x16x32_bf16 a[116:119], v[60:63], v[184:187], a[116:119]
    s_waitcnt lgkmcnt(1)
    v_mfma_f32_16x16x32_bf16 a[120:123], v[64:67], v[88:91], a[120:123]
    v_mfma_f32_16x16x32_bf16 a[124:127], v[64:67], v[112:115], a[124:127]
    v_mfma_f32_16x16x32_bf16 a[128:131], v[64:67], v[136:139], a[128:131]
    v_mfma_f32_16x16x32_bf16 a[132:135], v[64:67], v[160:163], a[132:135]
    v_mfma_f32_16x16x32_bf16 a[136:139], v[64:67], v[184:187], a[136:139]
    s_waitcnt lgkmcnt(0)
    v_mfma_f32_16x16x32_bf16 a[140:143], v[68:71], v[88:91], a[140:143]
    v_mfma_f32_16x16x32_bf16 a[144:147], v[68:71], v[112:115], a[144:147]
    v_mfma_f32_16x16x32_bf16 a[148:151], v[68:71], v[136:139], a[148:151]
    v_mfma_f32_16x16x32_bf16 a[152:155], v[68:71], v[160:163], a[152:155]
    v_mfma_f32_16x16x32_bf16 a[156:159], v[68:71], v[184:187], a[156:159]
    ds_read_b128 v[40:43], v28 offset:64
    ds_read_b128 v[44:47], v28 offset:6720
    ds_read_b128 v[48:51], v28 offset:13376
    ds_read_b128 v[52:55], v28 offset:20032
    ds_read_b128 v[56:59], v28 offset:26688
    ds_read_b128 v[60:63], v28 offset:33344
    ds_read_b128 v[64:67], v28 offset:40000
    ds_read_b128 v[68:71], v28 offset:46656
    s_waitcnt lgkmcnt(7)
    v_mfma_f32_16x16x32_bf16 a[0:3], v[40:43], v[92:95], a[0:3]
    v_mfma_f32_16x16x32_bf16 a[4:7], v[40:43], v[116:119], a[4:7]
    v_mfma_f32_16x16x32_bf16 a[8:11], v[40:43], v[140:143], a[8:11]
    v_mfma_f32_16x16x32_bf16 a[12:15], v[40:43], v[164:167], a[12:15]
    v_mfma_f32_16x16x32_bf16 a[16:19], v[40:43], v[188:191], a[16:19]
    s_waitcnt lgkmcnt(6)
    v_mfma_f32_16x16x32_bf16 a[20:23], v[44:47], v[92:95], a[20:23]
    v_mfma_f32_16x16x32_bf16 a[24:27], v[44:47], v[116:119], a[24:27]
    v_mfma_f32_16x16x32_bf16 a[28:31], v[44:47], v[140:143], a[28:31]
    v_mfma_f32_16x16x32_bf16 a[32:35], v[44:47], v[164:167], a[32:35]
    v_mfma_f32_16x16x32_bf16 a[36:39], v[44:47], v[188:191], a[36:39]
    s_waitcnt lgkmcnt(5)
    v_mfma_f32_16x16x32_bf16 a[40:43], v[48:51], v[92:95], a[40:43]
    v_mfma_f32_16x16x32_bf16 a[44:47], v[48:51], v[116:119], a[44:47]
    v_mfma_f32_16x16x32_bf16 a[48:51], v[48:51], v[140:143], a[48:51]
    v_mfma_f32_16x16x32_bf16 a[52:55], v[48:51], v[164:167], a[52:55]
    v_mfma_f32_16x16x32_bf16 a[56:59], v[48:51], v[188:191], a[56:59]
    s_waitcnt lgkmcnt(4)
    v_mfma_f32_16x16x32_bf16 a[60:63], v[52:55], v[92:95], a[60:63]
    v_mfma_f32_16x16x32_bf16 a[64:67], v[52:55], v[116:119], a[64:67]
    v_mfma_f32_16x16x32_bf16 a[68:71], v[52:55], v[140:143], a[68:71]
    v_mfma_f32_16x16x32_bf16 a[72:75], v[52:55], v[164:167], a[72:75]
    v_mfma_f32_16x16x32_bf16 a[76:79], v[52:55], v[188:191], a[76:79]
    s_waitcnt lgkmcnt(3)
    v_mfma_f32_16x16x32_bf16 a[80:83], v[56:59], v[92:95], a[80:83]
    v_mfma_f32_16x16x32_bf16 a[84:87], v[56:59], v[116:119], a[84:87]
    v_mfma_f32_16x16x32_bf16 a[88:91], v[56:59], v[140:143], a[88:91]
    v_mfma_f32_16x16x32_bf16 a[92:95], v[56:59], v[164:167], a[92:95]
    v_mfma_f32_16x16x32_bf16 a[96:99], v[56:59], v[188:191], a[96:99]
    s_waitcnt lgkmcnt(2)
    v_mfma_f32_16x16x32_bf16 a[100:103], v[60:63], v[92:95], a[100:103]
    v_mfma_f32_16x16x32_bf16 a[104:107], v[60:63], v[116:119], a[104:107]
    v_mfma_f32_16x16x32_bf16 a[108:111], v[60:63], v[140:143], a[108:111]
    v_mfma_f32_16x16x32_bf16 a[112:115], v[60:63], v[164:167], a[112:115]
    v_mfma_f32_16x16x32_bf16 a[116:119], v[60:63], v[188:191], a[116:119]
    s_waitcnt lgkmcnt(1)
    v_mfma_f32_16x16x32_bf16 a[120:123], v[64:67], v[92:95], a[120:123]
    v_mfma_f32_16x16x32_bf16 a[124:127], v[64:67], v[116:119], a[124:127]
    v_mfma_f32_16x16x32_bf16 a[128:131], v[64:67], v[140:143], a[128:131]
    v_mfma_f32_16x16x32_bf16 a[132:135], v[64:67], v[164:167], a[132:135]
    v_mfma_f32_16x16x32_bf16 a[136:139], v[64:67], v[188:191], a[136:139]
    s_waitcnt lgkmcnt(0)
    v_mfma_f32_16x16x32_bf16 a[140:143], v[68:71], v[92:95], a[140:143]
    v_mfma_f32_16x16x32_bf16 a[144:147], v[68:71], v[116:119], a[144:147]
    v_mfma_f32_16x16x32_bf16 a[148:151], v[68:71], v[140:143], a[148:151]
    v_mfma_f32_16x16x32_bf16 a[152:155], v[68:71], v[164:167], a[152:155]
    v_mfma_f32_16x16x32_bf16 a[156:159], v[68:71], v[188:191], a[156:159]
    ds_read_b128 v[40:43], v28 offset:128
    ds_read_b128 v[44:47], v28 offset:6784
    ds_read_b128 v[48:51], v28 offset:13440
    ds_read_b128 v[52:55], v28 offset:20096
    ds_read_b128 v[56:59], v28 offset:26752
    ds_read_b128 v[60:63], v28 offset:33408
    ds_read_b128 v[64:67], v28 offset:40064
    ds_read_b128 v[68:71], v28 offset:46720
    s_waitcnt lgkmcnt(7)
    v_mfma_f32_16x16x32_bf16 a[0:3], v[40:43], v[96:99], a[0:3]
    v_mfma_f32_16x16x32_bf16 a[4:7], v[40:43], v[120:123], a[4:7]
    v_mfma_f32_16x16x32_bf16 a[8:11], v[40:43], v[144:147], a[8:11]
    v_mfma_f32_16x16x32_bf16 a[12:15], v[40:43], v[168:171], a[12:15]
    v_mfma_f32_16x16x32_bf16 a[16:19], v[40:43], v[192:195], a[16:19]
    s_waitcnt lgkmcnt(6)
    v_mfma_f32_16x16x32_bf16 a[20:23], v[44:47], v[96:99], a[20:23]
    v_mfma_f32_16x16x32_bf16 a[24:27], v[44:47], v[120:123], a[24:27]
    v_mfma_f32_16x16x32_bf16 a[28:31], v[44:47], v[144:147], a[28:31]
    v_mfma_f32_16x16x32_bf16 a[32:35], v[44:47], v[168:171], a[32:35]
    v_mfma_f32_16x16x32_bf16 a[36:39], v[44:47], v[192:195], a[36:39]
    s_waitcnt lgkmcnt(5)
    v_mfma_f32_16x16x32_bf16 a[40:43], v[48:51], v[96:99], a[40:43]
    v_mfma_f32_16x16x32_bf16 a[44:47], v[48:51], v[120:123], a[44:47]
    v_mfma_f32_16x16x32_bf16 a[48:51], v[48:51], v[144:147], a[48:51]
    v_mfma_f32_16x16x32_bf16 a[52:55], v[48:51], v[168:171], a[52:55]
    v_mfma_f32_16x16x32_bf16 a[56:59], v[48:51], v[192:195], a[56:59]
    s_waitcnt lgkmcnt(4)
    v_mfma_f32_16x16x32_bf16 a[60:63], v[52:55], v[96:99], a[60:63]
    v_mfma_f32_16x16x32_bf16 a[64:67], v[52:55], v[120:123], a[64:67]
    v_mfma_f32_16x16x32_bf16 a[68:71], v[52:55], v[144:147], a[68:71]
    v_mfma_f32_16x16x32_bf16 a[72:75], v[52:55], v[168:171], a[72:75]
    v_mfma_f32_16x16x32_bf16 a[76:79], v[52:55], v[192:195], a[76:79]
    s_waitcnt lgkmcnt(3)
    v_mfma_f32_16x16x32_bf16 a[80:83], v[56:59], v[96:99], a[80:83]
    v_mfma_f32_16x16x32_bf16 a[84:87], v[56:59], v[120:123], a[84:87]
    v_mfma_f32_16x16x32_bf16 a[88:91], v[56:59], v[144:147], a[88:91]
    v_mfma_f32_16x16x32_bf16 a[92:95], v[56:59], v[168:171], a[92:95]
    v_mfma_f32_16x16x32_bf16 a[96:99], v[56:59], v[192:195], a[96:99]
    s_waitcnt lgkmcnt(2)
    v_mfma_f32_16x16x32_bf16 a[100:103], v[60:63], v[96:99], a[100:103]
    v_mfma_f32_16x16x32_bf16 a[104:107], v[60:63], v[120:123], a[104:107]
    v_mfma_f32_16x16x32_bf16 a[108:111], v[60:63], v[144:147], a[108:111]
    v_mfma_f32_16x16x32_bf16 a[112:115], v[60:63], v[168:171], a[112:115]
    v_mfma_f32_16x16x32_bf16 a[116:119], v[60:63], v[192:195], a[116:119]
    s_waitcnt lgkmcnt(1)
    v_mfma_f32_16x16x32_bf16 a[120:123], v[64:67], v[96:99], a[120:123]
    v_mfma_f32_16x16x32_bf16 a[124:127], v[64:67], v[120:123], a[124:127]
    v_mfma_f32_16x16x32_bf16 a[128:131], v[64:67], v[144:147], a[128:131]
    v_mfma_f32_16x16x32_bf16 a[132:135], v[64:67], v[168:171], a[132:135]
    v_mfma_f32_16x16x32_bf16 a[136:139], v[64:67], v[192:195], a[136:139]
    s_waitcnt lgkmcnt(0)
    v_mfma_f32_16x16x32_bf16 a[140:143], v[68:71], v[96:99], a[140:143]
    v_mfma_f32_16x16x32_bf16 a[144:147], v[68:71], v[120:123], a[144:147]
    v_mfma_f32_16x16x32_bf16 a[148:151], v[68:71], v[144:147], a[148:151]
    v_mfma_f32_16x16x32_bf16 a[152:155], v[68:71], v[168:171], a[152:155]
    v_mfma_f32_16x16x32_bf16 a[156:159], v[68:71], v[192:195], a[156:159]
    ds_read_b128 v[40:43], v28 offset:192
    ds_read_b128 v[44:47], v28 offset:6848
    ds_read_b128 v[48:51], v28 offset:13504
    ds_read_b128 v[52:55], v28 offset:20160
    ds_read_b128 v[56:59], v28 offset:26816
    ds_read_b128 v[60:63], v28 offset:33472
    ds_read_b128 v[64:67], v28 offset:40128
    ds_read_b128 v[68:71], v28 offset:46784
    s_waitcnt lgkmcnt(7)
    v_mfma_f32_16x16x32_bf16 a[0:3], v[40:43], v[100:103], a[0:3]
    v_mfma_f32_16x16x32_bf16 a[4:7], v[40:43], v[124:127], a[4:7]
    v_mfma_f32_16x16x32_bf16 a[8:11], v[40:43], v[148:151], a[8:11]
    v_mfma_f32_16x16x32_bf16 a[12:15], v[40:43], v[172:175], a[12:15]
    v_mfma_f32_16x16x32_bf16 a[16:19], v[40:43], v[196:199], a[16:19]
    s_waitcnt lgkmcnt(6)
    v_mfma_f32_16x16x32_bf16 a[20:23], v[44:47], v[100:103], a[20:23]
    v_mfma_f32_16x16x32_bf16 a[24:27], v[44:47], v[124:127], a[24:27]
    v_mfma_f32_16x16x32_bf16 a[28:31], v[44:47], v[148:151], a[28:31]
    v_mfma_f32_16x16x32_bf16 a[32:35], v[44:47], v[172:175], a[32:35]
    v_mfma_f32_16x16x32_bf16 a[36:39], v[44:47], v[196:199], a[36:39]
    s_waitcnt lgkmcnt(5)
    v_mfma_f32_16x16x32_bf16 a[40:43], v[48:51], v[100:103], a[40:43]
    v_mfma_f32_16x16x32_bf16 a[44:47], v[48:51], v[124:127], a[44:47]
    v_mfma_f32_16x16x32_bf16 a[48:51], v[48:51], v[148:151], a[48:51]
    v_mfma_f32_16x16x32_bf16 a[52:55], v[48:51], v[172:175], a[52:55]
    v_mfma_f32_16x16x32_bf16 a[56:59], v[48:51], v[196:199], a[56:59]
    s_waitcnt lgkmcnt(4)
    v_mfma_f32_16x16x32_bf16 a[60:63], v[52:55], v[100:103], a[60:63]
    v_mfma_f32_16x16x32_bf16 a[64:67], v[52:55], v[124:127], a[64:67]
    v_mfma_f32_16x16x32_bf16 a[68:71], v[52:55], v[148:151], a[68:71]
    v_mfma_f32_16x16x32_bf16 a[72:75], v[52:55], v[172:175], a[72:75]
    v_mfma_f32_16x16x32_bf16 a[76:79], v[52:55], v[196:199], a[76:79]
    s_waitcnt lgkmcnt(3)
    v_mfma_f32_16x16x32_bf16 a[80:83], v[56:59], v[100:103], a[80:83]
    v_mfma_f32_16x16x32_bf16 a[84:87], v[56:59], v[124:127], a[84:87]
    v_mfma_f32_16x16x32_bf16 a[88:91], v[56:59], v[148:151], a[88:91]
    v_mfma_f32_16x16x32_bf16 a[92:95], v[56:59], v[172:175], a[92:95]
    v_mfma_f32_16x16x32_bf16 a[96:99], v[56:59], v[196:199], a[96:99]
    s_waitcnt lgkmcnt(2)
    v_mfma_f32_16x16x32_bf16 a[100:103], v[60:63], v[100:103], a[100:103]
    v_mfma_f32_16x16x32_bf16 a[104:107], v[60:63], v[124:127], a[104:107]
    v_mfma_f32_16x16x32_bf16 a[108:111], v[60:63], v[148:151], a[108:111]
    v_mfma_f32_16x16x32_bf16 a[112:115], v[60:63], v[172:175], a[112:115]
    v_mfma_f32_16x16x32_bf16 a[116:119], v[60:63], v[196:199], a[116:119]
    s_waitcnt lgkmcnt(1)
    v_mfma_f32_16x16x32_bf16 a[120:123], v[64:67], v[100:103], a[120:123]
    v_mfma_f32_16x16x32_bf16 a[124:127], v[64:67], v[124:127], a[124:127]
    v_mfma_f32_16x16x32_bf16 a[128:131], v[64:67], v[148:151], a[128:131]
    v_mfma_f32_16x16x32_bf16 a[132:135], v[64:67], v[172:175], a[132:135]
    v_mfma_f32_16x16x32_bf16 a[136:139], v[64:67], v[196:199], a[136:139]
    s_waitcnt lgkmcnt(0)
    v_mfma_f32_16x16x32_bf16 a[140:143], v[68:71], v[100:103], a[140:143]
    v_mfma_f32_16x16x32_bf16 a[144:147], v[68:71], v[124:127], a[144:147]
    v_mfma_f32_16x16x32_bf16 a[148:151], v[68:71], v[148:151], a[148:151]
    v_mfma_f32_16x16x32_bf16 a[152:155], v[68:71], v[172:175], a[152:155]
    v_mfma_f32_16x16x32_bf16 a[156:159], v[68:71], v[196:199], a[156:159]
    ds_read_b128 v[40:43], v28 offset:256
    ds_read_b128 v[44:47], v28 offset:6912
    ds_read_b128 v[48:51], v28 offset:13568
    ds_read_b128 v[52:55], v28 offset:20224
    ds_read_b128 v[56:59], v28 offset:26880
    ds_read_b128 v[60:63], v28 offset:33536
    ds_read_b128 v[64:67], v28 offset:40192
    ds_read_b128 v[68:71], v28 offset:46848
    s_waitcnt lgkmcnt(7)
    v_mfma_f32_16x16x32_bf16 a[0:3], v[40:43], v[104:107], a[0:3]
    v_mfma_f32_16x16x32_bf16 a[4:7], v[40:43], v[128:131], a[4:7]
    v_mfma_f32_16x16x32_bf16 a[8:11], v[40:43], v[152:155], a[8:11]
    v_mfma_f32_16x16x32_bf16 a[12:15], v[40:43], v[176:179], a[12:15]
    v_mfma_f32_16x16x32_bf16 a[16:19], v[40:43], v[200:203], a[16:19]
    s_waitcnt lgkmcnt(6)
    v_mfma_f32_16x16x32_bf16 a[20:23], v[44:47], v[104:107], a[20:23]
    v_mfma_f32_16x16x32_bf16 a[24:27], v[44:47], v[128:131], a[24:27]
    v_mfma_f32_16x16x32_bf16 a[28:31], v[44:47], v[152:155], a[28:31]
    v_mfma_f32_16x16x32_bf16 a[32:35], v[44:47], v[176:179], a[32:35]
    v_mfma_f32_16x16x32_bf16 a[36:39], v[44:47], v[200:203], a[36:39]
    s_waitcnt lgkmcnt(5)
    v_mfma_f32_16x16x32_bf16 a[40:43], v[48:51], v[104:107], a[40:43]
    v_mfma_f32_16x16x32_bf16 a[44:47], v[48:51], v[128:131], a[44:47]
    v_mfma_f32_16x16x32_bf16 a[48:51], v[48:51], v[152:155], a[48:51]
    v_mfma_f32_16x16x32_bf16 a[52:55], v[48:51], v[176:179], a[52:55]
    v_mfma_f32_16x16x32_bf16 a[56:59], v[48:51], v[200:203], a[56:59]
    s_waitcnt lgkmcnt(4)
    v_mfma_f32_16x16x32_bf16 a[60:63], v[52:55], v[104:107], a[60:63]
    v_mfma_f32_16x16x32_bf16 a[64:67], v[52:55], v[128:131], a[64:67]
    v_mfma_f32_16x16x32_bf16 a[68:71], v[52:55], v[152:155], a[68:71]
    v_mfma_f32_16x16x32_bf16 a[72:75], v[52:55], v[176:179], a[72:75]
    v_mfma_f32_16x16x32_bf16 a[76:79], v[52:55], v[200:203], a[76:79]
    s_waitcnt lgkmcnt(3)
    v_mfma_f32_16x16x32_bf16 a[80:83], v[56:59], v[104:107], a[80:83]
    v_mfma_f32_16x16x32_bf16 a[84:87], v[56:59], v[128:131], a[84:87]
    v_mfma_f32_16x16x32_bf16 a[88:91], v[56:59], v[152:155], a[88:91]
    v_mfma_f32_16x16x32_bf16 a[92:95], v[56:59], v[176:179], a[92:95]
    v_mfma_f32_16x16x32_bf16 a[96:99], v[56:59], v[200:203], a[96:99]
    s_waitcnt lgkmcnt(2)
    v_mfma_f32_16x16x32_bf16 a[100:103], v[60:63], v[104:107], a[100:103]
    v_mfma_f32_16x16x32_bf16 a[104:107], v[60:63], v[128:131], a[104:107]
    v_mfma_f32_16x16x32_bf16 a[108:111], v[60:63], v[152:155], a[108:111]
    v_mfma_f32_16x16x32_bf16 a[112:115], v[60:63], v[176:179], a[112:115]
    v_mfma_f32_16x16x32_bf16 a[116:119], v[60:63], v[200:203], a[116:119]
    s_waitcnt lgkmcnt(1)
    v_mfma_f32_16x16x32_bf16 a[120:123], v[64:67], v[104:107], a[120:123]
    v_mfma_f32_16x16x32_bf16 a[124:127], v[64:67], v[128:131], a[124:127]
    v_mfma_f32_16x16x32_bf16 a[128:131], v[64:67], v[152:155], a[128:131]
    v_mfma_f32_16x16x32_bf16 a[132:135], v[64:67], v[176:179], a[132:135]
    v_mfma_f32_16x16x32_bf16 a[136:139], v[64:67], v[200:203], a[136:139]
    s_waitcnt lgkmcnt(0)
    v_mfma_f32_16x16x32_bf16 a[140:143], v[68:71], v[104:107], a[140:143]
    v_mfma_f32_16x16x32_bf16 a[144:147], v[68:71], v[128:131], a[144:147]
    v_mfma_f32_16x16x32_bf16 a[148:151], v[68:71], v[152:155], a[148:151]
    v_mfma_f32_16x16x32_bf16 a[152:155], v[68:71], v[176:179], a[152:155]
    v_mfma_f32_16x16x32_bf16 a[156:159], v[68:71], v[200:203], a[156:159]
    ds_read_b128 v[40:43], v28 offset:320
    ds_read_b128 v[44:47], v28 offset:6976
    ds_read_b128 v[48:51], v28 offset:13632
    ds_read_b128 v[52:55], v28 offset:20288
    ds_read_b128 v[56:59], v28 offset:26944
    ds_read_b128 v[60:63], v28 offset:33600
    ds_read_b128 v[64:67], v28 offset:40256
    ds_read_b128 v[68:71], v28 offset:46912
    s_waitcnt lgkmcnt(7)
    v_mfma_f32_16x16x32_bf16 a[0:3], v[40:43], v[108:111], a[0:3]
    v_mfma_f32_16x16x32_bf16 a[4:7], v[40:43], v[132:135], a[4:7]
    v_mfma_f32_16x16x32_bf16 a[8:11], v[40:43], v[156:159], a[8:11]
    v_mfma_f32_16x16x32_bf16 a[12:15], v[40:43], v[180:183], a[12:15]
    v_mfma_f32_16x16x32_bf16 a[16:19], v[40:43], v[204:207], a[16:19]
    s_waitcnt lgkmcnt(6)
    v_mfma_f32_16x16x32_bf16 a[20:23], v[44:47], v[108:111], a[20:23]
    v_mfma_f32_16x16x32_bf16 a[24:27], v[44:47], v[132:135], a[24:27]
    v_mfma_f32_16x16x32_bf16 a[28:31], v[44:47], v[156:159], a[28:31]
    v_mfma_f32_16x16x32_bf16 a[32:35], v[44:47], v[180:183], a[32:35]
    v_mfma_f32_16x16x32_bf16 a[36:39], v[44:47], v[204:207], a[36:39]
    s_waitcnt lgkmcnt(5)
    v_mfma_f32_16x16x32_bf16 a[40:43], v[48:51], v[108:111], a[40:43]
    v_mfma_f32_16x16x32_bf16 a[44:47], v[48:51], v[132:135], a[44:47]
    v_mfma_f32_16x16x32_bf16 a[48:51], v[48:51], v[156:159], a[48:51]
    v_mfma_f32_16x16x32_bf16 a[52:55], v[48:51], v[180:183], a[52:55]
    v_mfma_f32_16x16x32_bf16 a[56:59], v[48:51], v[204:207], a[56:59]
    s_waitcnt lgkmcnt(4)
    v_mfma_f32_16x16x32_bf16 a[60:63], v[52:55], v[108:111], a[60:63]
    v_mfma_f32_16x16x32_bf16 a[64:67], v[52:55], v[132:135], a[64:67]
    v_mfma_f32_16x16x32_bf16 a[68:71], v[52:55], v[156:159], a[68:71]
    v_mfma_f32_16x16x32_bf16 a[72:75], v[52:55], v[180:183], a[72:75]
    v_mfma_f32_16x16x32_bf16 a[76:79], v[52:55], v[204:207], a[76:79]
    s_waitcnt lgkmcnt(3)
    v_mfma_f32_16x16x32_bf16 a[80:83], v[56:59], v[108:111], a[80:83]
    v_mfma_f32_16x16x32_bf16 a[84:87], v[56:59], v[132:135], a[84:87]
    v_mfma_f32_16x16x32_bf16 a[88:91], v[56:59], v[156:159], a[88:91]
    v_mfma_f32_16x16x32_bf16 a[92:95], v[56:59], v[180:183], a[92:95]
    v_mfma_f32_16x16x32_bf16 a[96:99], v[56:59], v[204:207], a[96:99]
    s_waitcnt lgkmcnt(2)
    v_mfma_f32_16x16x32_bf16 a[100:103], v[60:63], v[108:111], a[100:103]
    v_mfma_f32_16x16x32_bf16 a[104:107], v[60:63], v[132:135], a[104:107]
    v_mfma_f32_16x16x32_bf16 a[108:111], v[60:63], v[156:159], a[108:111]
    v_mfma_f32_16x16x32_bf16 a[112:115], v[60:63], v[180:183], a[112:115]
    v_mfma_f32_16x16x32_bf16 a[116:119], v[60:63], v[204:207], a[116:119]
    s_waitcnt lgkmcnt(1)
    v_mfma_f32_16x16x32_bf16 a[120:123], v[64:67], v[108:111], a[120:123]
    v_mfma_f32_16x16x32_bf16 a[124:127], v[64:67], v[132:135], a[124:127]
    v_mfma_f32_16x16x32_bf16 a[128:131], v[64:67], v[156:159], a[128:131]
    v_mfma_f32_16x16x32_bf16 a[132:135], v[64:67], v[180:183], a[132:135]
    v_mfma_f32_16x16x32_bf16 a[136:139], v[64:67], v[204:207], a[136:139]
    s_waitcnt lgkmcnt(0)
    v_mfma_f32_16x16x32_bf16 a[140:143], v[68:71], v[108:111], a[140:143]
    v_mfma_f32_16x16x32_bf16 a[144:147], v[68:71], v[132:135], a[144:147]
    v_mfma_f32_16x16x32_bf16 a[148:151], v[68:71], v[156:159], a[148:151]
    v_mfma_f32_16x16x32_bf16 a[152:155], v[68:71], v[180:183], a[152:155]
    v_mfma_f32_16x16x32_bf16 a[156:159], v[68:71], v[204:207], a[156:159]
    s_nop 7
    s_add_u32 s23, s22, 0
    v_accvgpr_read_b32 v76, a0
    v_accvgpr_read_b32 v80, a20
    v_accvgpr_read_b32 v77, a1
    v_accvgpr_read_b32 v81, a21
    v_accvgpr_read_b32 v78, a2
    v_accvgpr_read_b32 v82, a22
    v_accvgpr_read_b32 v79, a3
    v_accvgpr_read_b32 v83, a23
    v_cvt_pk_bf16_f32 v72, v76, v77
    v_cvt_pk_bf16_f32 v73, v78, v79
    v_cvt_pk_bf16_f32 v74, v80, v81
    v_cvt_pk_bf16_f32 v75, v82, v83
    s_nop 1
    v_permlane16_swap_b32 v72, v74
    v_permlane16_swap_b32 v73, v75
    s_nop 0
    s_add_u32 s24, s23, 0
    buffer_store_dwordx4 v[72:75], v30, s[4:7], s24 offen sc1
    v_accvgpr_read_b32 v76, a4
    v_accvgpr_read_b32 v80, a24
    v_accvgpr_read_b32 v77, a5
    v_accvgpr_read_b32 v81, a25
    v_accvgpr_read_b32 v78, a6
    v_accvgpr_read_b32 v82, a26
    v_accvgpr_read_b32 v79, a7
    v_accvgpr_read_b32 v83, a27
    v_cvt_pk_bf16_f32 v84, v76, v77
    v_cvt_pk_bf16_f32 v85, v78, v79
    v_cvt_pk_bf16_f32 v86, v80, v81
    v_cvt_pk_bf16_f32 v87, v82, v83
    s_nop 1
    v_permlane16_swap_b32 v84, v86
    v_permlane16_swap_b32 v85, v87
    s_nop 0
    s_add_u32 s24, s23, 1024
    buffer_store_dwordx4 v[84:87], v30, s[4:7], s24 offen sc1
    v_accvgpr_read_b32 v76, a8
    v_accvgpr_read_b32 v80, a28
    v_accvgpr_read_b32 v77, a9
    v_accvgpr_read_b32 v81, a29
    v_accvgpr_read_b32 v78, a10
    v_accvgpr_read_b32 v82, a30
    v_accvgpr_read_b32 v79, a11
    v_accvgpr_read_b32 v83, a31
    v_cvt_pk_bf16_f32 v72, v76, v77
    v_cvt_pk_bf16_f32 v73, v78, v79
    v_cvt_pk_bf16_f32 v74, v80, v81
    v_cvt_pk_bf16_f32 v75, v82, v83
    s_nop 1
    v_permlane16_swap_b32 v72, v74
    v_permlane16_swap_b32 v73, v75
    s_nop 0
    s_add_u32 s24, s23, 2048
    buffer_store_dwordx4 v[72:75], v30, s[4:7], s24 offen sc1
    v_accvgpr_read_b32 v76, a12
    v_accvgpr_read_b32 v80, a32
    v_accvgpr_read_b32 v77, a13
    v_accvgpr_read_b32 v81, a33
    v_accvgpr_read_b32 v78, a14
    v_accvgpr_read_b32 v82, a34
    v_accvgpr_read_b32 v79, a15
    v_accvgpr_read_b32 v83, a35
    v_cvt_pk_bf16_f32 v84, v76, v77
    v_cvt_pk_bf16_f32 v85, v78, v79
    v_cvt_pk_bf16_f32 v86, v80, v81
    v_cvt_pk_bf16_f32 v87, v82, v83
    s_nop 1
    v_permlane16_swap_b32 v84, v86
    v_permlane16_swap_b32 v85, v87
    s_nop 0
    s_add_u32 s24, s23, 3072
    buffer_store_dwordx4 v[84:87], v30, s[4:7], s24 offen sc1
    v_accvgpr_read_b32 v76, a16
    v_accvgpr_read_b32 v80, a36
    v_accvgpr_read_b32 v77, a17
    v_accvgpr_read_b32 v81, a37
    v_accvgpr_read_b32 v78, a18
    v_accvgpr_read_b32 v82, a38
    v_accvgpr_read_b32 v79, a19
    v_accvgpr_read_b32 v83, a39
    v_cvt_pk_bf16_f32 v72, v76, v77
    v_cvt_pk_bf16_f32 v73, v78, v79
    v_cvt_pk_bf16_f32 v74, v80, v81
    v_cvt_pk_bf16_f32 v75, v82, v83
    s_nop 1
    v_permlane16_swap_b32 v72, v74
    v_permlane16_swap_b32 v73, v75
    s_nop 0
    s_add_u32 s24, s23, 4096
    buffer_store_dwordx4 v[72:75], v30, s[4:7], s24 offen sc1
    s_add_u32 s23, s22, 1310720
    v_accvgpr_read_b32 v76, a40
    v_accvgpr_read_b32 v80, a60
    v_accvgpr_read_b32 v77, a41
    v_accvgpr_read_b32 v81, a61
    v_accvgpr_read_b32 v78, a42
    v_accvgpr_read_b32 v82, a62
    v_accvgpr_read_b32 v79, a43
    v_accvgpr_read_b32 v83, a63
    v_cvt_pk_bf16_f32 v72, v76, v77
    v_cvt_pk_bf16_f32 v73, v78, v79
    v_cvt_pk_bf16_f32 v74, v80, v81
    v_cvt_pk_bf16_f32 v75, v82, v83
    s_nop 1
    v_permlane16_swap_b32 v72, v74
    v_permlane16_swap_b32 v73, v75
    s_nop 0
    s_add_u32 s24, s23, 0
    buffer_store_dwordx4 v[72:75], v30, s[4:7], s24 offen sc1
    v_accvgpr_read_b32 v76, a44
    v_accvgpr_read_b32 v80, a64
    v_accvgpr_read_b32 v77, a45
    v_accvgpr_read_b32 v81, a65
    v_accvgpr_read_b32 v78, a46
    v_accvgpr_read_b32 v82, a66
    v_accvgpr_read_b32 v79, a47
    v_accvgpr_read_b32 v83, a67
    v_cvt_pk_bf16_f32 v84, v76, v77
    v_cvt_pk_bf16_f32 v85, v78, v79
    v_cvt_pk_bf16_f32 v86, v80, v81
    v_cvt_pk_bf16_f32 v87, v82, v83
    s_nop 1
    v_permlane16_swap_b32 v84, v86
    v_permlane16_swap_b32 v85, v87
    s_nop 0
    s_add_u32 s24, s23, 1024
    buffer_store_dwordx4 v[84:87], v30, s[4:7], s24 offen sc1
    v_accvgpr_read_b32 v76, a48
    v_accvgpr_read_b32 v80, a68
    v_accvgpr_read_b32 v77, a49
    v_accvgpr_read_b32 v81, a69
    v_accvgpr_read_b32 v78, a50
    v_accvgpr_read_b32 v82, a70
    v_accvgpr_read_b32 v79, a51
    v_accvgpr_read_b32 v83, a71
    v_cvt_pk_bf16_f32 v72, v76, v77
    v_cvt_pk_bf16_f32 v73, v78, v79
    v_cvt_pk_bf16_f32 v74, v80, v81
    v_cvt_pk_bf16_f32 v75, v82, v83
    s_nop 1
    v_permlane16_swap_b32 v72, v74
    v_permlane16_swap_b32 v73, v75
    s_nop 0
    s_add_u32 s24, s23, 2048
    buffer_store_dwordx4 v[72:75], v30, s[4:7], s24 offen sc1
    v_accvgpr_read_b32 v76, a52
    v_accvgpr_read_b32 v80, a72
    v_accvgpr_read_b32 v77, a53
    v_accvgpr_read_b32 v81, a73
    v_accvgpr_read_b32 v78, a54
    v_accvgpr_read_b32 v82, a74
    v_accvgpr_read_b32 v79, a55
    v_accvgpr_read_b32 v83, a75
    v_cvt_pk_bf16_f32 v84, v76, v77
    v_cvt_pk_bf16_f32 v85, v78, v79
    v_cvt_pk_bf16_f32 v86, v80, v81
    v_cvt_pk_bf16_f32 v87, v82, v83
    s_nop 1
    v_permlane16_swap_b32 v84, v86
    v_permlane16_swap_b32 v85, v87
    s_nop 0
    s_add_u32 s24, s23, 3072
    buffer_store_dwordx4 v[84:87], v30, s[4:7], s24 offen sc1
    v_accvgpr_read_b32 v76, a56
    v_accvgpr_read_b32 v80, a76
    v_accvgpr_read_b32 v77, a57
    v_accvgpr_read_b32 v81, a77
    v_accvgpr_read_b32 v78, a58
    v_accvgpr_read_b32 v82, a78
    v_accvgpr_read_b32 v79, a59
    v_accvgpr_read_b32 v83, a79
    v_cvt_pk_bf16_f32 v72, v76, v77
    v_cvt_pk_bf16_f32 v73, v78, v79
    v_cvt_pk_bf16_f32 v74, v80, v81
    v_cvt_pk_bf16_f32 v75, v82, v83
    s_nop 1
    v_permlane16_swap_b32 v72, v74
    v_permlane16_swap_b32 v73, v75
    s_nop 0
    s_add_u32 s24, s23, 4096
    buffer_store_dwordx4 v[72:75], v30, s[4:7], s24 offen sc1
    s_add_u32 s23, s22, 2621440
    v_accvgpr_read_b32 v76, a80
    v_accvgpr_read_b32 v80, a100
    v_accvgpr_read_b32 v77, a81
    v_accvgpr_read_b32 v81, a101
    v_accvgpr_read_b32 v78, a82
    v_accvgpr_read_b32 v82, a102
    v_accvgpr_read_b32 v79, a83
    v_accvgpr_read_b32 v83, a103
    v_cvt_pk_bf16_f32 v72, v76, v77
    v_cvt_pk_bf16_f32 v73, v78, v79
    v_cvt_pk_bf16_f32 v74, v80, v81
    v_cvt_pk_bf16_f32 v75, v82, v83
    s_nop 1
    v_permlane16_swap_b32 v72, v74
    v_permlane16_swap_b32 v73, v75
    s_nop 0
    s_add_u32 s24, s23, 0
    buffer_store_dwordx4 v[72:75], v30, s[4:7], s24 offen sc1
    v_accvgpr_read_b32 v76, a84
    v_accvgpr_read_b32 v80, a104
    v_accvgpr_read_b32 v77, a85
    v_accvgpr_read_b32 v81, a105
    v_accvgpr_read_b32 v78, a86
    v_accvgpr_read_b32 v82, a106
    v_accvgpr_read_b32 v79, a87
    v_accvgpr_read_b32 v83, a107
    v_cvt_pk_bf16_f32 v84, v76, v77
    v_cvt_pk_bf16_f32 v85, v78, v79
    v_cvt_pk_bf16_f32 v86, v80, v81
    v_cvt_pk_bf16_f32 v87, v82, v83
    s_nop 1
    v_permlane16_swap_b32 v84, v86
    v_permlane16_swap_b32 v85, v87
    s_nop 0
    s_add_u32 s24, s23, 1024
    buffer_store_dwordx4 v[84:87], v30, s[4:7], s24 offen sc1
    v_accvgpr_read_b32 v76, a88
    v_accvgpr_read_b32 v80, a108
    v_accvgpr_read_b32 v77, a89
    v_accvgpr_read_b32 v81, a109
    v_accvgpr_read_b32 v78, a90
    v_accvgpr_read_b32 v82, a110
    v_accvgpr_read_b32 v79, a91
    v_accvgpr_read_b32 v83, a111
    v_cvt_pk_bf16_f32 v72, v76, v77
    v_cvt_pk_bf16_f32 v73, v78, v79
    v_cvt_pk_bf16_f32 v74, v80, v81
    v_cvt_pk_bf16_f32 v75, v82, v83
    s_nop 1
    v_permlane16_swap_b32 v72, v74
    v_permlane16_swap_b32 v73, v75
    s_nop 0
    s_add_u32 s24, s23, 2048
    buffer_store_dwordx4 v[72:75], v30, s[4:7], s24 offen sc1
    v_accvgpr_read_b32 v76, a92
    v_accvgpr_read_b32 v80, a112
    v_accvgpr_read_b32 v77, a93
    v_accvgpr_read_b32 v81, a113
    v_accvgpr_read_b32 v78, a94
    v_accvgpr_read_b32 v82, a114
    v_accvgpr_read_b32 v79, a95
    v_accvgpr_read_b32 v83, a115
    v_cvt_pk_bf16_f32 v84, v76, v77
    v_cvt_pk_bf16_f32 v85, v78, v79
    v_cvt_pk_bf16_f32 v86, v80, v81
    v_cvt_pk_bf16_f32 v87, v82, v83
    s_nop 1
    v_permlane16_swap_b32 v84, v86
    v_permlane16_swap_b32 v85, v87
    s_nop 0
    s_add_u32 s24, s23, 3072
    buffer_store_dwordx4 v[84:87], v30, s[4:7], s24 offen sc1
    v_accvgpr_read_b32 v76, a96
    v_accvgpr_read_b32 v80, a116
    v_accvgpr_read_b32 v77, a97
    v_accvgpr_read_b32 v81, a117
    v_accvgpr_read_b32 v78, a98
    v_accvgpr_read_b32 v82, a118
    v_accvgpr_read_b32 v79, a99
    v_accvgpr_read_b32 v83, a119
    v_cvt_pk_bf16_f32 v72, v76, v77
    v_cvt_pk_bf16_f32 v73, v78, v79
    v_cvt_pk_bf16_f32 v74, v80, v81
    v_cvt_pk_bf16_f32 v75, v82, v83
    s_nop 1
    v_permlane16_swap_b32 v72, v74
    v_permlane16_swap_b32 v73, v75
    s_nop 0
    s_add_u32 s24, s23, 4096
    buffer_store_dwordx4 v[72:75], v30, s[4:7], s24 offen sc1
    s_add_u32 s23, s22, 3932160
    v_accvgpr_read_b32 v76, a120
    v_accvgpr_read_b32 v80, a140
    v_accvgpr_read_b32 v77, a121
    v_accvgpr_read_b32 v81, a141
    v_accvgpr_read_b32 v78, a122
    v_accvgpr_read_b32 v82, a142
    v_accvgpr_read_b32 v79, a123
    v_accvgpr_read_b32 v83, a143
    v_cvt_pk_bf16_f32 v72, v76, v77
    v_cvt_pk_bf16_f32 v73, v78, v79
    v_cvt_pk_bf16_f32 v74, v80, v81
    v_cvt_pk_bf16_f32 v75, v82, v83
    s_nop 1
    v_permlane16_swap_b32 v72, v74
    v_permlane16_swap_b32 v73, v75
    s_nop 0
    s_add_u32 s24, s23, 0
    buffer_store_dwordx4 v[72:75], v30, s[4:7], s24 offen sc1
    v_accvgpr_read_b32 v76, a124
    v_accvgpr_read_b32 v80, a144
    v_accvgpr_read_b32 v77, a125
    v_accvgpr_read_b32 v81, a145
    v_accvgpr_read_b32 v78, a126
    v_accvgpr_read_b32 v82, a146
    v_accvgpr_read_b32 v79, a127
    v_accvgpr_read_b32 v83, a147
    v_cvt_pk_bf16_f32 v84, v76, v77
    v_cvt_pk_bf16_f32 v85, v78, v79
    v_cvt_pk_bf16_f32 v86, v80, v81
    v_cvt_pk_bf16_f32 v87, v82, v83
    s_nop 1
    v_permlane16_swap_b32 v84, v86
    v_permlane16_swap_b32 v85, v87
    s_nop 0
    s_add_u32 s24, s23, 1024
    buffer_store_dwordx4 v[84:87], v30, s[4:7], s24 offen sc1
    v_accvgpr_read_b32 v76, a128
    v_accvgpr_read_b32 v80, a148
    v_accvgpr_read_b32 v77, a129
    v_accvgpr_read_b32 v81, a149
    v_accvgpr_read_b32 v78, a130
    v_accvgpr_read_b32 v82, a150
    v_accvgpr_read_b32 v79, a131
    v_accvgpr_read_b32 v83, a151
    v_cvt_pk_bf16_f32 v72, v76, v77
    v_cvt_pk_bf16_f32 v73, v78, v79
    v_cvt_pk_bf16_f32 v74, v80, v81
    v_cvt_pk_bf16_f32 v75, v82, v83
    s_nop 1
    v_permlane16_swap_b32 v72, v74
    v_permlane16_swap_b32 v73, v75
    s_nop 0
    s_add_u32 s24, s23, 2048
    buffer_store_dwordx4 v[72:75], v30, s[4:7], s24 offen sc1
    v_accvgpr_read_b32 v76, a132
    v_accvgpr_read_b32 v80, a152
    v_accvgpr_read_b32 v77, a133
    v_accvgpr_read_b32 v81, a153
    v_accvgpr_read_b32 v78, a134
    v_accvgpr_read_b32 v82, a154
    v_accvgpr_read_b32 v79, a135
    v_accvgpr_read_b32 v83, a155
    v_cvt_pk_bf16_f32 v84, v76, v77
    v_cvt_pk_bf16_f32 v85, v78, v79
    v_cvt_pk_bf16_f32 v86, v80, v81
    v_cvt_pk_bf16_f32 v87, v82, v83
    s_nop 1
    v_permlane16_swap_b32 v84, v86
    v_permlane16_swap_b32 v85, v87
    s_nop 0
    s_add_u32 s24, s23, 3072
    buffer_store_dwordx4 v[84:87], v30, s[4:7], s24 offen sc1
    v_accvgpr_read_b32 v76, a136
    v_accvgpr_read_b32 v80, a156
    v_accvgpr_read_b32 v77, a137
    v_accvgpr_read_b32 v81, a157
    v_accvgpr_read_b32 v78, a138
    v_accvgpr_read_b32 v82, a158
    v_accvgpr_read_b32 v79, a139
    v_accvgpr_read_b32 v83, a159
    v_cvt_pk_bf16_f32 v72, v76, v77
    v_cvt_pk_bf16_f32 v73, v78, v79
    v_cvt_pk_bf16_f32 v74, v80, v81
    v_cvt_pk_bf16_f32 v75, v82, v83
    s_nop 1
    v_permlane16_swap_b32 v72, v74
    v_permlane16_swap_b32 v73, v75
    s_nop 0
    s_add_u32 s24, s23, 4096
    buffer_store_dwordx4 v[72:75], v30, s[4:7], s24 offen sc1
    s_branch wk_fin
wk_bjob_seg:
    v_and_b32 v1, 15, v0
    v_bfe_u32 v2, v0, 4, 2
    v_lshrrev_b32 v3, 6, v0
    s_mul_i32 s20, s16, 1179648
    s_mul_i32 s21, s18, 384
    s_add_u32 s20, s20, s21
    s_add_u32 s20, s20, 40001536
    v_add_u32 v31, 0, v0
    v_mul_u32_u24 v32, 2731, v31
    v_lshrrev_b32 v32, 16, v32
    v_mul_u32_u24 v33, 24, v32
    v_sub_u32 v33, v31, v33
    v_lshlrev_b32 v33, 4, v33
    v_mul_u32_u24 v4, 36864, v32
    v_add_u32 v4, v4, v33
    v_mul_u32_u24 v16, 416, v32
    v_add_u32 v16, v16, v33
    v_add_u32 v31, 256, v0
    v_mul_u32_u24 v32, 2731, v31
    v_lshrrev_b32 v32, 16, v32
    v_mul_u32_u24 v33, 24, v32
    v_sub_u32 v33, v31, v33
    v_lshlrev_b32 v33, 4, v33
    v_mul_u32_u24 v5, 36864, v32
    v_add_u32 v5, v5, v33
    v_mul_u32_u24 v17, 416, v32
    v_add_u32 v17, v17, v33
    v_add_u32 v31, 512, v0
    v_mul_u32_u24 v32, 2731, v31
    v_lshrrev_b32 v32, 16, v32
    v_mul_u32_u24 v33, 24, v32
    v_sub_u32 v33, v31, v33
    v_lshlrev_b32 v33, 4, v33
    v_mul_u32_u24 v6, 36864, v32
    v_add_u32 v6, v6, v33
    v_mul_u32_u24 v18, 416, v32
    v_add_u32 v18, v18, v33
    v_mul_u32_u24 v28, 416, v1
    v_lshl_add_u32 v28, v2, 4, v28
    v_mul_u32_u24 v31, 80, v3
    v_add_u32 v31, v31, v1
    v_mul_u32_u24 v29, 384, v31
    v_lshl_add_u32 v29, v2, 4, v29
    s_mul_i32 s21, s18, 245760
    s_add_u32 s21, s21, 26214400
    v_lshlrev_b32 v30, 6, v31
    v_and_b32 v32, 1, v2
    v_lshl_add_u32 v30, v32, 5, v30
    v_lshrrev_b32 v32, 1, v2
    v_lshl_add_u32 v30, v32, 4, v30
    s_lshl_b32 s22, s16, 5
    s_add_u32 s22, s22, s18
    s_mul_i32 s22, s22, 40960
    s_add_u32 s22, s22, 115474432
    s_mul_i32 s23, s19, 122880
    s_add_u32 s21, s21, s23
    s_mul_i32 s23, s19, 20480
    s_add_u32 s22, s22, s23
    s_add_u32 s23, s21, 0
    buffer_load_dwordx4 v[88:91], v29, s[4:7], s23 offen offset:0
    buffer_load_dwordx4 v[92:95], v29, s[4:7], s23 offen offset:64
    buffer_load_dwordx4 v[96:99], v29, s[4:7], s23 offen offset:128
    buffer_load_dwordx4 v[100:103], v29, s[4:7], s23 offen offset:192
    buffer_load_dwordx4 v[104:107], v29, s[4:7], s23 offen offset:256
    buffer_load_dwordx4 v[108:111], v29, s[4:7], s23 offen offset:320
    s_add_u32 s23, s21, 6144
    buffer_load_dwordx4 v[112:115], v29, s[4:7], s23 offen offset:0
    buffer_load_dwordx4 v[116:119], v29, s[4:7], s23 offen offset:64
    buffer_load_dwordx4 v[120:123], v29, s[4:7], s23 offen offset:128
    buffer_load_dwordx4 v[124:127], v29, s[4:7], s23 offen offset:192
    buffer_load_dwordx4 v[128:131], v29, s[4:7], s23 offen offset:256
    buffer_load_dwordx4 v[132:135], v29, s[4:7], s23 offen offset:320
    s_add_u32 s23, s21, 12288
    buffer_load_dwordx4 v[136:139], v29, s[4:7], s23 offen offset:0
    buffer_load_dwordx4 v[140:143], v29, s[4:7], s23 offen offset:64
    buffer_load_dwordx4 v[144:147], v29, s[4:7], s23 offen offset:128
    buffer_load_dwordx4 v[148:151], v29, s[4:7], s23 offen offset:192
    buffer_load_dwordx4 v[152:155], v29, s[4:7], s23 offen offset:256
    buffer_load_dwordx4 v[156:159], v29, s[4:7], s23 offen offset:320
    s_add_u32 s23, s21, 18432
    buffer_load_dwordx4 v[160:163], v29, s[4:7], s23 offen offset:0
    buffer_load_dwordx4 v[164:167], v29, s[4:7], s23 offen offset:64
    buffer_load_dwordx4 v[168:171], v29, s[4:7], s23 offen offset:128
    buffer_load_dwordx4 v[172:175], v29, s[4:7], s23 offen offset:192
    buffer_load_dwordx4 v[176:179], v29, s[4:7], s23 offen offset:256
    buffer_load_dwordx4 v[180:183], v29, s[4:7], s23 offen offset:320
    s_add_u32 s23, s21, 24576
    buffer_load_dwordx4 v[184:187], v29, s[4:7], s23 offen offset:0
    buffer_load_dwordx4 v[188:191], v29, s[4:7], s23 offen offset:64
    buffer_load_dwordx4 v[192:195], v29, s[4:7], s23 offen offset:128
    buffer_load_dwordx4 v[196:199], v29, s[4:7], s23 offen offset:192
    buffer_load_dwordx4 v[200:203], v29, s[4:7], s23 offen offset:256
    buffer_load_dwordx4 v[204:207], v29, s[4:7], s23 offen offset:320
    s_mov_b32 s36, 0
wk_waitvs:
    buffer_load_dword v31, off, s[4:7], s66 sc1
    s_waitcnt vmcnt(0)
    v_readfirstlane_b32 s35, v31
    s_add_u32 s36, s36, 1
    s_cmp_ge_u32 s36, 262144
    s_cbranch_scc1 chain_done
    s_cmp_ge_u32 s35, 24
    s_cbranch_scc1 wk_waitvs_ok
    s_sleep 4
    s_branch wk_waitvs
wk_waitvs_ok:
    buffer_load_dwordx4 v[40:43], v4, s[4:7], s20 offen sc1
    buffer_load_dwordx4 v[44:47], v5, s[4:7], s20 offen sc1
    buffer_load_dwordx4 v[48:51], v6, s[4:7], s20 offen sc1
    s_waitcnt vmcnt(0)
    ds_write_b128 v16, v[40:43]
    ds_write_b128 v17, v[44:47]
    ds_write_b128 v18, v[48:51]
    s_waitcnt lgkmcnt(0)
    s_barrier
    v_accvgpr_write_b32 a0, 0
    v_accvgpr_write_b32 a1, 0
    v_accvgpr_write_b32 a2, 0
    v_accvgpr_write_b32 a3, 0
    v_accvgpr_write_b32 a4, 0
    v_accvgpr_write_b32 a5, 0
    v_accvgpr_write_b32 a6, 0
    v_accvgpr_write_b32 a7, 0
    v_accvgpr_write_b32 a8, 0
    v_accvgpr_write_b32 a9, 0
    v_accvgpr_write_b32 a10, 0
    v_accvgpr_write_b32 a11, 0
    v_accvgpr_write_b32 a12, 0
    v_accvgpr_write_b32 a13, 0
    v_accvgpr_write_b32 a14, 0
    v_accvgpr_write_b32 a15, 0
    v_accvgpr_write_b32 a16, 0
    v_accvgpr_write_b32 a17, 0
    v_accvgpr_write_b32 a18, 0
    v_accvgpr_write_b32 a19, 0
    v_accvgpr_write_b32 a20, 0
    v_accvgpr_write_b32 a21, 0
    v_accvgpr_write_b32 a22, 0
    v_accvgpr_write_b32 a23, 0
    v_accvgpr_write_b32 a24, 0
    v_accvgpr_write_b32 a25, 0
    v_accvgpr_write_b32 a26, 0
    v_accvgpr_write_b32 a27, 0
    v_accvgpr_write_b32 a28, 0
    v_accvgpr_write_b32 a29, 0
    v_accvgpr_write_b32 a30, 0
    v_accvgpr_write_b32 a31, 0
    v_accvgpr_write_b32 a32, 0
    v_accvgpr_write_b32 a33, 0
    v_accvgpr_write_b32 a34, 0
    v_accvgpr_write_b32 a35, 0
    v_accvgpr_write_b32 a36, 0
    v_accvgpr_write_b32 a37, 0
    v_accvgpr_write_b32 a38, 0
    v_accvgpr_write_b32 a39, 0
    s_waitcnt vmcnt(0)
    ds_read_b128 v[40:43], v28 offset:0
    ds_read_b128 v[44:47], v28 offset:6656
    s_waitcnt lgkmcnt(1)
    v_mfma_f32_16x16x32_bf16 a[0:3], v[40:43], v[88:91], a[0:3]
    v_mfma_f32_16x16x32_bf16 a[4:7], v[40:43], v[112:115], a[4:7]
    v_mfma_f32_16x16x32_bf16 a[8:11], v[40:43], v[136:139], a[8:11]
    v_mfma_f32_16x16x32_bf16 a[12:15], v[40:43], v[160:163], a[12:15]
    v_mfma_f32_16x16x32_bf16 a[16:19], v[40:43], v[184:187], a[16:19]
    s_waitcnt lgkmcnt(0)
    v_mfma_f32_16x16x32_bf16 a[20:23], v[44:47], v[88:91], a[20:23]
    v_mfma_f32_16x16x32_bf16 a[24:27], v[44:47], v[112:115], a[24:27]
    v_mfma_f32_16x16x32_bf16 a[28:31], v[44:47], v[136:139], a[28:31]
    v_mfma_f32_16x16x32_bf16 a[32:35], v[44:47], v[160:163], a[32:35]
    v_mfma_f32_16x16x32_bf16 a[36:39], v[44:47], v[184:187], a[36:39]
    ds_read_b128 v[40:43], v28 offset:64
    ds_read_b128 v[44:47], v28 offset:6720
    s_waitcnt lgkmcnt(1)
    v_mfma_f32_16x16x32_bf16 a[0:3], v[40:43], v[92:95], a[0:3]
    v_mfma_f32_16x16x32_bf16 a[4:7], v[40:43], v[116:119], a[4:7]
    v_mfma_f32_16x16x32_bf16 a[8:11], v[40:43], v[140:143], a[8:11]
    v_mfma_f32_16x16x32_bf16 a[12:15], v[40:43], v[164:167], a[12:15]
    v_mfma_f32_16x16x32_bf16 a[16:19], v[40:43], v[188:191], a[16:19]
    s_waitcnt lgkmcnt(0)
    v_mfma_f32_16x16x32_bf16 a[20:23], v[44:47], v[92:95], a[20:23]
    v_mfma_f32_16x16x32_bf16 a[24:27], v[44:47], v[116:119], a[24:27]
    v_mfma_f32_16x16x32_bf16 a[28:31], v[44:47], v[140:143], a[28:31]
    v_mfma_f32_16x16x32_bf16 a[32:35], v[44:47], v[164:167], a[32:35]
    v_mfma_f32_16x16x32_bf16 a[36:39], v[44:47], v[188:191], a[36:39]
    ds_read_b128 v[40:43], v28 offset:128
    ds_read_b128 v[44:47], v28 offset:6784
    s_waitcnt lgkmcnt(1)
    v_mfma_f32_16x16x32_bf16 a[0:3], v[40:43], v[96:99], a[0:3]
    v_mfma_f32_16x16x32_bf16 a[4:7], v[40:43], v[120:123], a[4:7]
    v_mfma_f32_16x16x32_bf16 a[8:11], v[40:43], v[144:147], a[8:11]
    v_mfma_f32_16x16x32_bf16 a[12:15], v[40:43], v[168:171], a[12:15]
    v_mfma_f32_16x16x32_bf16 a[16:19], v[40:43], v[192:195], a[16:19]
    s_waitcnt lgkmcnt(0)
    v_mfma_f32_16x16x32_bf16 a[20:23], v[44:47], v[96:99], a[20:23]
    v_mfma_f32_16x16x32_bf16 a[24:27], v[44:47], v[120:123], a[24:27]
    v_mfma_f32_16x16x32_bf16 a[28:31], v[44:47], v[144:147], a[28:31]
    v_mfma_f32_16x16x32_bf16 a[32:35], v[44:47], v[168:171], a[32:35]
    v_mfma_f32_16x16x32_bf16 a[36:39], v[44:47], v[192:195], a[36:39]
    ds_read_b128 v[40:43], v28 offset:192
    ds_read_b128 v[44:47], v28 offset:6848
    s_waitcnt lgkmcnt(1)
    v_mfma_f32_16x16x32_bf16 a[0:3], v[40:43], v[100:103], a[0:3]
    v_mfma_f32_16x16x32_bf16 a[4:7], v[40:43], v[124:127], a[4:7]
    v_mfma_f32_16x16x32_bf16 a[8:11], v[40:43], v[148:151], a[8:11]
    v_mfma_f32_16x16x32_bf16 a[12:15], v[40:43], v[172:175], a[12:15]
    v_mfma_f32_16x16x32_bf16 a[16:19], v[40:43], v[196:199], a[16:19]
    s_waitcnt lgkmcnt(0)
    v_mfma_f32_16x16x32_bf16 a[20:23], v[44:47], v[100:103], a[20:23]
    v_mfma_f32_16x16x32_bf16 a[24:27], v[44:47], v[124:127], a[24:27]
    v_mfma_f32_16x16x32_bf16 a[28:31], v[44:47], v[148:151], a[28:31]
    v_mfma_f32_16x16x32_bf16 a[32:35], v[44:47], v[172:175], a[32:35]
    v_mfma_f32_16x16x32_bf16 a[36:39], v[44:47], v[196:199], a[36:39]
    ds_read_b128 v[40:43], v28 offset:256
    ds_read_b128 v[44:47], v28 offset:6912
    s_waitcnt lgkmcnt(1)
    v_mfma_f32_16x16x32_bf16 a[0:3], v[40:43], v[104:107], a[0:3]
    v_mfma_f32_16x16x32_bf16 a[4:7], v[40:43], v[128:131], a[4:7]
    v_mfma_f32_16x16x32_bf16 a[8:11], v[40:43], v[152:155], a[8:11]
    v_mfma_f32_16x16x32_bf16 a[12:15], v[40:43], v[176:179], a[12:15]
    v_mfma_f32_16x16x32_bf16 a[16:19], v[40:43], v[200:203], a[16:19]
    s_waitcnt lgkmcnt(0)
    v_mfma_f32_16x16x32_bf16 a[20:23], v[44:47], v[104:107], a[20:23]
    v_mfma_f32_16x16x32_bf16 a[24:27], v[44:47], v[128:131], a[24:27]
    v_mfma_f32_16x16x32_bf16 a[28:31], v[44:47], v[152:155], a[28:31]
    v_mfma_f32_16x16x32_bf16 a[32:35], v[44:47], v[176:179], a[32:35]
    v_mfma_f32_16x16x32_bf16 a[36:39], v[44:47], v[200:203], a[36:39]
    ds_read_b128 v[40:43], v28 offset:320
    ds_read_b128 v[44:47], v28 offset:6976
    s_waitcnt lgkmcnt(1)
    v_mfma_f32_16x16x32_bf16 a[0:3], v[40:43], v[108:111], a[0:3]
    v_mfma_f32_16x16x32_bf16 a[4:7], v[40:43], v[132:135], a[4:7]
    v_mfma_f32_16x16x32_bf16 a[8:11], v[40:43], v[156:159], a[8:11]
    v_mfma_f32_16x16x32_bf16 a[12:15], v[40:43], v[180:183], a[12:15]
    v_mfma_f32_16x16x32_bf16 a[16:19], v[40:43], v[204:207], a[16:19]
    s_waitcnt lgkmcnt(0)
    v_mfma_f32_16x16x32_bf16 a[20:23], v[44:47], v[108:111], a[20:23]
    v_mfma_f32_16x16x32_bf16 a[24:27], v[44:47], v[132:135], a[24:27]
    v_mfma_f32_16x16x32_bf16 a[28:31], v[44:47], v[156:159], a[28:31]
    v_mfma_f32_16x16x32_bf16 a[32:35], v[44:47], v[180:183], a[32:35]
    v_mfma_f32_16x16x32_bf16 a[36:39], v[44:47], v[204:207], a[36:39]
    s_nop 7
    s_add_u32 s23, s22, 0
    v_accvgpr_read_b32 v76, a0
    v_accvgpr_read_b32 v80, a20
    v_accvgpr_read_b32 v77, a1
    v_accvgpr_read_b32 v81, a21
    v_accvgpr_read_b32 v78, a2
    v_accvgpr_read_b32 v82, a22
    v_accvgpr_read_b32 v79, a3
    v_accvgpr_read_b32 v83, a23
    v_cvt_pk_bf16_f32 v72, v76, v77
    v_cvt_pk_bf16_f32 v73, v78, v79
    v_cvt_pk_bf16_f32 v74, v80, v81
    v_cvt_pk_bf16_f32 v75, v82, v83
    s_nop 1
    v_permlane16_swap_b32 v72, v74
    v_permlane16_swap_b32 v73, v75
    s_nop 0
    s_add_u32 s24, s23, 0
    buffer_store_dwordx4 v[72:75], v30, s[4:7], s24 offen sc1
    v_accvgpr_read_b32 v76, a4
    v_accvgpr_read_b32 v80, a24
    v_accvgpr_read_b32 v77, a5
    v_accvgpr_read_b32 v81, a25
    v_accvgpr_read_b32 v78, a6
    v_accvgpr_read_b32 v82, a26
    v_accvgpr_read_b32 v79, a7
    v_accvgpr_read_b32 v83, a27
    v_cvt_pk_bf16_f32 v84, v76, v77
    v_cvt_pk_bf16_f32 v85, v78, v79
    v_cvt_pk_bf16_f32 v86, v80, v81
    v_cvt_pk_bf16_f32 v87, v82, v83
    s_nop 1
    v_permlane16_swap_b32 v84, v86
    v_permlane16_swap_b32 v85, v87
    s_nop 0
    s_add_u32 s24, s23, 1024
    buffer_store_dwordx4 v[84:87], v30, s[4:7], s24 offen sc1
    v_accvgpr_read_b32 v76, a8
    v_accvgpr_read_b32 v80, a28
    v_accvgpr_read_b32 v77, a9
    v_accvgpr_read_b32 v81, a29
    v_accvgpr_read_b32 v78, a10
    v_accvgpr_read_b32 v82, a30
    v_accvgpr_read_b32 v79, a11
    v_accvgpr_read_b32 v83, a31
    v_cvt_pk_bf16_f32 v72, v76, v77
    v_cvt_pk_bf16_f32 v73, v78, v79
    v_cvt_pk_bf16_f32 v74, v80, v81
    v_cvt_pk_bf16_f32 v75, v82, v83
    s_nop 1
    v_permlane16_swap_b32 v72, v74
    v_permlane16_swap_b32 v73, v75
    s_nop 0
    s_add_u32 s24, s23, 2048
    buffer_store_dwordx4 v[72:75], v30, s[4:7], s24 offen sc1
    v_accvgpr_read_b32 v76, a12
    v_accvgpr_read_b32 v80, a32
    v_accvgpr_read_b32 v77, a13
    v_accvgpr_read_b32 v81, a33
    v_accvgpr_read_b32 v78, a14
    v_accvgpr_read_b32 v82, a34
    v_accvgpr_read_b32 v79, a15
    v_accvgpr_read_b32 v83, a35
    v_cvt_pk_bf16_f32 v84, v76, v77
    v_cvt_pk_bf16_f32 v85, v78, v79
    v_cvt_pk_bf16_f32 v86, v80, v81
    v_cvt_pk_bf16_f32 v87, v82, v83
    s_nop 1
    v_permlane16_swap_b32 v84, v86
    v_permlane16_swap_b32 v85, v87
    s_nop 0
    s_add_u32 s24, s23, 3072
    buffer_store_dwordx4 v[84:87], v30, s[4:7], s24 offen sc1
    v_accvgpr_read_b32 v76, a16
    v_accvgpr_read_b32 v80, a36
    v_accvgpr_read_b32 v77, a17
    v_accvgpr_read_b32 v81, a37
    v_accvgpr_read_b32 v78, a18
    v_accvgpr_read_b32 v82, a38
    v_accvgpr_read_b32 v79, a19
    v_accvgpr_read_b32 v83, a39
    v_cvt_pk_bf16_f32 v72, v76, v77
    v_cvt_pk_bf16_f32 v73, v78, v79
    v_cvt_pk_bf16_f32 v74, v80, v81
    v_cvt_pk_bf16_f32 v75, v82, v83
    s_nop 1
    v_permlane16_swap_b32 v72, v74
    v_permlane16_swap_b32 v73, v75
    s_nop 0
    s_add_u32 s24, s23, 4096
    buffer_store_dwordx4 v[72:75], v30, s[4:7], s24 offen sc1
    s_branch wk_fin
wk_attnp:
    v_and_b32 v1, 15, v0
    v_bfe_u32 v2, v0, 4, 2
    v_lshrrev_b32 v3, 6, v0
    v_lshl_add_u32 v3, s17, 2, v3
    v_and_b32 v11, 63, v0
    v_xor_b32 v9, 16, v11
    v_lshlrev_b32 v9, 2, v9
    v_xor_b32 v10, 32, v11
    v_lshlrev_b32 v10, 2, v10
    v_lshl_add_u32 v11, s16, 5, v3
    v_lshl_add_u32 v12, v11, 3, v1
    v_mul_u32_u24 v12, 384, v12
    v_add_u32 v12, 224362496, v12
    v_lshl_add_u32 v12, v2, 4, v12
    v_mul_u32_u24 v13, 384, v3
    v_lshl_add_u32 v13, v2, 4, v13
    s_lshl_b32 s18, s16, 5
    v_add_u32 v14, -8, v1
    v_max_i32 v14, 0, v14
    v_min_i32 v14, 31, v14
    v_add_u32 v14, s18, v14
    v_mul_u32_u24 v14, 36864, v14
    v_add_u32 v14, v14, v13
    v_add_u32 v4, 39989248, v14
    v_add_u32 v14, 8, v1
    v_max_i32 v14, 0, v14
    v_min_i32 v14, 31, v14
    v_add_u32 v14, s18, v14
    v_mul_u32_u24 v14, 36864, v14
    v_add_u32 v14, v14, v13
    v_add_u32 v5, 39989248, v14
    v_add_u32 v14, 24, v1
    v_max_i32 v14, 0, v14
    v_min_i32 v14, 31, v14
    v_add_u32 v14, s18, v14
    v_mul_u32_u24 v14, 36864, v14
    v_add_u32 v14, v14, v13
    v_add_u32 v6, 39989248, v14
    v_cmp_gt_u32 vcc, 8, v1
    s_nop 1
    v_cndmask_b32 v4, v4, v12, vcc
    v_add_u32 v14, 0, v1
    v_add_u32 v14, s18, v14
    v_mul_u32_u24 v14, 36864, v14
    v_add_u32 v14, v14, v13
    v_add_u32 v7, 39976960, v14
    v_add_u32 v14, 16, v1
    v_add_u32 v14, s18, v14
    v_mul_u32_u24 v14, 36864, v14
    v_add_u32 v14, v14, v13
    v_add_u32 v8, 39976960, v14
    buffer_load_dwordx4 v[44:47], v5, s[4:7], 0 offen offset:0 sc1
    buffer_load_dwordx4 v[68:71], v6, s[4:7], 0 offen offset:0 sc1
    buffer_load_dwordx4 v[92:95], v7, s[4:7], 0 offen offset:0 sc1
    buffer_load_dwordx4 v[116:119], v8, s[4:7], 0 offen offset:0 sc1
    buffer_load_dwordx4 v[48:51], v5, s[4:7], 0 offen offset:64 sc1
    buffer_load_dwordx4 v[72:75], v6, s[4:7], 0 offen offset:64 sc1
    buffer_load_dwordx4 v[96:99], v7, s[4:7], 0 offen offset:64 sc1
    buffer_load_dwordx4 v[120:123], v8, s[4:7], 0 offen offset:64 sc1
    buffer_load_dwordx4 v[52:55], v5, s[4:7], 0 offen offset:128 sc1
    buffer_load_dwordx4 v[76:79], v6, s[4:7], 0 offen offset:128 sc1
    buffer_load_dwordx4 v[100:103], v7, s[4:7], 0 offen offset:128 sc1
    buffer_load_dwordx4 v[124:127], v8, s[4:7], 0 offen offset:128 sc1
    buffer_load_dwordx4 v[56:59], v5, s[4:7], 0 offen offset:192 sc1
    buffer_load_dwordx4 v[80:83], v6, s[4:7], 0 offen offset:192 sc1
    buffer_load_dwordx4 v[104:107], v7, s[4:7], 0 offen offset:192 sc1
    buffer_load_dwordx4 v[128:131], v8, s[4:7], 0 offen offset:192 sc1
    buffer_load_dwordx4 v[60:63], v5, s[4:7], 0 offen offset:256 sc1
    buffer_load_dwordx4 v[84:87], v6, s[4:7], 0 offen offset:256 sc1
    buffer_load_dwordx4 v[108:111], v7, s[4:7], 0 offen offset:256 sc1
    buffer_load_dwordx4 v[132:135], v8, s[4:7], 0 offen offset:256 sc1
    buffer_load_dwordx4 v[64:67], v5, s[4:7], 0 offen offset:320 sc1
    buffer_load_dwordx4 v[88:91], v6, s[4:7], 0 offen offset:320 sc1
    buffer_load_dwordx4 v[112:115], v7, s[4:7], 0 offen offset:320 sc1
    buffer_load_dwordx4 v[136:139], v8, s[4:7], 0 offen offset:320 sc1
    s_mov_b32 s36, 0
wk_wkm:
    buffer_load_dword v11, off, s[4:7], s66 sc1
    s_waitcnt vmcnt(0)
    v_readfirstlane_b32 s35, v11
    s_add_u32 s36, s36, 1
    s_cmp_ge_u32 s36, 262144
    s_cbranch_scc1 chain_done
    s_cmp_ge_u32 s35, 32
    s_cbranch_scc1 wk_wkm_ok
    s_sleep 16
    s_branch wk_wkm
wk_wkm_ok:
    buffer_load_dwordx4 v[20:23], v4, s[4:7], 0 offen offset:0 sc1
    buffer_load_dwordx4 v[24:27], v4, s[4:7], 0 offen offset:64 sc1
    buffer_load_dwordx4 v[28:31], v4, s[4:7], 0 offen offset:128 sc1
    buffer_load_dwordx4 v[32:35], v4, s[4:7], 0 offen offset:192 sc1
    buffer_load_dwordx4 v[36:39], v4, s[4:7], 0 offen offset:256 sc1
    buffer_load_dwordx4 v[40:43], v4, s[4:7], 0 offen offset:320 sc1
    v_mov_b32 v140, 0
    v_mov_b32 v141, 0
    v_mov_b32 v142, 0
    v_mov_b32 v143, 0
    v_mov_b32 v144, 0
    v_mov_b32 v145, 0
    v_mov_b32 v146, 0
    v_mov_b32 v147, 0
    v_mov_b32 v148, 0
    v_mov_b32 v149, 0
    v_mov_b32 v150, 0
    v_mov_b32 v151, 0
    v_mov_b32 v152, 0
    v_mov_b32 v153, 0
    v_mov_b32 v154, 0
    v_mov_b32 v155, 0
    v_mov_b32 v156, 0
    v_mov_b32 v157, 0
    v_mov_b32 v158, 0
    v_mov_b32 v159, 0
    v_mov_b32 v160, 0
    v_mov_b32 v161, 0
    v_mov_b32 v162, 0
    v_mov_b32 v163, 0
    s_waitcnt vmcnt(5)
    v_mfma_f32_16x16x32_bf16 v[140:143], v[20:23], v[92:95], v[140:143]
    v_mfma_f32_16x16x32_bf16 v[144:147], v[44:47], v[92:95], v[144:147]
    v_mfma_f32_16x16x32_bf16 v[148:151], v[68:71], v[92:95], v[148:151]
    v_mfma_f32_16x16x32_bf16 v[152:155], v[20:23], v[116:119], v[152:155]
    v_mfma_f32_16x16x32_bf16 v[156:159], v[44:47], v[116:119], v[156:159]
    v_mfma_f32_16x16x32_bf16 v[160:163], v[68:71], v[116:119], v[160:163]
    s_waitcnt vmcnt(4)
    v_mfma_f32_16x16x32_bf16 v[140:143], v[24:27], v[96:99], v[140:143]
    v_mfma_f32_16x16x32_bf16 v[144:147], v[48:51], v[96:99], v[144:147]
    v_mfma_f32_16x16x32_bf16 v[148:151], v[72:75], v[96:99], v[148:151]
    v_mfma_f32_16x16x32_bf16 v[152:155], v[24:27], v[120:123], v[152:155]
    v_mfma_f32_16x16x32_bf16 v[156:159], v[48:51], v[120:123], v[156:159]
    v_mfma_f32_16x16x32_bf16 v[160:163], v[72:75], v[120:123], v[160:163]
    s_waitcnt vmcnt(3)
    v_mfma_f32_16x16x32_bf16 v[140:143], v[28:31], v[100:103], v[140:143]
    v_mfma_f32_16x16x32_bf16 v[144:147], v[52:55], v[100:103], v[144:147]
    v_mfma_f32_16x16x32_bf16 v[148:151], v[76:79], v[100:103], v[148:151]
    v_mfma_f32_16x16x32_bf16 v[152:155], v[28:31], v[124:127], v[152:155]
    v_mfma_f32_16x16x32_bf16 v[156:159], v[52:55], v[124:127], v[156:159]
    v_mfma_f32_16x16x32_bf16 v[160:163], v[76:79], v[124:127], v[160:163]
    s_waitcnt vmcnt(2)
    v_mfma_f32_16x16x32_bf16 v[140:143], v[32:35], v[104:107], v[140:143]
    v_mfma_f32_16x16x32_bf16 v[144:147], v[56:59], v[104:107], v[144:147]
    v_mfma_f32_16x16x32_bf16 v[148:151], v[80:83], v[104:107], v[148:151]
    v_mfma_f32_16x16x32_bf16 v[152:155], v[32:35], v[128:131], v[152:155]
    v_mfma_f32_16x16x32_bf16 v[156:159], v[56:59], v[128:131], v[156:159]
    v_mfma_f32_16x16x32_bf16 v[160:163], v[80:83], v[128:131], v[160:163]
    s_waitcnt vmcnt(1)
    v_mfma_f32_16x16x32_bf16 v[140:143], v[36:39], v[108:111], v[140:143]
    v_mfma_f32_16x16x32_bf16 v[144:147], v[60:63], v[108:111], v[144:147]
    v_mfma_f32_16x16x32_bf16 v[148:151], v[84:87], v[108:111], v[148:151]
    v_mfma_f32_16x16x32_bf16 v[152:155], v[36:39], v[132:135], v[152:155]
    v_mfma_f32_16x16x32_bf16 v[156:159], v[60:63], v[132:135], v[156:159]
    v_mfma_f32_16x16x32_bf16 v[160:163], v[84:87], v[132:135], v[160:163]
    s_waitcnt vmcnt(0)
    v_mfma_f32_16x16x32_bf16 v[140:143], v[40:43], v[112:115], v[140:143]
    v_mfma_f32_16x16x32_bf16 v[144:147], v[64:67], v[112:115], v[144:147]
    v_mfma_f32_16x16x32_bf16 v[148:151], v[88:91], v[112:115], v[148:151]
    v_mfma_f32_16x16x32_bf16 v[152:155], v[40:43], v[136:139], v[152:155]
    v_mfma_f32_16x16x32_bf16 v[156:159], v[64:67], v[136:139], v[156:159]
    v_mfma_f32_16x16x32_bf16 v[160:163], v[88:91], v[136:139], v[160:163]
    s_nop 7
    v_lshlrev_b32 v15, 2, v2
    v_add_u32 v16, 0, v1
    v_sub_u32 v16, v16, v15
    v_cmp_le_i32 s[20:21], -8, v16
    v_cmp_le_i32 s[22:23], -7, v16
    v_cmp_le_i32 s[24:25], -6, v16
    v_cmp_le_i32 s[26:27], -5, v16
    v_cmp_le_i32 s[28:29], 8, v16
    v_cmp_le_i32 s[30:31], 9, v16
    v_cmp_le_i32 s[32:33], 10, v16
    v_cmp_le_i32 s[34:35], 11, v16
    v_cmp_le_i32 s[36:37], 24, v16
    v_cmp_gt_u32 vcc, 2, v2
    s_nop 1
    s_and_b64 s[36:37], s[36:37], vcc
    v_cmp_le_i32 s[38:39], 25, v16
    v_cmp_gt_u32 vcc, 2, v2
    s_nop 1
    s_and_b64 s[38:39], s[38:39], vcc
    v_cmp_le_i32 s[40:41], 26, v16
    v_cmp_gt_u32 vcc, 2, v2
    s_nop 1
    s_and_b64 s[40:41], s[40:41], vcc
    v_cmp_le_i32 s[42:43], 27, v16
    v_cmp_gt_u32 vcc, 2, v2
    s_nop 1
    s_and_b64 s[42:43], s[42:43], vcc
    s_nop 1
    v_cvt_pk_bf16_f32 v11, v140, v141
    v_cvt_pk_bf16_f32 v12, v142, v143
    v_lshlrev_b32 v140, 16, v11
    v_and_b32 v141, 0xffff0000, v11
    v_lshlrev_b32 v142, 16, v12
    v_and_b32 v143, 0xffff0000, v12
    v_mul_f32 v140, 0x3d93cd3a, v140
    v_mul_f32 v141, 0x3d93cd3a, v141
    v_mul_f32 v142, 0x3d93cd3a, v142
    v_mul_f32 v143, 0x3d93cd3a, v143
    v_cvt_pk_bf16_f32 v11, v140, v141
    v_cvt_pk_bf16_f32 v12, v142, v143
    v_lshlrev_b32 v140, 16, v11
    v_and_b32 v141, 0xffff0000, v11
    v_lshlrev_b32 v142, 16, v12
    v_and_b32 v143, 0xffff0000, v12
    v_cvt_pk_bf16_f32 v11, v144, v145
    v_cvt_pk_bf16_f32 v12, v146, v147
    v_lshlrev_b32 v144, 16, v11
    v_and_b32 v145, 0xffff0000, v11
    v_lshlrev_b32 v146, 16, v12
    v_and_b32 v147, 0xffff0000, v12
    v_mul_f32 v144, 0x3d93cd3a, v144
    v_mul_f32 v145, 0x3d93cd3a, v145
    v_mul_f32 v146, 0x3d93cd3a, v146
    v_mul_f32 v147, 0x3d93cd3a, v147
    v_cvt_pk_bf16_f32 v11, v144, v145
    v_cvt_pk_bf16_f32 v12, v146, v147
    v_lshlrev_b32 v144, 16, v11
    v_and_b32 v145, 0xffff0000, v11
    v_lshlrev_b32 v146, 16, v12
    v_and_b32 v147, 0xffff0000, v12
    v_cvt_pk_bf16_f32 v11, v148, v149
    v_cvt_pk_bf16_f32 v12, v150, v151
    v_lshlrev_b32 v148, 16, v11
    v_and_b32 v149, 0xffff0000, v11
    v_lshlrev_b32 v150, 16, v12
    v_and_b32 v151, 0xffff0000, v12
    v_mul_f32 v148, 0x3d93cd3a, v148
    v_mul_f32 v149, 0x3d93cd3a, v149
    v_mul_f32 v150, 0x3d93cd3a, v150
    v_mul_f32 v151, 0x3d93cd3a, v151
    v_cvt_pk_bf16_f32 v11, v148, v149
    v_cvt_pk_bf16_f32 v12, v150, v151
    v_lshlrev_b32 v148, 16, v11
    v_and_b32 v149, 0xffff0000, v11
    v_lshlrev_b32 v150, 16, v12
    v_and_b32 v151, 0xffff0000, v12
    v_mov_b32 v13, 0xce6e6b28
    v_cndmask_b32 v140, v13, v140, s[20:21]
    v_cndmask_b32 v141, v13, v141, s[22:23]
    v_cndmask_b32 v142, v13, v142, s[24:25]
    v_cndmask_b32 v143, v13, v143, s[26:27]
    v_cndmask_b32 v144, v13, v144, s[28:29]
    v_cndmask_b32 v145, v13, v145, s[30:31]
    v_cndmask_b32 v146, v13, v146, s[32:33]
    v_cndmask_b32 v147, v13, v147, s[34:35]
    v_cndmask_b32 v148, v13, v148, s[36:37]
    v_cndmask_b32 v149, v13, v149, s[38:39]
    v_cndmask_b32 v150, v13, v150, s[40:41]
    v_cndmask_b32 v151, v13, v151, s[42:43]
    v_max_f32 v11, v140, v141
    v_max_f32 v11, v11, v142
    v_max_f32 v11, v11, v143
    v_max_f32 v11, v11, v144
    v_max_f32 v11, v11, v145
    v_max_f32 v11, v11, v146
    v_max_f32 v11, v11, v147
    v_max_f32 v11, v11, v148
    v_max_f32 v11, v11, v149
    v_max_f32 v11, v11, v150
    v_max_f32 v11, v11, v151
    v_mov_b32 v12, v11
    s_nop 1
    v_permlane16_swap_b32 v11, v12
    s_nop 0
    v_max_f32 v11, v11, v12
    v_mov_b32 v12, v11
    s_nop 1
    v_permlane32_swap_b32 v11, v12
    s_nop 0
    v_max_f32 v11, v11, v12
    v_sub_f32 v140, v140, v11
    v_mul_f32 v140, 0x3fb8aa3b, v140
    v_sub_f32 v141, v141, v11
    v_mul_f32 v141, 0x3fb8aa3b, v141
    v_sub_f32 v142, v142, v11
    v_mul_f32 v142, 0x3fb8aa3b, v142
    v_sub_f32 v143, v143, v11
    v_mul_f32 v143, 0x3fb8aa3b, v143
    v_sub_f32 v144, v144, v11
    v_mul_f32 v144, 0x3fb8aa3b, v144
    v_sub_f32 v145, v145, v11
    v_mul_f32 v145, 0x3fb8aa3b, v145
    v_sub_f32 v146, v146, v11
    v_mul_f32 v146, 0x3fb8aa3b, v146
    v_sub_f32 v147, v147, v11
    v_mul_f32 v147, 0x3fb8aa3b, v147
    v_sub_f32 v148, v148, v11
    v_mul_f32 v148, 0x3fb8aa3b, v148
    v_sub_f32 v149, v149, v11
    v_mul_f32 v149, 0x3fb8aa3b, v149
    v_sub_f32 v150, v150, v11
    v_mul_f32 v150, 0x3fb8aa3b, v150
    v_sub_f32 v151, v151, v11
    v_mul_f32 v151, 0x3fb8aa3b, v151
    v_exp_f32 v140, v140
    v_exp_f32 v141, v141
    v_exp_f32 v142, v142
    v_exp_f32 v143, v143
    v_exp_f32 v144, v144
    v_exp_f32 v145, v145
    v_exp_f32 v146, v146
    v_exp_f32 v147, v147
    v_exp_f32 v148, v148
    v_exp_f32 v149, v149
    v_exp_f32 v150, v150
    v_exp_f32 v151, v151
    s_nop 0
    v_add_f32 v11, v140, v141
    v_add_f32 v11, v11, v142
    v_add_f32 v11, v11, v143
    v_add_f32 v11, v11, v144
    v_add_f32 v11, v11, v145
    v_add_f32 v11, v11, v146
    v_add_f32 v11, v11, v147
    v_add_f32 v11, v11, v148
    v_add_f32 v11, v11, v149
    v_add_f32 v11, v11, v150
    v_add_f32 v11, v11, v151
    v_mov_b32 v12, v11
    s_nop 1
    v_permlane16_swap_b32 v11, v12
    s_nop 0
    v_add_f32 v11, v11, v12
    v_mov_b32 v12, v11
    s_nop 1
    v_permlane32_swap_b32 v11, v12
    s_nop 0
    v_add_f32 v11, v11, v12
    v_rcp_f32 v11, v11
    s_nop 0
    v_mul_f32 v140, v140, v11
    v_mul_f32 v141, v141, v11
    v_mul_f32 v142, v142, v11
    v_mul_f32 v143, v143, v11
    v_mul_f32 v144, v144, v11
    v_mul_f32 v145, v145, v11
    v_mul_f32 v146, v146, v11
    v_mul_f32 v147, v147, v11
    v_mul_f32 v148, v148, v11
    v_mul_f32 v149, v149, v11
    v_mul_f32 v150, v150, v11
    v_mul_f32 v151, v151, v11
    v_add_u32 v16, 16, v1
    v_sub_u32 v16, v16, v15
    v_cmp_le_i32 s[20:21], -8, v16
    v_cmp_le_i32 s[22:23], -7, v16
    v_cmp_le_i32 s[24:25], -6, v16
    v_cmp_le_i32 s[26:27], -5, v16
    v_cmp_le_i32 s[28:29], 8, v16
    v_cmp_le_i32 s[30:31], 9, v16
    v_cmp_le_i32 s[32:33], 10, v16
    v_cmp_le_i32 s[34:35], 11, v16
    v_cmp_le_i32 s[36:37], 24, v16
    v_cmp_gt_u32 vcc, 2, v2
    s_nop 1
    s_and_b64 s[36:37], s[36:37], vcc
    v_cmp_le_i32 s[38:39], 25, v16
    v_cmp_gt_u32 vcc, 2, v2
    s_nop 1
    s_and_b64 s[38:39], s[38:39], vcc
    v_cmp_le_i32 s[40:41], 26, v16
    v_cmp_gt_u32 vcc, 2, v2
    s_nop 1
    s_and_b64 s[40:41], s[40:41], vcc
    v_cmp_le_i32 s[42:43], 27, v16
    v_cmp_gt_u32 vcc, 2, v2
    s_nop 1
    s_and_b64 s[42:43], s[42:43], vcc
    s_nop 1
    v_cvt_pk_bf16_f32 v11, v152, v153
    v_cvt_pk_bf16_f32 v12, v154, v155
    v_lshlrev_b32 v152, 16, v11
    v_and_b32 v153, 0xffff0000, v11
    v_lshlrev_b32 v154, 16, v12
    v_and_b32 v155, 0xffff0000, v12
    v_mul_f32 v152, 0x3d93cd3a, v152
    v_mul_f32 v153, 0x3d93cd3a, v153
    v_mul_f32 v154, 0x3d93cd3a, v154
    v_mul_f32 v155, 0x3d93cd3a, v155
    v_cvt_pk_bf16_f32 v11, v152, v153
    v_cvt_pk_bf16_f32 v12, v154, v155
    v_lshlrev_b32 v152, 16, v11
    v_and_b32 v153, 0xffff0000, v11
    v_lshlrev_b32 v154, 16, v12
    v_and_b32 v155, 0xffff0000, v12
    v_cvt_pk_bf16_f32 v11, v156, v157
    v_cvt_pk_bf16_f32 v12, v158, v159
    v_lshlrev_b32 v156, 16, v11
    v_and_b32 v157, 0xffff0000, v11
    v_lshlrev_b32 v158, 16, v12
    v_and_b32 v159, 0xffff0000, v12
    v_mul_f32 v156, 0x3d93cd3a, v156
    v_mul_f32 v157, 0x3d93cd3a, v157
    v_mul_f32 v158, 0x3d93cd3a, v158
    v_mul_f32 v159, 0x3d93cd3a, v159
    v_cvt_pk_bf16_f32 v11, v156, v157
    v_cvt_pk_bf16_f32 v12, v158, v159
    v_lshlrev_b32 v156, 16, v11
    v_and_b32 v157, 0xffff0000, v11
    v_lshlrev_b32 v158, 16, v12
    v_and_b32 v159, 0xffff0000, v12
    v_cvt_pk_bf16_f32 v11, v160, v161
    v_cvt_pk_bf16_f32 v12, v162, v163
    v_lshlrev_b32 v160, 16, v11
    v_and_b32 v161, 0xffff0000, v11
    v_lshlrev_b32 v162, 16, v12
    v_and_b32 v163, 0xffff0000, v12
    v_mul_f32 v160, 0x3d93cd3a, v160
    v_mul_f32 v161, 0x3d93cd3a, v161
    v_mul_f32 v162, 0x3d93cd3a, v162
    v_mul_f32 v163, 0x3d93cd3a, v163
    v_cvt_pk_bf16_f32 v11, v160, v161
    v_cvt_pk_bf16_f32 v12, v162, v163
    v_lshlrev_b32 v160, 16, v11
    v_and_b32 v161, 0xffff0000, v11
    v_lshlrev_b32 v162, 16, v12
    v_and_b32 v163, 0xffff0000, v12
    v_mov_b32 v13, 0xce6e6b28
    v_cndmask_b32 v152, v13, v152, s[20:21]
    v_cndmask_b32 v153, v13, v153, s[22:23]
    v_cndmask_b32 v154, v13, v154, s[24:25]
    v_cndmask_b32 v155, v13, v155, s[26:27]
    v_cndmask_b32 v156, v13, v156, s[28:29]
    v_cndmask_b32 v157, v13, v157, s[30:31]
    v_cndmask_b32 v158, v13, v158, s[32:33]
    v_cndmask_b32 v159, v13, v159, s[34:35]
    v_cndmask_b32 v160, v13, v160, s[36:37]
    v_cndmask_b32 v161, v13, v161, s[38:39]
    v_cndmask_b32 v162, v13, v162, s[40:41]
    v_cndmask_b32 v163, v13, v163, s[42:43]
    v_max_f32 v11, v152, v153
    v_max_f32 v11, v11, v154
    v_max_f32 v11, v11, v155
    v_max_f32 v11, v11, v156
    v_max_f32 v11, v11, v157
    v_max_f32 v11, v11, v158
    v_max_f32 v11, v11, v159
    v_max_f32 v11, v11, v160
    v_max_f32 v11, v11, v161
    v_max_f32 v11, v11, v162
    v_max_f32 v11, v11, v163
    v_mov_b32 v12, v11
    s_nop 1
    v_permlane16_swap_b32 v11, v12
    s_nop 0
    v_max_f32 v11, v11, v12
    v_mov_b32 v12, v11
    s_nop 1
    v_permlane32_swap_b32 v11, v12
    s_nop 0
    v_max_f32 v11, v11, v12
    v_sub_f32 v152, v152, v11
    v_mul_f32 v152, 0x3fb8aa3b, v152
    v_sub_f32 v153, v153, v11
    v_mul_f32 v153, 0x3fb8aa3b, v153
    v_sub_f32 v154, v154, v11
    v_mul_f32 v154, 0x3fb8aa3b, v154
    v_sub_f32 v155, v155, v11
    v_mul_f32 v155, 0x3fb8aa3b, v155
    v_sub_f32 v156, v156, v11
    v_mul_f32 v156, 0x3fb8aa3b, v156
    v_sub_f32 v157, v157, v11
    v_mul_f32 v157, 0x3fb8aa3b, v157
    v_sub_f32 v158, v158, v11
    v_mul_f32 v158, 0x3fb8aa3b, v158
    v_sub_f32 v159, v159, v11
    v_mul_f32 v159, 0x3fb8aa3b, v159
    v_sub_f32 v160, v160, v11
    v_mul_f32 v160, 0x3fb8aa3b, v160
    v_sub_f32 v161, v161, v11
    v_mul_f32 v161, 0x3fb8aa3b, v161
    v_sub_f32 v162, v162, v11
    v_mul_f32 v162, 0x3fb8aa3b, v162
    v_sub_f32 v163, v163, v11
    v_mul_f32 v163, 0x3fb8aa3b, v163
    v_exp_f32 v152, v152
    v_exp_f32 v153, v153
    v_exp_f32 v154, v154
    v_exp_f32 v155, v155
    v_exp_f32 v156, v156
    v_exp_f32 v157, v157
    v_exp_f32 v158, v158
    v_exp_f32 v159, v159
    v_exp_f32 v160, v160
    v_exp_f32 v161, v161
    v_exp_f32 v162, v162
    v_exp_f32 v163, v163
    s_nop 0
    v_add_f32 v11, v152, v153
    v_add_f32 v11, v11, v154
    v_add_f32 v11, v11, v155
    v_add_f32 v11, v11, v156
    v_add_f32 v11, v11, v157
    v_add_f32 v11, v11, v158
    v_add_f32 v11, v11, v159
    v_add_f32 v11, v11, v160
    v_add_f32 v11, v11, v161
    v_add_f32 v11, v11, v162
    v_add_f32 v11, v11, v163
    v_mov_b32 v12, v11
    s_nop 1
    v_permlane16_swap_b32 v11, v12
    s_nop 0
    v_add_f32 v11, v11, v12
    v_mov_b32 v12, v11
    s_nop 1
    v_permlane32_swap_b32 v11, v12
    s_nop 0
    v_add_f32 v11, v11, v12
    v_rcp_f32 v11, v11
    s_nop 0
    v_mul_f32 v152, v152, v11
    v_mul_f32 v153, v153, v11
    v_mul_f32 v154, v154, v11
    v_mul_f32 v155, v155, v11
    v_mul_f32 v156, v156, v11
    v_mul_f32 v157, v157, v11
    v_mul_f32 v158, v158, v11
    v_mul_f32 v159, v159, v11
    v_mul_f32 v160, v160, v11
    v_mul_f32 v161, v161, v11
    v_mul_f32 v162, v162, v11
    v_mul_f32 v163, v163, v11
    v_lshlrev_b32 v16, 6, v3
    v_lshl_add_u32 v16, v2, 3, v16
    v_add_u32 v16, 496, v16
    v_lshlrev_b32 v19, 4, v3
    v_lshl_add_u32 v19, v2, 3, v19
    v_cmp_gt_u32 vcc, 2, v2
    s_nop 1
    v_cndmask_b32 v19, v16, v19, vcc
    v_add_u32 v17, 0, v1
    v_add_u32 v17, s18, v17
    v_mul_u32_u24 v17, 2560, v17
    v_add_u32 v17, 230653952, v17
    v_add_u32 v18, v17, v19
    v_add_u32 v17, v17, v16
    v_cvt_pk_bf16_f32 v140, v140, v141
    v_cvt_pk_bf16_f32 v141, v142, v143
    buffer_store_dwordx2 v[140:141], v18, s[4:7], 0 offen sc1
    v_cvt_pk_bf16_f32 v144, v144, v145
    v_cvt_pk_bf16_f32 v145, v146, v147
    buffer_store_dwordx2 v[144:145], v17, s[4:7], 0 offen offset:32 sc1
    v_cvt_pk_bf16_f32 v148, v148, v149
    v_cvt_pk_bf16_f32 v149, v150, v151
    v_cmp_gt_u32 vcc, 2, v2
    s_and_saveexec_b64 s[20:21], vcc
    buffer_store_dwordx2 v[148:149], v17, s[4:7], 0 offen offset:64 sc1
    s_mov_b64 exec, s[20:21]
    v_add_u32 v17, 16, v1
    v_add_u32 v17, s18, v17
    v_mul_u32_u24 v17, 2560, v17
    v_add_u32 v17, 230653952, v17
    v_add_u32 v18, v17, v19
    v_add_u32 v17, v17, v16
    v_cvt_pk_bf16_f32 v152, v152, v153
    v_cvt_pk_bf16_f32 v153, v154, v155
    buffer_store_dwordx2 v[152:153], v18, s[4:7], 0 offen sc1
    v_cvt_pk_bf16_f32 v156, v156, v157
    v_cvt_pk_bf16_f32 v157, v158, v159
    buffer_store_dwordx2 v[156:157], v17, s[4:7], 0 offen offset:32 sc1
    v_cvt_pk_bf16_f32 v160, v160, v161
    v_cvt_pk_bf16_f32 v161, v162, v163
    v_cmp_gt_u32 vcc, 2, v2
    s_and_saveexec_b64 s[20:21], vcc
    buffer_store_dwordx2 v[160:161], v17, s[4:7], 0 offen offset:64 sc1
    s_mov_b64 exec, s[20:21]
    s_branch wk_fin
wk_attno:
    v_and_b32 v1, 15, v0
    v_bfe_u32 v2, v0, 4, 2
    s_lshl_b32 s18, s17, 5
    s_lshl_b32 s19, s17, 1
    s_mul_i32 s20, s16, 40
    s_add_u32 s19, s19, s20
    s_lshl_b32 s19, s19, 13
    s_add_u32 s19, s19, 203348224
    v_lshlrev_b32 v11, 8, v2
    v_lshl_add_u32 v4, v1, 4, v11
    v_lshlrev_b32 v11, 6, v1
    v_lshl_add_u32 v5, v2, 4, v11
    s_mul_i32 s25, s16, 1310720
    s_lshl_b32 s20, s18, 6
    s_add_u32 s25, s25, s20
    s_add_u32 s25, s25, 115474432
    s_mul_i32 s20, s16, 81920
    s_add_u32 s20, s20, 230653952
    v_mul_u32_u24 v9, 2560, v1
    v_lshl_add_u32 v9, v2, 4, v9
    v_add_u32 v10, 40960, v9
    v_mov_b32 v20, 0
    v_mov_b32 v21, 0
    v_mov_b32 v22, 0
    v_mov_b32 v23, 0
    v_mov_b32 v24, 0
    v_mov_b32 v25, 0
    v_mov_b32 v26, 0
    v_mov_b32 v27, 0
    v_mov_b32 v28, 0
    v_mov_b32 v29, 0
    v_mov_b32 v30, 0
    v_mov_b32 v31, 0
    v_mov_b32 v32, 0
    v_mov_b32 v33, 0
    v_mov_b32 v34, 0
    v_mov_b32 v35, 0
    s_cmp_lg_u32 s52, 0
    s_cbranch_scc1 wk_attno_v1
    s_add_u32 s21, s25, 0
    buffer_load_dwordx4 v[164:167], v5, s[4:7], s21 offen sc1
    buffer_load_dwordx4 v[168:171], v5, s[4:7], s21 offen offset:1024 sc1
    s_add_u32 s21, s25, 40960
    buffer_load_dwordx4 v[180:183], v5, s[4:7], s21 offen sc1
    buffer_load_dwordx4 v[184:187], v5, s[4:7], s21 offen offset:1024 sc1
    s_branch wk_attno_go0
wk_attno_v1:
    s_cmp_lg_u32 s52, 1
    s_cbranch_scc1 wk_attno_v2
    s_add_u32 s21, s25, 81920
    buffer_load_dwordx4 v[36:39], v5, s[4:7], s21 offen sc1
    buffer_load_dwordx4 v[40:43], v5, s[4:7], s21 offen offset:1024 sc1
    s_add_u32 s21, s25, 122880
    buffer_load_dwordx4 v[52:55], v5, s[4:7], s21 offen sc1
    buffer_load_dwordx4 v[56:59], v5, s[4:7], s21 offen offset:1024 sc1
    s_add_u32 s21, s25, 163840
    buffer_load_dwordx4 v[68:71], v5, s[4:7], s21 offen sc1
    buffer_load_dwordx4 v[72:75], v5, s[4:7], s21 offen offset:1024 sc1
    s_add_u32 s21, s25, 204800
    buffer_load_dwordx4 v[84:87], v5, s[4:7], s21 offen sc1
    buffer_load_dwordx4 v[88:91], v5, s[4:7], s21 offen offset:1024 sc1
    s_add_u32 s21, s25, 245760
    buffer_load_dwordx4 v[100:103], v5, s[4:7], s21 offen sc1
    buffer_load_dwordx4 v[104:107], v5, s[4:7], s21 offen offset:1024 sc1
    s_add_u32 s21, s25, 286720
    buffer_load_dwordx4 v[116:119], v5, s[4:7], s21 offen sc1
    buffer_load_dwordx4 v[120:123], v5, s[4:7], s21 offen offset:1024 sc1
    s_add_u32 s21, s25, 327680
    buffer_load_dwordx4 v[132:135], v5, s[4:7], s21 offen sc1
    buffer_load_dwordx4 v[136:139], v5, s[4:7], s21 offen offset:1024 sc1
    s_add_u32 s21, s25, 368640
    buffer_load_dwordx4 v[148:151], v5, s[4:7], s21 offen sc1
    buffer_load_dwordx4 v[152:155], v5, s[4:7], s21 offen offset:1024 sc1
    s_add_u32 s21, s25, 409600
    buffer_load_dwordx4 v[164:167], v5, s[4:7], s21 offen sc1
    buffer_load_dwordx4 v[168:171], v5, s[4:7], s21 offen offset:1024 sc1
    s_add_u32 s21, s25, 450560
    buffer_load_dwordx4 v[180:183], v5, s[4:7], s21 offen sc1
    buffer_load_dwordx4 v[184:187], v5, s[4:7], s21 offen offset:1024 sc1
    s_branch wk_attno_go0
wk_attno_v2:
    s_cmp_lg_u32 s52, 2
    s_cbranch_scc1 wk_attno_v3
    s_add_u32 s21, s25, 491520
    buffer_load_dwordx4 v[36:39], v5, s[4:7], s21 offen sc1
    buffer_load_dwordx4 v[40:43], v5, s[4:7], s21 offen offset:1024 sc1
    s_add_u32 s21, s25, 532480
    buffer_load_dwordx4 v[52:55], v5, s[4:7], s21 offen sc1
    buffer_load_dwordx4 v[56:59], v5, s[4:7], s21 offen offset:1024 sc1
    s_add_u32 s21, s25, 573440
    buffer_load_dwordx4 v[68:71], v5, s[4:7], s21 offen sc1
    buffer_load_dwordx4 v[72:75], v5, s[4:7], s21 offen offset:1024 sc1
    s_add_u32 s21, s25, 614400
    buffer_load_dwordx4 v[84:87], v5, s[4:7], s21 offen sc1
    buffer_load_dwordx4 v[88:91], v5, s[4:7], s21 offen offset:1024 sc1
    s_add_u32 s21, s25, 655360
    buffer_load_dwordx4 v[100:103], v5, s[4:7], s21 offen sc1
    buffer_load_dwordx4 v[104:107], v5, s[4:7], s21 offen offset:1024 sc1
    s_add_u32 s21, s25, 696320
    buffer_load_dwordx4 v[116:119], v5, s[4:7], s21 offen sc1
    buffer_load_dwordx4 v[120:123], v5, s[4:7], s21 offen offset:1024 sc1
    s_add_u32 s21, s25, 737280
    buffer_load_dwordx4 v[132:135], v5, s[4:7], s21 offen sc1
    buffer_load_dwordx4 v[136:139], v5, s[4:7], s21 offen offset:1024 sc1
    s_add_u32 s21, s25, 778240
    buffer_load_dwordx4 v[148:151], v5, s[4:7], s21 offen sc1
    buffer_load_dwordx4 v[152:155], v5, s[4:7], s21 offen offset:1024 sc1
    s_add_u32 s21, s25, 819200
    buffer_load_dwordx4 v[164:167], v5, s[4:7], s21 offen sc1
    buffer_load_dwordx4 v[168:171], v5, s[4:7], s21 offen offset:1024 sc1
    s_add_u32 s21, s25, 860160
    buffer_load_dwordx4 v[180:183], v5, s[4:7], s21 offen sc1
    buffer_load_dwordx4 v[184:187], v5, s[4:7], s21 offen offset:1024 sc1
    s_branch wk_attno_go0
wk_attno_v3:
    s_cmp_lg_u32 s52, 3
    s_cbranch_scc1 wk_attno_v4
    s_add_u32 s21, s25, 901120
    buffer_load_dwordx4 v[36:39], v5, s[4:7], s21 offen sc1
    buffer_load_dwordx4 v[40:43], v5, s[4:7], s21 offen offset:1024 sc1
    s_add_u32 s21, s25, 942080
    buffer_load_dwordx4 v[52:55], v5, s[4:7], s21 offen sc1
    buffer_load_dwordx4 v[56:59], v5, s[4:7], s21 offen offset:1024 sc1
    s_add_u32 s21, s25, 983040
    buffer_load_dwordx4 v[68:71], v5, s[4:7], s21 offen sc1
    buffer_load_dwordx4 v[72:75], v5, s[4:7], s21 offen offset:1024 sc1
    s_add_u32 s21, s25, 1024000
    buffer_load_dwordx4 v[84:87], v5, s[4:7], s21 offen sc1
    buffer_load_dwordx4 v[88:91], v5, s[4:7], s21 offen offset:1024 sc1
    s_add_u32 s21, s25, 1064960
    buffer_load_dwordx4 v[100:103], v5, s[4:7], s21 offen sc1
    buffer_load_dwordx4 v[104:107], v5, s[4:7], s21 offen offset:1024 sc1
    s_add_u32 s21, s25, 1105920
    buffer_load_dwordx4 v[116:119], v5, s[4:7], s21 offen sc1
    buffer_load_dwordx4 v[120:123], v5, s[4:7], s21 offen offset:1024 sc1
    s_add_u32 s21, s25, 1146880
    buffer_load_dwordx4 v[132:135], v5, s[4:7], s21 offen sc1
    buffer_load_dwordx4 v[136:139], v5, s[4:7], s21 offen offset:1024 sc1
    s_add_u32 s21, s25, 1187840
    buffer_load_dwordx4 v[148:151], v5, s[4:7], s21 offen sc1
    buffer_load_dwordx4 v[152:155], v5, s[4:7], s21 offen offset:1024 sc1
    s_add_u32 s21, s25, 1228800
    buffer_load_dwordx4 v[164:167], v5, s[4:7], s21 offen sc1
    buffer_load_dwordx4 v[168:171], v5, s[4:7], s21 offen offset:1024 sc1
    s_add_u32 s21, s25, 1269760
    buffer_load_dwordx4 v[180:183], v5, s[4:7], s21 offen sc1
    buffer_load_dwordx4 v[184:187], v5, s[4:7], s21 offen offset:1024 sc1
    s_branch wk_attno_go0
wk_attno_v4:
wk_attno_go0:
    s_mov_b32 s36, 0
wk_wp2:
    buffer_load_dword v11, off, s[4:7], s66 sc1
    s_waitcnt vmcnt(0)
    v_readfirstlane_b32 s35, v11
    s_add_u32 s36, s36, 1
    s_cmp_ge_u32 s36, 262144
    s_cbranch_scc1 chain_done
    s_cmp_ge_u32 s35, 8
    s_cbranch_scc1 wk_wp2_ok
    s_sleep 4
    s_branch wk_wp2
wk_wp2_ok:
    s_mov_b32 s36, 0
wk_wu2:
    buffer_load_dword v11, off, s[4:7], s67 sc1
    s_waitcnt vmcnt(0)
    v_readfirstlane_b32 s35, v11
    s_add_u32 s36, s36, 1
    s_cmp_ge_u32 s36, 262144
    s_cbranch_scc1 chain_done
    s_cmp_ge_u32 s35, 32
    s_cbranch_scc1 wk_wu2_ok
    s_sleep 4
    s_branch wk_wu2
wk_wu2_ok:
    s_cmp_lg_u32 s52, 0
    s_cbranch_scc1 wk_attno_w1
    s_add_u32 s21, s19, 0
    buffer_load_dwordx4 v[36:39], v4, s[4:7], s21 offen sc1
    s_add_u32 s21, s21, 8192
    buffer_load_dwordx4 v[40:43], v4, s[4:7], s21 offen sc1
    buffer_load_dwordx4 v[44:47], v9, s[4:7], s20 offen offset:0 sc1
    buffer_load_dwordx4 v[48:51], v10, s[4:7], s20 offen offset:0 sc1
    s_add_u32 s21, s19, 1024
    buffer_load_dwordx4 v[52:55], v4, s[4:7], s21 offen sc1
    s_add_u32 s21, s21, 8192
    buffer_load_dwordx4 v[56:59], v4, s[4:7], s21 offen sc1
    buffer_load_dwordx4 v[60:63], v9, s[4:7], s20 offen offset:64 sc1
    buffer_load_dwordx4 v[64:67], v10, s[4:7], s20 offen offset:64 sc1
    s_add_u32 s21, s19, 2048
    buffer_load_dwordx4 v[68:71], v4, s[4:7], s21 offen sc1
    s_add_u32 s21, s21, 8192
    buffer_load_dwordx4 v[72:75], v4, s[4:7], s21 offen sc1
    buffer_load_dwordx4 v[76:79], v9, s[4:7], s20 offen offset:128 sc1
    buffer_load_dwordx4 v[80:83], v10, s[4:7], s20 offen offset:128 sc1
    s_add_u32 s21, s19, 3072
    buffer_load_dwordx4 v[84:87], v4, s[4:7], s21 offen sc1
    s_add_u32 s21, s21, 8192
    buffer_load_dwordx4 v[88:91], v4, s[4:7], s21 offen sc1
    buffer_load_dwordx4 v[92:95], v9, s[4:7], s20 offen offset:192 sc1
    buffer_load_dwordx4 v[96:99], v10, s[4:7], s20 offen offset:192 sc1
    s_add_u32 s21, s19, 4096
    buffer_load_dwordx4 v[100:103], v4, s[4:7], s21 offen sc1
    s_add_u32 s21, s21, 8192
    buffer_load_dwordx4 v[104:107], v4, s[4:7], s21 offen sc1
    buffer_load_dwordx4 v[108:111], v9, s[4:7], s20 offen offset:256 sc1
    buffer_load_dwordx4 v[112:115], v10, s[4:7], s20 offen offset:256 sc1
    s_add_u32 s21, s19, 5120
    buffer_load_dwordx4 v[116:119], v4, s[4:7], s21 offen sc1
    s_add_u32 s21, s21, 8192
    buffer_load_dwordx4 v[120:123], v4, s[4:7], s21 offen sc1
    buffer_load_dwordx4 v[124:127], v9, s[4:7], s20 offen offset:320 sc1
    buffer_load_dwordx4 v[128:131], v10, s[4:7], s20 offen offset:320 sc1
    s_add_u32 s21, s19, 6144
    buffer_load_dwordx4 v[132:135], v4, s[4:7], s21 offen sc1
    s_add_u32 s21, s21, 8192
    buffer_load_dwordx4 v[136:139], v4, s[4:7], s21 offen sc1
    buffer_load_dwordx4 v[140:143], v9, s[4:7], s20 offen offset:384 sc1
    buffer_load_dwordx4 v[144:147], v10, s[4:7], s20 offen offset:384 sc1
    s_add_u32 s21, s19, 7168
    buffer_load_dwordx4 v[148:151], v4, s[4:7], s21 offen sc1
    s_add_u32 s21, s21, 8192
    buffer_load_dwordx4 v[152:155], v4, s[4:7], s21 offen sc1
    buffer_load_dwordx4 v[156:159], v9, s[4:7], s20 offen offset:448 sc1
    buffer_load_dwordx4 v[160:163], v10, s[4:7], s20 offen offset:448 sc1
    buffer_load_dwordx4 v[172:175], v9, s[4:7], s20 offen offset:512 sc1
    buffer_load_dwordx4 v[176:179], v10, s[4:7], s20 offen offset:512 sc1
    buffer_load_dwordx4 v[188:191], v9, s[4:7], s20 offen offset:576 sc1
    buffer_load_dwordx4 v[192:195], v10, s[4:7], s20 offen offset:576 sc1
    s_branch wk_attno_go
wk_attno_w1:
    s_cmp_lg_u32 s52, 1
    s_cbranch_scc1 wk_attno_w2
    buffer_load_dwordx4 v[44:47], v9, s[4:7], s20 offen offset:640 sc1
    buffer_load_dwordx4 v[48:51], v10, s[4:7], s20 offen offset:640 sc1
    buffer_load_dwordx4 v[60:63], v9, s[4:7], s20 offen offset:704 sc1
    buffer_load_dwordx4 v[64:67], v10, s[4:7], s20 offen offset:704 sc1
    buffer_load_dwordx4 v[76:79], v9, s[4:7], s20 offen offset:768 sc1
    buffer_load_dwordx4 v[80:83], v10, s[4:7], s20 offen offset:768 sc1
    buffer_load_dwordx4 v[92:95], v9, s[4:7], s20 offen offset:832 sc1
    buffer_load_dwordx4 v[96:99], v10, s[4:7], s20 offen offset:832 sc1
    buffer_load_dwordx4 v[108:111], v9, s[4:7], s20 offen offset:896 sc1
    buffer_load_dwordx4 v[112:115], v10, s[4:7], s20 offen offset:896 sc1
    buffer_load_dwordx4 v[124:127], v9, s[4:7], s20 offen offset:960 sc1
    buffer_load_dwordx4 v[128:131], v10, s[4:7], s20 offen offset:960 sc1
    buffer_load_dwordx4 v[140:143], v9, s[4:7], s20 offen offset:1024 sc1
    buffer_load_dwordx4 v[144:147], v10, s[4:7], s20 offen offset:1024 sc1
    buffer_load_dwordx4 v[156:159], v9, s[4:7], s20 offen offset:1088 sc1
    buffer_load_dwordx4 v[160:163], v10, s[4:7], s20 offen offset:1088 sc1
    buffer_load_dwordx4 v[172:175], v9, s[4:7], s20 offen offset:1152 sc1
    buffer_load_dwordx4 v[176:179], v10, s[4:7], s20 offen offset:1152 sc1
    buffer_load_dwordx4 v[188:191], v9, s[4:7], s20 offen offset:1216 sc1
    buffer_load_dwordx4 v[192:195], v10, s[4:7], s20 offen offset:1216 sc1
    s_branch wk_attno_go
wk_attno_w2:
    s_cmp_lg_u32 s52, 2
    s_cbranch_scc1 wk_attno_w3
    buffer_load_dwordx4 v[44:47], v9, s[4:7], s20 offen offset:1280 sc1
    buffer_load_dwordx4 v[48:51], v10, s[4:7], s20 offen offset:1280 sc1
    buffer_load_dwordx4 v[60:63], v9, s[4:7], s20 offen offset:1344 sc1
    buffer_load_dwordx4 v[64:67], v10, s[4:7], s20 offen offset:1344 sc1
    buffer_load_dwordx4 v[76:79], v9, s[4:7], s20 offen offset:1408 sc1
    buffer_load_dwordx4 v[80:83], v10, s[4:7], s20 offen offset:1408 sc1
    buffer_load_dwordx4 v[92:95], v9, s[4:7], s20 offen offset:1472 sc1
    buffer_load_dwordx4 v[96:99], v10, s[4:7], s20 offen offset:1472 sc1
    buffer_load_dwordx4 v[108:111], v9, s[4:7], s20 offen offset:1536 sc1
    buffer_load_dwordx4 v[112:115], v10, s[4:7], s20 offen offset:1536 sc1
    buffer_load_dwordx4 v[124:127], v9, s[4:7], s20 offen offset:1600 sc1
    buffer_load_dwordx4 v[128:131], v10, s[4:7], s20 offen offset:1600 sc1
    buffer_load_dwordx4 v[140:143], v9, s[4:7], s20 offen offset:1664 sc1
    buffer_load_dwordx4 v[144:147], v10, s[4:7], s20 offen offset:1664 sc1
    buffer_load_dwordx4 v[156:159], v9, s[4:7], s20 offen offset:1728 sc1
    buffer_load_dwordx4 v[160:163], v10, s[4:7], s20 offen offset:1728 sc1
    buffer_load_dwordx4 v[172:175], v9, s[4:7], s20 offen offset:1792 sc1
    buffer_load_dwordx4 v[176:179], v10, s[4:7], s20 offen offset:1792 sc1
    buffer_load_dwordx4 v[188:191], v9, s[4:7], s20 offen offset:1856 sc1
    buffer_load_dwordx4 v[192:195], v10, s[4:7], s20 offen offset:1856 sc1
    s_branch wk_attno_go
wk_attno_w3:
    s_cmp_lg_u32 s52, 3
    s_cbranch_scc1 wk_attno_w4
    buffer_load_dwordx4 v[44:47], v9, s[4:7], s20 offen offset:1920 sc1
    buffer_load_dwordx4 v[48:51], v10, s[4:7], s20 offen offset:1920 sc1
    buffer_load_dwordx4 v[60:63], v9, s[4:7], s20 offen offset:1984 sc1
    buffer_load_dwordx4 v[64:67], v10, s[4:7], s20 offen offset:1984 sc1
    buffer_load_dwordx4 v[76:79], v9, s[4:7], s20 offen offset:2048 sc1
    buffer_load_dwordx4 v[80:83], v10, s[4:7], s20 offen offset:2048 sc1
    buffer_load_dwordx4 v[92:95], v9, s[4:7], s20 offen offset:2112 sc1
    buffer_load_dwordx4 v[96:99], v10, s[4:7], s20 offen offset:2112 sc1
    buffer_load_dwordx4 v[108:111], v9, s[4:7], s20 offen offset:2176 sc1
    buffer_load_dwordx4 v[112:115], v10, s[4:7], s20 offen offset:2176 sc1
    buffer_load_dwordx4 v[124:127], v9, s[4:7], s20 offen offset:2240 sc1
    buffer_load_dwordx4 v[128:131], v10, s[4:7], s20 offen offset:2240 sc1
    buffer_load_dwordx4 v[140:143], v9, s[4:7], s20 offen offset:2304 sc1
    buffer_load_dwordx4 v[144:147], v10, s[4:7], s20 offen offset:2304 sc1
    buffer_load_dwordx4 v[156:159], v9, s[4:7], s20 offen offset:2368 sc1
    buffer_load_dwordx4 v[160:163], v10, s[4:7], s20 offen offset:2368 sc1
    buffer_load_dwordx4 v[172:175], v9, s[4:7], s20 offen offset:2432 sc1
    buffer_load_dwordx4 v[176:179], v10, s[4:7], s20 offen offset:2432 sc1
    buffer_load_dwordx4 v[188:191], v9, s[4:7], s20 offen offset:2496 sc1
    buffer_load_dwordx4 v[192:195], v10, s[4:7], s20 offen offset:2496 sc1
    s_branch wk_attno_go
wk_attno_w4:
wk_attno_go:
    s_waitcnt vmcnt(0)
    v_mfma_f32_16x16x32_bf16 v[20:23], v[36:39], v[44:47], v[20:23]
    v_mfma_f32_16x16x32_bf16 v[24:27], v[36:39], v[48:51], v[24:27]
    v_mfma_f32_16x16x32_bf16 v[28:31], v[40:43], v[44:47], v[28:31]
    v_mfma_f32_16x16x32_bf16 v[32:35], v[40:43], v[48:51], v[32:35]
    v_mfma_f32_16x16x32_bf16 v[20:23], v[52:55], v[60:63], v[20:23]
    v_mfma_f32_16x16x32_bf16 v[24:27], v[52:55], v[64:67], v[24:27]
    v_mfma_f32_16x16x32_bf16 v[28:31], v[56:59], v[60:63], v[28:31]
    v_mfma_f32_16x16x32_bf16 v[32:35], v[56:59], v[64:67], v[32:35]
    v_mfma_f32_16x16x32_bf16 v[20:23], v[68:71], v[76:79], v[20:23]
    v_mfma_f32_16x16x32_bf16 v[24:27], v[68:71], v[80:83], v[24:27]
    v_mfma_f32_16x16x32_bf16 v[28:31], v[72:75], v[76:79], v[28:31]
    v_mfma_f32_16x16x32_bf16 v[32:35], v[72:75], v[80:83], v[32:35]
    v_mfma_f32_16x16x32_bf16 v[20:23], v[84:87], v[92:95], v[20:23]
    v_mfma_f32_16x16x32_bf16 v[24:27], v[84:87], v[96:99], v[24:27]
    v_mfma_f32_16x16x32_bf16 v[28:31], v[88:91], v[92:95], v[28:31]
    v_mfma_f32_16x16x32_bf16 v[32:35], v[88:91], v[96:99], v[32:35]
    v_mfma_f32_16x16x32_bf16 v[20:23], v[100:103], v[108:111], v[20:23]
    v_mfma_f32_16x16x32_bf16 v[24:27], v[100:103], v[112:115], v[24:27]
    v_mfma_f32_16x16x32_bf16 v[28:31], v[104:107], v[108:111], v[28:31]
    v_mfma_f32_16x16x32_bf16 v[32:35], v[104:107], v[112:115], v[32:35]
    v_mfma_f32_16x16x32_bf16 v[20:23], v[116:119], v[124:127], v[20:23]
    v_mfma_f32_16x16x32_bf16 v[24:27], v[116:119], v[128:131], v[24:27]
    v_mfma_f32_16x16x32_bf16 v[28:31], v[120:123], v[124:127], v[28:31]
    v_mfma_f32_16x16x32_bf16 v[32:35], v[120:123], v[128:131], v[32:35]
    v_mfma_f32_16x16x32_bf16 v[20:23], v[132:135], v[140:143], v[20:23]
    v_mfma_f32_16x16x32_bf16 v[24:27], v[132:135], v[144:147], v[24:27]
    v_mfma_f32_16x16x32_bf16 v[28:31], v[136:139], v[140:143], v[28:31]
    v_mfma_f32_16x16x32_bf16 v[32:35], v[136:139], v[144:147], v[32:35]
    v_mfma_f32_16x16x32_bf16 v[20:23], v[148:151], v[156:159], v[20:23]
    v_mfma_f32_16x16x32_bf16 v[24:27], v[148:151], v[160:163], v[24:27]
    v_mfma_f32_16x16x32_bf16 v[28:31], v[152:155], v[156:159], v[28:31]
    v_mfma_f32_16x16x32_bf16 v[32:35], v[152:155], v[160:163], v[32:35]
    v_mfma_f32_16x16x32_bf16 v[20:23], v[164:167], v[172:175], v[20:23]
    v_mfma_f32_16x16x32_bf16 v[24:27], v[164:167], v[176:179], v[24:27]
    v_mfma_f32_16x16x32_bf16 v[28:31], v[168:171], v[172:175], v[28:31]
    v_mfma_f32_16x16x32_bf16 v[32:35], v[168:171], v[176:179], v[32:35]
    v_mfma_f32_16x16x32_bf16 v[20:23], v[180:183], v[188:191], v[20:23]
    v_mfma_f32_16x16x32_bf16 v[24:27], v[180:183], v[192:195], v[24:27]
    v_mfma_f32_16x16x32_bf16 v[28:31], v[184:187], v[188:191], v[28:31]
    v_mfma_f32_16x16x32_bf16 v[32:35], v[184:187], v[192:195], v[32:35]
    s_nop 7
    v_and_b32 v11, 63, v0
    v_lshlrev_b32 v11, 4, v11
    s_cmp_eq_u32 s52, 0
    s_cbranch_scc1 wk_attno_w0a
    s_sub_u32 s21, s52, 1
    s_lshl_b32 s21, s21, 12
    v_add_u32 v12, s21, v11
    ds_write_b128 v12, v[20:23] offset:0
    ds_write_b128 v12, v[24:27] offset:1024
    ds_write_b128 v12, v[28:31] offset:2048
    ds_write_b128 v12, v[32:35] offset:3072
    s_waitcnt lgkmcnt(0)
wk_attno_w0a:
    s_barrier
    s_cmp_lg_u32 s52, 0
    s_cbranch_scc1 wk_fin
    ds_read_b128 v[36:39], v11 offset:0
    ds_read_b128 v[40:43], v11 offset:1024
    ds_read_b128 v[44:47], v11 offset:2048
    ds_read_b128 v[48:51], v11 offset:3072
    ds_read_b128 v[52:55], v11 offset:4096
    ds_read_b128 v[56:59], v11 offset:5120
    ds_read_b128 v[60:63], v11 offset:6144
    ds_read_b128 v[64:67], v11 offset:7168
    ds_read_b128 v[68:71], v11 offset:8192
    ds_read_b128 v[72:75], v11 offset:9216
    ds_read_b128 v[76:79], v11 offset:10240
    ds_read_b128 v[80:83], v11 offset:11264
    s_waitcnt lgkmcnt(0)
    v_add_f32 v20, v20, v36
    v_add_f32 v21, v21, v37
    v_add_f32 v22, v22, v38
    v_add_f32 v23, v23, v39
    v_add_f32 v24, v24, v40
    v_add_f32 v25, v25, v41
    v_add_f32 v26, v26, v42
    v_add_f32 v27, v27, v43
    v_add_f32 v28, v28, v44
    v_add_f32 v29, v29, v45
    v_add_f32 v30, v30, v46
    v_add_f32 v31, v31, v47
    v_add_f32 v32, v32, v48
    v_add_f32 v33, v33, v49
    v_add_f32 v34, v34, v50
    v_add_f32 v35, v35, v51
    v_add_f32 v20, v20, v52
    v_add_f32 v21, v21, v53
    v_add_f32 v22, v22, v54
    v_add_f32 v23, v23, v55
    v_add_f32 v24, v24, v56
    v_add_f32 v25, v25, v57
    v_add_f32 v26, v26, v58
    v_add_f32 v27, v27, v59
    v_add_f32 v28, v28, v60
    v_add_f32 v29, v29, v61
    v_add_f32 v30, v30, v62
    v_add_f32 v31, v31, v63
    v_add_f32 v32, v32, v64
    v_add_f32 v33, v33, v65
    v_add_f32 v34, v34, v66
    v_add_f32 v35, v35, v67
    v_add_f32 v20, v20, v68
    v_add_f32 v21, v21, v69
    v_add_f32 v22, v22, v70
    v_add_f32 v23, v23, v71
    v_add_f32 v24, v24, v72
    v_add_f32 v25, v25, v73
    v_add_f32 v26, v26, v74
    v_add_f32 v27, v27, v75
    v_add_f32 v28, v28, v76
    v_add_f32 v29, v29, v77
    v_add_f32 v30, v30, v78
    v_add_f32 v31, v31, v79
    v_add_f32 v32, v32, v80
    v_add_f32 v33, v33, v81
    v_add_f32 v34, v34, v82
    v_add_f32 v35, v35, v83
    s_lshl_b32 s21, s16, 5
    v_add_u32 v11, s21, v1
    v_mul_u32_u24 v11, 1280, v11
    v_lshlrev_b32 v12, 2, v2
    v_add_u32 v12, s18, v12
    v_lshl_add_u32 v11, v12, 1, v11
    s_mov_b32 s22, 235896832
    s_mov_b32 s23, 20480
    s_add_u32 s24, s22, s23
    buffer_load_dwordx2 v[100:101], v11, s[8:11], 0 offen offset:0
    buffer_load_dwordx2 v[102:103], v11, s[8:11], s23 offen offset:0
    buffer_load_dwordx2 v[104:105], v11, s[8:11], 0 offen offset:32
    buffer_load_dwordx2 v[106:107], v11, s[8:11], s23 offen offset:32
    s_waitcnt vmcnt(0)
    v_cvt_pk_bf16_f32 v108, v20, v21
    v_cvt_pk_bf16_f32 v109, v22, v23
    v_lshlrev_b32 v110, 16, v108
    v_lshlrev_b32 v114, 16, v100
    v_add_f32 v110, v110, v114
    v_and_b32 v111, 0xffff0000, v108
    v_and_b32 v115, 0xffff0000, v100
    v_add_f32 v111, v111, v115
    v_lshlrev_b32 v112, 16, v109
    v_lshlrev_b32 v116, 16, v101
    v_add_f32 v112, v112, v116
    v_and_b32 v113, 0xffff0000, v109
    v_and_b32 v117, 0xffff0000, v101
    v_add_f32 v113, v113, v117
    v_cvt_pk_bf16_f32 v20, v110, v111
    v_cvt_pk_bf16_f32 v21, v112, v113
    buffer_store_dwordx2 v[20:21], v11, s[4:7], s22 offen offset:0 sc1
    v_cvt_pk_bf16_f32 v108, v24, v25
    v_cvt_pk_bf16_f32 v109, v26, v27
    v_lshlrev_b32 v110, 16, v108
    v_lshlrev_b32 v114, 16, v102
    v_add_f32 v110, v110, v114
    v_and_b32 v111, 0xffff0000, v108
    v_and_b32 v115, 0xffff0000, v102
    v_add_f32 v111, v111, v115
    v_lshlrev_b32 v112, 16, v109
    v_lshlrev_b32 v116, 16, v103
    v_add_f32 v112, v112, v116
    v_and_b32 v113, 0xffff0000, v109
    v_and_b32 v117, 0xffff0000, v103
    v_add_f32 v113, v113, v117
    v_cvt_pk_bf16_f32 v24, v110, v111
    v_cvt_pk_bf16_f32 v25, v112, v113
    buffer_store_dwordx2 v[24:25], v11, s[4:7], s24 offen offset:0 sc1
    v_cvt_pk_bf16_f32 v108, v28, v29
    v_cvt_pk_bf16_f32 v109, v30, v31
    v_lshlrev_b32 v110, 16, v108
    v_lshlrev_b32 v114, 16, v104
    v_add_f32 v110, v110, v114
    v_and_b32 v111, 0xffff0000, v108
    v_and_b32 v115, 0xffff0000, v104
    v_add_f32 v111, v111, v115
    v_lshlrev_b32 v112, 16, v109
    v_lshlrev_b32 v116, 16, v105
    v_add_f32 v112, v112, v116
    v_and_b32 v113, 0xffff0000, v109
    v_and_b32 v117, 0xffff0000, v105
    v_add_f32 v113, v113, v117
    v_cvt_pk_bf16_f32 v28, v110, v111
    v_cvt_pk_bf16_f32 v29, v112, v113
    buffer_store_dwordx2 v[28:29], v11, s[4:7], s22 offen offset:32 sc1
    v_cvt_pk_bf16_f32 v108, v32, v33
    v_cvt_pk_bf16_f32 v109, v34, v35
    v_lshlrev_b32 v110, 16, v108
    v_lshlrev_b32 v114, 16, v106
    v_add_f32 v110, v110, v114
    v_and_b32 v111, 0xffff0000, v108
    v_and_b32 v115, 0xffff0000, v106
    v_add_f32 v111, v111, v115
    v_lshlrev_b32 v112, 16, v109
    v_lshlrev_b32 v116, 16, v107
    v_add_f32 v112, v112, v116
    v_and_b32 v113, 0xffff0000, v109
    v_and_b32 v117, 0xffff0000, v107
    v_add_f32 v113, v113, v117
    v_cvt_pk_bf16_f32 v32, v110, v111
    v_cvt_pk_bf16_f32 v33, v112, v113
    buffer_store_dwordx2 v[32:33], v11, s[4:7], s24 offen offset:32 sc1
    s_branch wk_fin
wk_attno_big:
    v_and_b32 v1, 15, v0
    v_bfe_u32 v2, v0, 4, 2
    v_lshrrev_b32 v3, 6, v0
    v_lshlrev_b32 v3, 5, v3
    s_lshl_b32 s18, s17, 7
    v_add_u32 v3, s18, v3
    v_lshrrev_b32 v11, 4, v3
    v_lshl_add_u32 v11, v11, 5, v2
    v_lshlrev_b32 v11, 8, v11
    v_lshl_add_u32 v4, v1, 4, v11
    s_mul_i32 s19, s16, 327680
    s_add_u32 s19, s19, 203348224
    v_add_u32 v11, v3, v1
    v_lshlrev_b32 v11, 6, v11
    v_lshl_add_u32 v5, v2, 4, v11
    s_mul_i32 s25, s16, 1310720
    s_add_u32 s25, s25, 115474432
    s_mul_i32 s20, s16, 81920
    s_add_u32 s20, s20, 230653952
    v_mul_u32_u24 v9, 2560, v1
    v_lshl_add_u32 v9, v2, 4, v9
    v_add_u32 v10, 40960, v9
    v_mov_b32 v20, 0
    v_mov_b32 v21, 0
    v_mov_b32 v22, 0
    v_mov_b32 v23, 0
    v_mov_b32 v24, 0
    v_mov_b32 v25, 0
    v_mov_b32 v26, 0
    v_mov_b32 v27, 0
    v_mov_b32 v28, 0
    v_mov_b32 v29, 0
    v_mov_b32 v30, 0
    v_mov_b32 v31, 0
    v_mov_b32 v32, 0
    v_mov_b32 v33, 0
    v_mov_b32 v34, 0
    v_mov_b32 v35, 0
    s_add_u32 s21, s19, 0
    buffer_load_dwordx4 v[36:39], v4, s[4:7], s21 offen sc1
    s_add_u32 s21, s21, 8192
    buffer_load_dwordx4 v[40:43], v4, s[4:7], s21 offen sc1
    buffer_load_dwordx4 v[44:47], v9, s[4:7], s20 offen offset:0 sc1
    buffer_load_dwordx4 v[48:51], v10, s[4:7], s20 offen offset:0 sc1
    s_add_u32 s21, s19, 1024
    buffer_load_dwordx4 v[52:55], v4, s[4:7], s21 offen sc1
    s_add_u32 s21, s21, 8192
    buffer_load_dwordx4 v[56:59], v4, s[4:7], s21 offen sc1
    buffer_load_dwordx4 v[60:63], v9, s[4:7], s20 offen offset:64 sc1
    buffer_load_dwordx4 v[64:67], v10, s[4:7], s20 offen offset:64 sc1
    s_add_u32 s21, s19, 2048
    buffer_load_dwordx4 v[68:71], v4, s[4:7], s21 offen sc1
    s_add_u32 s21, s21, 8192
    buffer_load_dwordx4 v[72:75], v4, s[4:7], s21 offen sc1
    buffer_load_dwordx4 v[76:79], v9, s[4:7], s20 offen offset:128 sc1
    buffer_load_dwordx4 v[80:83], v10, s[4:7], s20 offen offset:128 sc1
    s_add_u32 s21, s19, 3072
    buffer_load_dwordx4 v[84:87], v4, s[4:7], s21 offen sc1
    s_add_u32 s21, s21, 8192
    buffer_load_dwordx4 v[88:91], v4, s[4:7], s21 offen sc1
    buffer_load_dwordx4 v[92:95], v9, s[4:7], s20 offen offset:192 sc1
    buffer_load_dwordx4 v[96:99], v10, s[4:7], s20 offen offset:192 sc1
    s_add_u32 s21, s19, 4096
    buffer_load_dwordx4 v[100:103], v4, s[4:7], s21 offen sc1
    s_add_u32 s21, s21, 8192
    buffer_load_dwordx4 v[104:107], v4, s[4:7], s21 offen sc1
    buffer_load_dwordx4 v[108:111], v9, s[4:7], s20 offen offset:256 sc1
    buffer_load_dwordx4 v[112:115], v10, s[4:7], s20 offen offset:256 sc1
    s_add_u32 s21, s19, 5120
    buffer_load_dwordx4 v[116:119], v4, s[4:7], s21 offen sc1
    s_add_u32 s21, s21, 8192
    buffer_load_dwordx4 v[120:123], v4, s[4:7], s21 offen sc1
    buffer_load_dwordx4 v[124:127], v9, s[4:7], s20 offen offset:320 sc1
    buffer_load_dwordx4 v[128:131], v10, s[4:7], s20 offen offset:320 sc1
    s_add_u32 s21, s19, 6144
    buffer_load_dwordx4 v[132:135], v4, s[4:7], s21 offen sc1
    s_add_u32 s21, s21, 8192
    buffer_load_dwordx4 v[136:139], v4, s[4:7], s21 offen sc1
    buffer_load_dwordx4 v[140:143], v9, s[4:7], s20 offen offset:384 sc1
    buffer_load_dwordx4 v[144:147], v10, s[4:7], s20 offen offset:384 sc1
    s_add_u32 s21, s19, 7168
    buffer_load_dwordx4 v[148:151], v4, s[4:7], s21 offen sc1
    s_add_u32 s21, s21, 8192
    buffer_load_dwordx4 v[152:155], v4, s[4:7], s21 offen sc1
    buffer_load_dwordx4 v[156:159], v9, s[4:7], s20 offen offset:448 sc1
    buffer_load_dwordx4 v[160:163], v10, s[4:7], s20 offen offset:448 sc1
    s_waitcnt vmcnt(28)
    v_mfma_f32_16x16x32_bf16 v[20:23], v[36:39], v[44:47], v[20:23]
    v_mfma_f32_16x16x32_bf16 v[24:27], v[36:39], v[48:51], v[24:27]
    v_mfma_f32_16x16x32_bf16 v[28:31], v[40:43], v[44:47], v[28:31]
    v_mfma_f32_16x16x32_bf16 v[32:35], v[40:43], v[48:51], v[32:35]
    s_add_u32 s21, s25, 0
    buffer_load_dwordx4 v[36:39], v5, s[4:7], s21 offen sc1
    buffer_load_dwordx4 v[40:43], v5, s[4:7], s21 offen offset:1024 sc1
    buffer_load_dwordx4 v[44:47], v9, s[4:7], s20 offen offset:512 sc1
    buffer_load_dwordx4 v[48:51], v10, s[4:7], s20 offen offset:512 sc1
    s_waitcnt vmcnt(28)
    v_mfma_f32_16x16x32_bf16 v[20:23], v[52:55], v[60:63], v[20:23]
    v_mfma_f32_16x16x32_bf16 v[24:27], v[52:55], v[64:67], v[24:27]
    v_mfma_f32_16x16x32_bf16 v[28:31], v[56:59], v[60:63], v[28:31]
    v_mfma_f32_16x16x32_bf16 v[32:35], v[56:59], v[64:67], v[32:35]
    s_add_u32 s21, s25, 40960
    buffer_load_dwordx4 v[52:55], v5, s[4:7], s21 offen sc1
    buffer_load_dwordx4 v[56:59], v5, s[4:7], s21 offen offset:1024 sc1
    buffer_load_dwordx4 v[60:63], v9, s[4:7], s20 offen offset:576 sc1
    buffer_load_dwordx4 v[64:67], v10, s[4:7], s20 offen offset:576 sc1
    s_waitcnt vmcnt(28)
    v_mfma_f32_16x16x32_bf16 v[20:23], v[68:71], v[76:79], v[20:23]
    v_mfma_f32_16x16x32_bf16 v[24:27], v[68:71], v[80:83], v[24:27]
    v_mfma_f32_16x16x32_bf16 v[28:31], v[72:75], v[76:79], v[28:31]
    v_mfma_f32_16x16x32_bf16 v[32:35], v[72:75], v[80:83], v[32:35]
    s_add_u32 s21, s25, 81920
    buffer_load_dwordx4 v[68:71], v5, s[4:7], s21 offen sc1
    buffer_load_dwordx4 v[72:75], v5, s[4:7], s21 offen offset:1024 sc1
    buffer_load_dwordx4 v[76:79], v9, s[4:7], s20 offen offset:640 sc1
    buffer_load_dwordx4 v[80:83], v10, s[4:7], s20 offen offset:640 sc1
    s_waitcnt vmcnt(28)
    v_mfma_f32_16x16x32_bf16 v[20:23], v[84:87], v[92:95], v[20:23]
    v_mfma_f32_16x16x32_bf16 v[24:27], v[84:87], v[96:99], v[24:27]
    v_mfma_f32_16x16x32_bf16 v[28:31], v[88:91], v[92:95], v[28:31]
    v_mfma_f32_16x16x32_bf16 v[32:35], v[88:91], v[96:99], v[32:35]
    s_add_u32 s21, s25, 122880
    buffer_load_dwordx4 v[84:87], v5, s[4:7], s21 offen sc1
    buffer_load_dwordx4 v[88:91], v5, s[4:7], s21 offen offset:1024 sc1
    buffer_load_dwordx4 v[92:95], v9, s[4:7], s20 offen offset:704 sc1
    buffer_load_dwordx4 v[96:99], v10, s[4:7], s20 offen offset:704 sc1
    s_waitcnt vmcnt(28)
    v_mfma_f32_16x16x32_bf16 v[20:23], v[100:103], v[108:111], v[20:23]
    v_mfma_f32_16x16x32_bf16 v[24:27], v[100:103], v[112:115], v[24:27]
    v_mfma_f32_16x16x32_bf16 v[28:31], v[104:107], v[108:111], v[28:31]
    v_mfma_f32_16x16x32_bf16 v[32:35], v[104:107], v[112:115], v[32:35]
    s_add_u32 s21, s25, 163840
    buffer_load_dwordx4 v[100:103], v5, s[4:7], s21 offen sc1
    buffer_load_dwordx4 v[104:107], v5, s[4:7], s21 offen offset:1024 sc1
    buffer_load_dwordx4 v[108:111], v9, s[4:7], s20 offen offset:768 sc1
    buffer_load_dwordx4 v[112:115], v10, s[4:7], s20 offen offset:768 sc1
    s_waitcnt vmcnt(28)
    v_mfma_f32_16x16x32_bf16 v[20:23], v[116:119], v[124:127], v[20:23]
    v_mfma_f32_16x16x32_bf16 v[24:27], v[116:119], v[128:131], v[24:27]
    v_mfma_f32_16x16x32_bf16 v[28:31], v[120:123], v[124:127], v[28:31]
    v_mfma_f32_16x16x32_bf16 v[32:35], v[120:123], v[128:131], v[32:35]
    s_add_u32 s21, s25, 204800
    buffer_load_dwordx4 v[116:119], v5, s[4:7], s21 offen sc1
    buffer_load_dwordx4 v[120:123], v5, s[4:7], s21 offen offset:1024 sc1
    buffer_load_dwordx4 v[124:127], v9, s[4:7], s20 offen offset:832 sc1
    buffer_load_dwordx4 v[128:131], v10, s[4:7], s20 offen offset:832 sc1
    s_waitcnt vmcnt(28)
    v_mfma_f32_16x16x32_bf16 v[20:23], v[132:135], v[140:143], v[20:23]
    v_mfma_f32_16x16x32_bf16 v[24:27], v[132:135], v[144:147], v[24:27]
    v_mfma_f32_16x16x32_bf16 v[28:31], v[136:139], v[140:143], v[28:31]
    v_mfma_f32_16x16x32_bf16 v[32:35], v[136:139], v[144:147], v[32:35]
    s_add_u32 s21, s25, 245760
    buffer_load_dwordx4 v[132:135], v5, s[4:7], s21 offen sc1
    buffer_load_dwordx4 v[136:139], v5, s[4:7], s21 offen offset:1024 sc1
    buffer_load_dwordx4 v[140:143], v9, s[4:7], s20 offen offset:896 sc1
    buffer_load_dwordx4 v[144:147], v10, s[4:7], s20 offen offset:896 sc1
    s_waitcnt vmcnt(28)
    v_mfma_f32_16x16x32_bf16 v[20:23], v[148:151], v[156:159], v[20:23]
    v_mfma_f32_16x16x32_bf16 v[24:27], v[148:151], v[160:163], v[24:27]
    v_mfma_f32_16x16x32_bf16 v[28:31], v[152:155], v[156:159], v[28:31]
    v_mfma_f32_16x16x32_bf16 v[32:35], v[152:155], v[160:163], v[32:35]
    s_add_u32 s21, s25, 286720
    buffer_load_dwordx4 v[148:151], v5, s[4:7], s21 offen sc1
    buffer_load_dwordx4 v[152:155], v5, s[4:7], s21 offen offset:1024 sc1
    buffer_load_dwordx4 v[156:159], v9, s[4:7], s20 offen offset:960 sc1
    buffer_load_dwordx4 v[160:163], v10, s[4:7], s20 offen offset:960 sc1
    s_waitcnt vmcnt(28)
    v_mfma_f32_16x16x32_bf16 v[20:23], v[36:39], v[44:47], v[20:23]
    v_mfma_f32_16x16x32_bf16 v[24:27], v[36:39], v[48:51], v[24:27]
    v_mfma_f32_16x16x32_bf16 v[28:31], v[40:43], v[44:47], v[28:31]
    v_mfma_f32_16x16x32_bf16 v[32:35], v[40:43], v[48:51], v[32:35]
    s_add_u32 s21, s25, 327680
    buffer_load_dwordx4 v[36:39], v5, s[4:7], s21 offen sc1
    buffer_load_dwordx4 v[40:43], v5, s[4:7], s21 offen offset:1024 sc1
    buffer_load_dwordx4 v[44:47], v9, s[4:7], s20 offen offset:1024 sc1
    buffer_load_dwordx4 v[48:51], v10, s[4:7], s20 offen offset:1024 sc1
    s_waitcnt vmcnt(28)
    v_mfma_f32_16x16x32_bf16 v[20:23], v[52:55], v[60:63], v[20:23]
    v_mfma_f32_16x16x32_bf16 v[24:27], v[52:55], v[64:67], v[24:27]
    v_mfma_f32_16x16x32_bf16 v[28:31], v[56:59], v[60:63], v[28:31]
    v_mfma_f32_16x16x32_bf16 v[32:35], v[56:59], v[64:67], v[32:35]
    s_add_u32 s21, s25, 368640
    buffer_load_dwordx4 v[52:55], v5, s[4:7], s21 offen sc1
    buffer_load_dwordx4 v[56:59], v5, s[4:7], s21 offen offset:1024 sc1
    buffer_load_dwordx4 v[60:63], v9, s[4:7], s20 offen offset:1088 sc1
    buffer_load_dwordx4 v[64:67], v10, s[4:7], s20 offen offset:1088 sc1
    s_waitcnt vmcnt(28)
    v_mfma_f32_16x16x32_bf16 v[20:23], v[68:71], v[76:79], v[20:23]
    v_mfma_f32_16x16x32_bf16 v[24:27], v[68:71], v[80:83], v[24:27]
    v_mfma_f32_16x16x32_bf16 v[28:31], v[72:75], v[76:79], v[28:31]
    v_mfma_f32_16x16x32_bf16 v[32:35], v[72:75], v[80:83], v[32:35]
    s_add_u32 s21, s25, 409600
    buffer_load_dwordx4 v[68:71], v5, s[4:7], s21 offen sc1
    buffer_load_dwordx4 v[72:75], v5, s[4:7], s21 offen offset:1024 sc1
    buffer_load_dwordx4 v[76:79], v9, s[4:7], s20 offen offset:1152 sc1
    buffer_load_dwordx4 v[80:83], v10, s[4:7], s20 offen offset:1152 sc1
    s_waitcnt vmcnt(28)
    v_mfma_f32_16x16x32_bf16 v[20:23], v[84:87], v[92:95], v[20:23]
    v_mfma_f32_16x16x32_bf16 v[24:27], v[84:87], v[96:99], v[24:27]
    v_mfma_f32_16x16x32_bf16 v[28:31], v[88:91], v[92:95], v[28:31]
    v_mfma_f32_16x16x32_bf16 v[32:35], v[88:91], v[96:99], v[32:35]
    s_add_u32 s21, s25, 450560
    buffer_load_dwordx4 v[84:87], v5, s[4:7], s21 offen sc1
    buffer_load_dwordx4 v[88:91], v5, s[4:7], s21 offen offset:1024 sc1
    buffer_load_dwordx4 v[92:95], v9, s[4:7], s20 offen offset:1216 sc1
    buffer_load_dwordx4 v[96:99], v10, s[4:7], s20 offen offset:1216 sc1
    s_waitcnt vmcnt(28)
    v_mfma_f32_16x16x32_bf16 v[20:23], v[100:103], v[108:111], v[20:23]
    v_mfma_f32_16x16x32_bf16 v[24:27], v[100:103], v[112:115], v[24:27]
    v_mfma_f32_16x16x32_bf16 v[28:31], v[104:107], v[108:111], v[28:31]
    v_mfma_f32_16x16x32_bf16 v[32:35], v[104:107], v[112:115], v[32:35]
    s_add_u32 s21, s25, 491520
    buffer_load_dwordx4 v[100:103], v5, s[4:7], s21 offen sc1
    buffer_load_dwordx4 v[104:107], v5, s[4:7], s21 offen offset:1024 sc1
    buffer_load_dwordx4 v[108:111], v9, s[4:7], s20 offen offset:1280 sc1
    buffer_load_dwordx4 v[112:115], v10, s[4:7], s20 offen offset:1280 sc1
    s_waitcnt vmcnt(28)
    v_mfma_f32_16x16x32_bf16 v[20:23], v[116:119], v[124:127], v[20:23]
    v_mfma_f32_16x16x32_bf16 v[24:27], v[116:119], v[128:131], v[24:27]
    v_mfma_f32_16x16x32_bf16 v[28:31], v[120:123], v[124:127], v[28:31]
    v_mfma_f32_16x16x32_bf16 v[32:35], v[120:123], v[128:131], v[32:35]
    s_add_u32 s21, s25, 532480
    buffer_load_dwordx4 v[116:119], v5, s[4:7], s21 offen sc1
    buffer_load_dwordx4 v[120:123], v5, s[4:7], s21 offen offset:1024 sc1
    buffer_load_dwordx4 v[124:127], v9, s[4:7], s20 offen offset:1344 sc1
    buffer_load_dwordx4 v[128:131], v10, s[4:7], s20 offen offset:1344 sc1
    s_waitcnt vmcnt(28)
    v_mfma_f32_16x16x32_bf16 v[20:23], v[132:135], v[140:143], v[20:23]
    v_mfma_f32_16x16x32_bf16 v[24:27], v[132:135], v[144:147], v[24:27]
    v_mfma_f32_16x16x32_bf16 v[28:31], v[136:139], v[140:143], v[28:31]
    v_mfma_f32_16x16x32_bf16 v[32:35], v[136:139], v[144:147], v[32:35]
    s_add_u32 s21, s25, 573440
    buffer_load_dwordx4 v[132:135], v5, s[4:7], s21 offen sc1
    buffer_load_dwordx4 v[136:139], v5, s[4:7], s21 offen offset:1024 sc1
    buffer_load_dwordx4 v[140:143], v9, s[4:7], s20 offen offset:1408 sc1
    buffer_load_dwordx4 v[144:147], v10, s[4:7], s20 offen offset:1408 sc1
    s_waitcnt vmcnt(28)
    v_mfma_f32_16x16x32_bf16 v[20:23], v[148:151], v[156:159], v[20:23]
    v_mfma_f32_16x16x32_bf16 v[24:27], v[148:151], v[160:163], v[24:27]
    v_mfma_f32_16x16x32_bf16 v[28:31], v[152:155], v[156:159], v[28:31]
    v_mfma_f32_16x16x32_bf16 v[32:35], v[152:155], v[160:163], v[32:35]
    s_add_u32 s21, s25, 614400
    buffer_load_dwordx4 v[148:151], v5, s[4:7], s21 offen sc1
    buffer_load_dwordx4 v[152:155], v5, s[4:7], s21 offen offset:1024 sc1
    buffer_load_dwordx4 v[156:159], v9, s[4:7], s20 offen offset:1472 sc1
    buffer_load_dwordx4 v[160:163], v10, s[4:7], s20 offen offset:1472 sc1
    s_waitcnt vmcnt(28)
    v_mfma_f32_16x16x32_bf16 v[20:23], v[36:39], v[44:47], v[20:23]
    v_mfma_f32_16x16x32_bf16 v[24:27], v[36:39], v[48:51], v[24:27]
    v_mfma_f32_16x16x32_bf16 v[28:31], v[40:43], v[44:47], v[28:31]
    v_mfma_f32_16x16x32_bf16 v[32:35], v[40:43], v[48:51], v[32:35]
    s_add_u32 s21, s25, 655360
    buffer_load_dwordx4 v[36:39], v5, s[4:7], s21 offen sc1
    buffer_load_dwordx4 v[40:43], v5, s[4:7], s21 offen offset:1024 sc1
    buffer_load_dwordx4 v[44:47], v9, s[4:7], s20 offen offset:1536 sc1
    buffer_load_dwordx4 v[48:51], v10, s[4:7], s20 offen offset:1536 sc1
    s_waitcnt vmcnt(28)
    v_mfma_f32_16x16x32_bf16 v[20:23], v[52:55], v[60:63], v[20:23]
    v_mfma_f32_16x16x32_bf16 v[24:27], v[52:55], v[64:67], v[24:27]
    v_mfma_f32_16x16x32_bf16 v[28:31], v[56:59], v[60:63], v[28:31]
    v_mfma_f32_16x16x32_bf16 v[32:35], v[56:59], v[64:67], v[32:35]
    s_add_u32 s21, s25, 696320
    buffer_load_dwordx4 v[52:55], v5, s[4:7], s21 offen sc1
    buffer_load_dwordx4 v[56:59], v5, s[4:7], s21 offen offset:1024 sc1
    buffer_load_dwordx4 v[60:63], v9, s[4:7], s20 offen offset:1600 sc1
    buffer_load_dwordx4 v[64:67], v10, s[4:7], s20 offen offset:1600 sc1
    s_waitcnt vmcnt(28)
    v_mfma_f32_16x16x32_bf16 v[20:23], v[68:71], v[76:79], v[20:23]
    v_mfma_f32_16x16x32_bf16 v[24:27], v[68:71], v[80:83], v[24:27]
    v_mfma_f32_16x16x32_bf16 v[28:31], v[72:75], v[76:79], v[28:31]
    v_mfma_f32_16x16x32_bf16 v[32:35], v[72:75], v[80:83], v[32:35]
    s_add_u32 s21, s25, 737280
    buffer_load_dwordx4 v[68:71], v5, s[4:7], s21 offen sc1
    buffer_load_dwordx4 v[72:75], v5, s[4:7], s21 offen offset:1024 sc1
    buffer_load_dwordx4 v[76:79], v9, s[4:7], s20 offen offset:1664 sc1
    buffer_load_dwordx4 v[80:83], v10, s[4:7], s20 offen offset:1664 sc1
    s_waitcnt vmcnt(28)
    v_mfma_f32_16x16x32_bf16 v[20:23], v[84:87], v[92:95], v[20:23]
    v_mfma_f32_16x16x32_bf16 v[24:27], v[84:87], v[96:99], v[24:27]
    v_mfma_f32_16x16x32_bf16 v[28:31], v[88:91], v[92:95], v[28:31]
    v_mfma_f32_16x16x32_bf16 v[32:35], v[88:91], v[96:99], v[32:35]
    s_add_u32 s21, s25, 778240
    buffer_load_dwordx4 v[84:87], v5, s[4:7], s21 offen sc1
    buffer_load_dwordx4 v[88:91], v5, s[4:7], s21 offen offset:1024 sc1
    buffer_load_dwordx4 v[92:95], v9, s[4:7], s20 offen offset:1728 sc1
    buffer_load_dwordx4 v[96:99], v10, s[4:7], s20 offen offset:1728 sc1
    s_waitcnt vmcnt(28)
    v_mfma_f32_16x16x32_bf16 v[20:23], v[100:103], v[108:111], v[20:23]
    v_mfma_f32_16x16x32_bf16 v[24:27], v[100:103], v[112:115], v[24:27]
    v_mfma_f32_16x16x32_bf16 v[28:31], v[104:107], v[108:111], v[28:31]
    v_mfma_f32_16x16x32_bf16 v[32:35], v[104:107], v[112:115], v[32:35]
    s_add_u32 s21, s25, 819200
    buffer_load_dwordx4 v[100:103], v5, s[4:7], s21 offen sc1
    buffer_load_dwordx4 v[104:107], v5, s[4:7], s21 offen offset:1024 sc1
    buffer_load_dwordx4 v[108:111], v9, s[4:7], s20 offen offset:1792 sc1
    buffer_load_dwordx4 v[112:115], v10, s[4:7], s20 offen offset:1792 sc1
    s_waitcnt vmcnt(28)
    v_mfma_f32_16x16x32_bf16 v[20:23], v[116:119], v[124:127], v[20:23]
    v_mfma_f32_16x16x32_bf16 v[24:27], v[116:119], v[128:131], v[24:27]
    v_mfma_f32_16x16x32_bf16 v[28:31], v[120:123], v[124:127], v[28:31]
    v_mfma_f32_16x16x32_bf16 v[32:35], v[120:123], v[128:131], v[32:35]
    s_add_u32 s21, s25, 860160
    buffer_load_dwordx4 v[116:119], v5, s[4:7], s21 offen sc1
    buffer_load_dwordx4 v[120:123], v5, s[4:7], s21 offen offset:1024 sc1
    buffer_load_dwordx4 v[124:127], v9, s[4:7], s20 offen offset:1856 sc1
    buffer_load_dwordx4 v[128:131], v10, s[4:7], s20 offen offset:1856 sc1
    s_waitcnt vmcnt(28)
    v_mfma_f32_16x16x32_bf16 v[20:23], v[132:135], v[140:143], v[20:23]
    v_mfma_f32_16x16x32_bf16 v[24:27], v[132:135], v[144:147], v[24:27]
    v_mfma_f32_16x16x32_bf16 v[28:31], v[136:139], v[140:143], v[28:31]
    v_mfma_f32_16x16x32_bf16 v[32:35], v[136:139], v[144:147], v[32:35]
    s_add_u32 s21, s25, 901120
    buffer_load_dwordx4 v[132:135], v5, s[4:7], s21 offen sc1
    buffer_load_dwordx4 v[136:139], v5, s[4:7], s21 offen offset:1024 sc1
    buffer_load_dwordx4 v[140:143], v9, s[4:7], s20 offen offset:1920 sc1
    buffer_load_dwordx4 v[144:147], v10, s[4:7], s20 offen offset:1920 sc1
    s_waitcnt vmcnt(28)
    v_mfma_f32_16x16x32_bf16 v[20:23], v[148:151], v[156:159], v[20:23]
    v_mfma_f32_16x16x32_bf16 v[24:27], v[148:151], v[160:163], v[24:27]
    v_mfma_f32_16x16x32_bf16 v[28:31], v[152:155], v[156:159], v[28:31]
    v_mfma_f32_16x16x32_bf16 v[32:35], v[152:155], v[160:163], v[32:35]
    s_add_u32 s21, s25, 942080
    buffer_load_dwordx4 v[148:151], v5, s[4:7], s21 offen sc1
    buffer_load_dwordx4 v[152:155], v5, s[4:7], s21 offen offset:1024 sc1
    buffer_load_dwordx4 v[156:159], v9, s[4:7], s20 offen offset:1984 sc1
    buffer_load_dwordx4 v[160:163], v10, s[4:7], s20 offen offset:1984 sc1
    s_waitcnt vmcnt(28)
    v_mfma_f32_16x16x32_bf16 v[20:23], v[36:39], v[44:47], v[20:23]
    v_mfma_f32_16x16x32_bf16 v[24:27], v[36:39], v[48:51], v[24:27]
    v_mfma_f32_16x16x32_bf16 v[28:31], v[40:43], v[44:47], v[28:31]
    v_mfma_f32_16x16x32_bf16 v[32:35], v[40:43], v[48:51], v[32:35]
    s_add_u32 s21, s25, 983040
    buffer_load_dwordx4 v[36:39], v5, s[4:7], s21 offen sc1
    buffer_load_dwordx4 v[40:43], v5, s[4:7], s21 offen offset:1024 sc1
    buffer_load_dwordx4 v[44:47], v9, s[4:7], s20 offen offset:2048 sc1
    buffer_load_dwordx4 v[48:51], v10, s[4:7], s20 offen offset:2048 sc1
    s_waitcnt vmcnt(28)
    v_mfma_f32_16x16x32_bf16 v[20:23], v[52:55], v[60:63], v[20:23]
    v_mfma_f32_16x16x32_bf16 v[24:27], v[52:55], v[64:67], v[24:27]
    v_mfma_f32_16x16x32_bf16 v[28:31], v[56:59], v[60:63], v[28:31]
    v_mfma_f32_16x16x32_bf16 v[32:35], v[56:59], v[64:67], v[32:35]
    s_add_u32 s21, s25, 1024000
    buffer_load_dwordx4 v[52:55], v5, s[4:7], s21 offen sc1
    buffer_load_dwordx4 v[56:59], v5, s[4:7], s21 offen offset:1024 sc1
    buffer_load_dwordx4 v[60:63], v9, s[4:7], s20 offen offset:2112 sc1
    buffer_load_dwordx4 v[64:67], v10, s[4:7], s20 offen offset:2112 sc1
    s_waitcnt vmcnt(28)
    v_mfma_f32_16x16x32_bf16 v[20:23], v[68:71], v[76:79], v[20:23]
    v_mfma_f32_16x16x32_bf16 v[24:27], v[68:71], v[80:83], v[24:27]
    v_mfma_f32_16x16x32_bf16 v[28:31], v[72:75], v[76:79], v[28:31]
    v_mfma_f32_16x16x32_bf16 v[32:35], v[72:75], v[80:83], v[32:35]
    s_add_u32 s21, s25, 1064960
    buffer_load_dwordx4 v[68:71], v5, s[4:7], s21 offen sc1
    buffer_load_dwordx4 v[72:75], v5, s[4:7], s21 offen offset:1024 sc1
    buffer_load_dwordx4 v[76:79], v9, s[4:7], s20 offen offset:2176 sc1
    buffer_load_dwordx4 v[80:83], v10, s[4:7], s20 offen offset:2176 sc1
    s_waitcnt vmcnt(28)
    v_mfma_f32_16x16x32_bf16 v[20:23], v[84:87], v[92:95], v[20:23]
    v_mfma_f32_16x16x32_bf16 v[24:27], v[84:87], v[96:99], v[24:27]
    v_mfma_f32_16x16x32_bf16 v[28:31], v[88:91], v[92:95], v[28:31]
    v_mfma_f32_16x16x32_bf16 v[32:35], v[88:91], v[96:99], v[32:35]
    s_add_u32 s21, s25, 1105920
    buffer_load_dwordx4 v[84:87], v5, s[4:7], s21 offen sc1
    buffer_load_dwordx4 v[88:91], v5, s[4:7], s21 offen offset:1024 sc1
    buffer_load_dwordx4 v[92:95], v9, s[4:7], s20 offen offset:2240 sc1
    buffer_load_dwordx4 v[96:99], v10, s[4:7], s20 offen offset:2240 sc1
    s_waitcnt vmcnt(28)
    v_mfma_f32_16x16x32_bf16 v[20:23], v[100:103], v[108:111], v[20:23]
    v_mfma_f32_16x16x32_bf16 v[24:27], v[100:103], v[112:115], v[24:27]
    v_mfma_f32_16x16x32_bf16 v[28:31], v[104:107], v[108:111], v[28:31]
    v_mfma_f32_16x16x32_bf16 v[32:35], v[104:107], v[112:115], v[32:35]
    s_add_u32 s21, s25, 1146880
    buffer_load_dwordx4 v[100:103], v5, s[4:7], s21 offen sc1
    buffer_load_dwordx4 v[104:107], v5, s[4:7], s21 offen offset:1024 sc1
    buffer_load_dwordx4 v[108:111], v9, s[4:7], s20 offen offset:2304 sc1
    buffer_load_dwordx4 v[112:115], v10, s[4:7], s20 offen offset:2304 sc1
    s_waitcnt vmcnt(28)
    v_mfma_f32_16x16x32_bf16 v[20:23], v[116:119], v[124:127], v[20:23]
    v_mfma_f32_16x16x32_bf16 v[24:27], v[116:119], v[128:131], v[24:27]
    v_mfma_f32_16x16x32_bf16 v[28:31], v[120:123], v[124:127], v[28:31]
    v_mfma_f32_16x16x32_bf16 v[32:35], v[120:123], v[128:131], v[32:35]
    s_add_u32 s21, s25, 1187840
    buffer_load_dwordx4 v[116:119], v5, s[4:7], s21 offen sc1
    buffer_load_dwordx4 v[120:123], v5, s[4:7], s21 offen offset:1024 sc1
    buffer_load_dwordx4 v[124:127], v9, s[4:7], s20 offen offset:2368 sc1
    buffer_load_dwordx4 v[128:131], v10, s[4:7], s20 offen offset:2368 sc1
    s_waitcnt vmcnt(28)
    v_mfma_f32_16x16x32_bf16 v[20:23], v[132:135], v[140:143], v[20:23]
    v_mfma_f32_16x16x32_bf16 v[24:27], v[132:135], v[144:147], v[24:27]
    v_mfma_f32_16x16x32_bf16 v[28:31], v[136:139], v[140:143], v[28:31]
    v_mfma_f32_16x16x32_bf16 v[32:35], v[136:139], v[144:147], v[32:35]
    s_add_u32 s21, s25, 1228800
    buffer_load_dwordx4 v[132:135], v5, s[4:7], s21 offen sc1
    buffer_load_dwordx4 v[136:139], v5, s[4:7], s21 offen offset:1024 sc1
    buffer_load_dwordx4 v[140:143], v9, s[4:7], s20 offen offset:2432 sc1
    buffer_load_dwordx4 v[144:147], v10, s[4:7], s20 offen offset:2432 sc1
    s_waitcnt vmcnt(28)
    v_mfma_f32_16x16x32_bf16 v[20:23], v[148:151], v[156:159], v[20:23]
    v_mfma_f32_16x16x32_bf16 v[24:27], v[148:151], v[160:163], v[24:27]
    v_mfma_f32_16x16x32_bf16 v[28:31], v[152:155], v[156:159], v[28:31]
    v_mfma_f32_16x16x32_bf16 v[32:35], v[152:155], v[160:163], v[32:35]
    s_add_u32 s21, s25, 1269760
    buffer_load_dwordx4 v[148:151], v5, s[4:7], s21 offen sc1
    buffer_load_dwordx4 v[152:155], v5, s[4:7], s21 offen offset:1024 sc1
    buffer_load_dwordx4 v[156:159], v9, s[4:7], s20 offen offset:2496 sc1
    buffer_load_dwordx4 v[160:163], v10, s[4:7], s20 offen offset:2496 sc1
    s_waitcnt vmcnt(28)
    v_mfma_f32_16x16x32_bf16 v[20:23], v[36:39], v[44:47], v[20:23]
    v_mfma_f32_16x16x32_bf16 v[24:27], v[36:39], v[48:51], v[24:27]
    v_mfma_f32_16x16x32_bf16 v[28:31], v[40:43], v[44:47], v[28:31]
    v_mfma_f32_16x16x32_bf16 v[32:35], v[40:43], v[48:51], v[32:35]
    s_waitcnt vmcnt(24)
    v_mfma_f32_16x16x32_bf16 v[20:23], v[52:55], v[60:63], v[20:23]
    v_mfma_f32_16x16x32_bf16 v[24:27], v[52:55], v[64:67], v[24:27]
    v_mfma_f32_16x16x32_bf16 v[28:31], v[56:59], v[60:63], v[28:31]
    v_mfma_f32_16x16x32_bf16 v[32:35], v[56:59], v[64:67], v[32:35]
    s_waitcnt vmcnt(20)
    v_mfma_f32_16x16x32_bf16 v[20:23], v[68:71], v[76:79], v[20:23]
    v_mfma_f32_16x16x32_bf16 v[24:27], v[68:71], v[80:83], v[24:27]
    v_mfma_f32_16x16x32_bf16 v[28:31], v[72:75], v[76:79], v[28:31]
    v_mfma_f32_16x16x32_bf16 v[32:35], v[72:75], v[80:83], v[32:35]
    s_waitcnt vmcnt(16)
    v_mfma_f32_16x16x32_bf16 v[20:23], v[84:87], v[92:95], v[20:23]
    v_mfma_f32_16x16x32_bf16 v[24:27], v[84:87], v[96:99], v[24:27]
    v_mfma_f32_16x16x32_bf16 v[28:31], v[88:91], v[92:95], v[28:31]
    v_mfma_f32_16x16x32_bf16 v[32:35], v[88:91], v[96:99], v[32:35]
    s_waitcnt vmcnt(12)
    v_mfma_f32_16x16x32_bf16 v[20:23], v[100:103], v[108:111], v[20:23]
    v_mfma_f32_16x16x32_bf16 v[24:27], v[100:103], v[112:115], v[24:27]
    v_mfma_f32_16x16x32_bf16 v[28:31], v[104:107], v[108:111], v[28:31]
    v_mfma_f32_16x16x32_bf16 v[32:35], v[104:107], v[112:115], v[32:35]
    s_waitcnt vmcnt(8)
    v_mfma_f32_16x16x32_bf16 v[20:23], v[116:119], v[124:127], v[20:23]
    v_mfma_f32_16x16x32_bf16 v[24:27], v[116:119], v[128:131], v[24:27]
    v_mfma_f32_16x16x32_bf16 v[28:31], v[120:123], v[124:127], v[28:31]
    v_mfma_f32_16x16x32_bf16 v[32:35], v[120:123], v[128:131], v[32:35]
    s_waitcnt vmcnt(4)
    v_mfma_f32_16x16x32_bf16 v[20:23], v[132:135], v[140:143], v[20:23]
    v_mfma_f32_16x16x32_bf16 v[24:27], v[132:135], v[144:147], v[24:27]
    v_mfma_f32_16x16x32_bf16 v[28:31], v[136:139], v[140:143], v[28:31]
    v_mfma_f32_16x16x32_bf16 v[32:35], v[136:139], v[144:147], v[32:35]
    s_waitcnt vmcnt(0)
    v_mfma_f32_16x16x32_bf16 v[20:23], v[148:151], v[156:159], v[20:23]
    v_mfma_f32_16x16x32_bf16 v[24:27], v[148:151], v[160:163], v[24:27]
    v_mfma_f32_16x16x32_bf16 v[28:31], v[152:155], v[156:159], v[28:31]
    v_mfma_f32_16x16x32_bf16 v[32:35], v[152:155], v[160:163], v[32:35]
    s_nop 7
    s_lshl_b32 s18, s16, 5
    v_add_u32 v11, s18, v1
    v_mul_u32_u24 v11, 1280, v11
    v_lshl_add_u32 v12, v2, 2, v3
    v_lshl_add_u32 v11, v12, 1, v11
    s_mov_b32 s22, 235896832
    s_mov_b32 s23, 20480
    s_add_u32 s24, s22, s23
    buffer_load_dwordx2 v[36:37], v11, s[8:11], 0 offen offset:0
    buffer_load_dwordx2 v[38:39], v11, s[8:11], s23 offen offset:0
    buffer_load_dwordx2 v[40:41], v11, s[8:11], 0 offen offset:32
    buffer_load_dwordx2 v[42:43], v11, s[8:11], s23 offen offset:32
    s_waitcnt vmcnt(0)
    v_cvt_pk_bf16_f32 v44, v20, v21
    v_cvt_pk_bf16_f32 v45, v22, v23
    v_lshlrev_b32 v46, 16, v44
    v_lshlrev_b32 v50, 16, v36
    v_add_f32 v46, v46, v50
    v_and_b32 v47, 0xffff0000, v44
    v_and_b32 v51, 0xffff0000, v36
    v_add_f32 v47, v47, v51
    v_lshlrev_b32 v48, 16, v45
    v_lshlrev_b32 v52, 16, v37
    v_add_f32 v48, v48, v52
    v_and_b32 v49, 0xffff0000, v45
    v_and_b32 v53, 0xffff0000, v37
    v_add_f32 v49, v49, v53
    v_cvt_pk_bf16_f32 v20, v46, v47
    v_cvt_pk_bf16_f32 v21, v48, v49
    buffer_store_dwordx2 v[20:21], v11, s[4:7], s22 offen offset:0 sc1
    v_cvt_pk_bf16_f32 v44, v24, v25
    v_cvt_pk_bf16_f32 v45, v26, v27
    v_lshlrev_b32 v46, 16, v44
    v_lshlrev_b32 v50, 16, v38
    v_add_f32 v46, v46, v50
    v_and_b32 v47, 0xffff0000, v44
    v_and_b32 v51, 0xffff0000, v38
    v_add_f32 v47, v47, v51
    v_lshlrev_b32 v48, 16, v45
    v_lshlrev_b32 v52, 16, v39
    v_add_f32 v48, v48, v52
    v_and_b32 v49, 0xffff0000, v45
    v_and_b32 v53, 0xffff0000, v39
    v_add_f32 v49, v49, v53
    v_cvt_pk_bf16_f32 v24, v46, v47
    v_cvt_pk_bf16_f32 v25, v48, v49
    buffer_store_dwordx2 v[24:25], v11, s[4:7], s24 offen offset:0 sc1
    v_cvt_pk_bf16_f32 v44, v28, v29
    v_cvt_pk_bf16_f32 v45, v30, v31
    v_lshlrev_b32 v46, 16, v44
    v_lshlrev_b32 v50, 16, v40
    v_add_f32 v46, v46, v50
    v_and_b32 v47, 0xffff0000, v44
    v_and_b32 v51, 0xffff0000, v40
    v_add_f32 v47, v47, v51
    v_lshlrev_b32 v48, 16, v45
    v_lshlrev_b32 v52, 16, v41
    v_add_f32 v48, v48, v52
    v_and_b32 v49, 0xffff0000, v45
    v_and_b32 v53, 0xffff0000, v41
    v_add_f32 v49, v49, v53
    v_cvt_pk_bf16_f32 v28, v46, v47
    v_cvt_pk_bf16_f32 v29, v48, v49
    buffer_store_dwordx2 v[28:29], v11, s[4:7], s22 offen offset:32 sc1
    v_cvt_pk_bf16_f32 v44, v32, v33
    v_cvt_pk_bf16_f32 v45, v34, v35
    v_lshlrev_b32 v46, 16, v44
    v_lshlrev_b32 v50, 16, v42
    v_add_f32 v46, v46, v50
    v_and_b32 v47, 0xffff0000, v44
    v_and_b32 v51, 0xffff0000, v42
    v_add_f32 v47, v47, v51
    v_lshlrev_b32 v48, 16, v45
    v_lshlrev_b32 v52, 16, v43
    v_add_f32 v48, v48, v52
    v_and_b32 v49, 0xffff0000, v45
    v_and_b32 v53, 0xffff0000, v43
    v_add_f32 v49, v49, v53
    v_cvt_pk_bf16_f32 v32, v46, v47
    v_cvt_pk_bf16_f32 v33, v48, v49
    buffer_store_dwordx2 v[32:33], v11, s[4:7], s24 offen offset:32 sc1
    s_branch wk_fin
wk_ffn1_big:
    s_mul_i32 s20, s16, 163840
    s_add_u32 s20, s20, 34078720
    s_mul_i32 s21, s17, 163840
    s_add_u32 s21, s21, 238518272
    v_lshrrev_b32 v113, 3, v0
    v_and_b32 v114, 7, v0
    v_add_u32 v115, 0, v113
    v_mul_u32_u24 v100, 1280, v115
    v_lshl_add_u32 v100, v114, 4, v100
    v_mul_u32_u24 v104, 1280, v115
    v_lshl_add_u32 v104, v114, 4, v104
    v_add_u32 v115, 32, v113
    v_mul_u32_u24 v101, 1280, v115
    v_lshl_add_u32 v101, v114, 4, v101
    v_mul_u32_u24 v105, 1280, v115
    v_lshl_add_u32 v105, v114, 4, v105
    v_add_u32 v115, 64, v113
    v_mul_u32_u24 v102, 1280, v115
    v_lshl_add_u32 v102, v114, 4, v102
    v_mul_u32_u24 v106, 1280, v115
    v_lshl_add_u32 v106, v114, 4, v106
    v_add_u32 v115, 96, v113
    v_mul_u32_u24 v103, 1280, v115
    v_lshl_add_u32 v103, v114, 4, v103
    v_mul_u32_u24 v107, 1280, v115
    v_lshl_add_u32 v107, v114, 4, v107
    v_and_b32 v115, 7, v113
    v_xor_b32 v115, v115, v114
    v_lshlrev_b32 v115, 4, v115
    v_lshl_add_u32 v108, v113, 7, v115
    v_lshrrev_b32 v113, 6, v0
    v_lshrrev_b32 v114, 1, v113
    v_and_b32 v115, 1, v113
    v_and_b32 v116, 15, v0
    v_bfe_u32 v117, v0, 4, 2
    v_and_b32 v118, 7, v0
    v_xor_b32 v118, v118, v117
    v_lshlrev_b32 v118, 4, v118
    v_mul_u32_u24 v119, 64, v114
    v_add_u32 v119, v119, v116
    v_lshl_add_u32 v109, v119, 7, v118
    v_xor_b32 v110, 64, v109
    v_mul_u32_u24 v119, 64, v115
    v_add_u32 v119, v119, v116
    v_lshl_add_u32 v111, v119, 7, v118
    v_add_u32 v111, 16384, v111
    v_xor_b32 v112, 64, v111
    v_accvgpr_write_b32 a0, 0
    v_accvgpr_write_b32 a1, 0
    v_accvgpr_write_b32 a2, 0
    v_accvgpr_write_b32 a3, 0
    v_accvgpr_write_b32 a4, 0
    v_accvgpr_write_b32 a5, 0
    v_accvgpr_write_b32 a6, 0
    v_accvgpr_write_b32 a7, 0
    v_accvgpr_write_b32 a8, 0
    v_accvgpr_write_b32 a9, 0
    v_accvgpr_write_b32 a10, 0
    v_accvgpr_write_b32 a11, 0
    v_accvgpr_write_b32 a12, 0
    v_accvgpr_write_b32 a13, 0
    v_accvgpr_write_b32 a14, 0
    v_accvgpr_write_b32 a15, 0
    v_accvgpr_write_b32 a16, 0
    v_accvgpr_write_b32 a17, 0
    v_accvgpr_write_b32 a18, 0
    v_accvgpr_write_b32 a19, 0
    v_accvgpr_write_b32 a20, 0
    v_accvgpr_write_b32 a21, 0
    v_accvgpr_write_b32 a22, 0
    v_accvgpr_write_b32 a23, 0
    v_accvgpr_write_b32 a24, 0
    v_accvgpr_write_b32 a25, 0
    v_accvgpr_write_b32 a26, 0
    v_accvgpr_write_b32 a27, 0
    v_accvgpr_write_b32 a28, 0
    v_accvgpr_write_b32 a29, 0
    v_accvgpr_write_b32 a30, 0
    v_accvgpr_write_b32 a31, 0
    v_accvgpr_write_b32 a32, 0
    v_accvgpr_write_b32 a33, 0
    v_accvgpr_write_b32 a34, 0
    v_accvgpr_write_b32 a35, 0
    v_accvgpr_write_b32 a36, 0
    v_accvgpr_write_b32 a37, 0
    v_accvgpr_write_b32 a38, 0
    v_accvgpr_write_b32 a39, 0
    v_accvgpr_write_b32 a40, 0
    v_accvgpr_write_b32 a41, 0
    v_accvgpr_write_b32 a42, 0
    v_accvgpr_write_b32 a43, 0
    v_accvgpr_write_b32 a44, 0
    v_accvgpr_write_b32 a45, 0
    v_accvgpr_write_b32 a46, 0
    v_accvgpr_write_b32 a47, 0
    v_accvgpr_write_b32 a48, 0
    v_accvgpr_write_b32 a49, 0
    v_accvgpr_write_b32 a50, 0
    v_accvgpr_write_b32 a51, 0
    v_accvgpr_write_b32 a52, 0
    v_accvgpr_write_b32 a53, 0
    v_accvgpr_write_b32 a54, 0
    v_accvgpr_write_b32 a55, 0
    v_accvgpr_write_b32 a56, 0
    v_accvgpr_write_b32 a57, 0
    v_accvgpr_write_b32 a58, 0
    v_accvgpr_write_b32 a59, 0
    v_accvgpr_write_b32 a60, 0
    v_accvgpr_write_b32 a61, 0
    v_accvgpr_write_b32 a62, 0
    v_accvgpr_write_b32 a63, 0
    v_add_u32 v121, 0xc000, v108
    v_add_u32 v126, 0x18000, v108
    v_add_u32 v122, 0xc000, v109
    v_add_u32 v127, 0x18000, v109
    v_add_u32 v123, 0xc000, v110
    v_add_u32 v128, 0x18000, v110
    v_add_u32 v124, 0xc000, v111
    v_add_u32 v129, 0x18000, v111
    v_add_u32 v125, 0xc000, v112
    v_add_u32 v130, 0x18000, v112
    buffer_load_dwordx4 v[68:71], v100, s[4:7], s20 offen offset:0 sc1
    buffer_load_dwordx4 v[72:75], v101, s[4:7], s20 offen offset:0 sc1
    buffer_load_dwordx4 v[76:79], v102, s[4:7], s20 offen offset:0 sc1
    buffer_load_dwordx4 v[80:83], v103, s[4:7], s20 offen offset:0 sc1
    buffer_load_dwordx4 v[84:87], v104, s[4:7], s21 offen offset:0 sc1
    buffer_load_dwordx4 v[88:91], v105, s[4:7], s21 offen offset:0 sc1
    buffer_load_dwordx4 v[92:95], v106, s[4:7], s21 offen offset:0 sc1
    buffer_load_dwordx4 v[96:99], v107, s[4:7], s21 offen offset:0 sc1
    s_waitcnt vmcnt(0)
    ds_write_b128 v108, v[68:71] offset:0
    ds_write_b128 v108, v[72:75] offset:4096
    ds_write_b128 v108, v[76:79] offset:8192
    ds_write_b128 v108, v[80:83] offset:12288
    ds_write_b128 v108, v[84:87] offset:16384
    ds_write_b128 v108, v[88:91] offset:20480
    ds_write_b128 v108, v[92:95] offset:24576
    ds_write_b128 v108, v[96:99] offset:28672
    buffer_load_dwordx4 v[68:71], v100, s[4:7], s20 offen offset:128 sc1
    buffer_load_dwordx4 v[72:75], v101, s[4:7], s20 offen offset:128 sc1
    buffer_load_dwordx4 v[76:79], v102, s[4:7], s20 offen offset:128 sc1
    buffer_load_dwordx4 v[80:83], v103, s[4:7], s20 offen offset:128 sc1
    buffer_load_dwordx4 v[84:87], v104, s[4:7], s21 offen offset:128 sc1
    buffer_load_dwordx4 v[88:91], v105, s[4:7], s21 offen offset:128 sc1
    buffer_load_dwordx4 v[92:95], v106, s[4:7], s21 offen offset:128 sc1
    buffer_load_dwordx4 v[96:99], v107, s[4:7], s21 offen offset:128 sc1
    s_waitcnt vmcnt(0)
    ds_write_b128 v108, v[68:71] offset:32768
    ds_write_b128 v108, v[72:75] offset:36864
    ds_write_b128 v108, v[76:79] offset:40960
    ds_write_b128 v108, v[80:83] offset:45056
    ds_write_b128 v121, v[84:87] offset:0
    ds_write_b128 v121, v[88:91] offset:4096
    ds_write_b128 v121, v[92:95] offset:8192
    ds_write_b128 v121, v[96:99] offset:12288
    s_waitcnt lgkmcnt(0)
    s_barrier
    ds_read_b128 v[4:7], v109 offset:0
    ds_read_b128 v[8:11], v109 offset:2048
    ds_read_b128 v[12:15], v109 offset:4096
    ds_read_b128 v[16:19], v109 offset:6144
    ds_read_b128 v[20:23], v111 offset:0
    ds_read_b128 v[24:27], v111 offset:2048
    ds_read_b128 v[28:31], v111 offset:4096
    ds_read_b128 v[32:35], v111 offset:6144
    buffer_load_dwordx4 v[68:71], v100, s[4:7], s20 offen offset:256 sc1
    buffer_load_dwordx4 v[72:75], v101, s[4:7], s20 offen offset:256 sc1
    buffer_load_dwordx4 v[76:79], v102, s[4:7], s20 offen offset:256 sc1
    buffer_load_dwordx4 v[80:83], v103, s[4:7], s20 offen offset:256 sc1
    buffer_load_dwordx4 v[84:87], v104, s[4:7], s21 offen offset:256 sc1
    buffer_load_dwordx4 v[88:91], v105, s[4:7], s21 offen offset:256 sc1
    buffer_load_dwordx4 v[92:95], v106, s[4:7], s21 offen offset:256 sc1
    buffer_load_dwordx4 v[96:99], v107, s[4:7], s21 offen offset:256 sc1
    s_waitcnt lgkmcnt(0)
    v_mfma_f32_16x16x32_bf16 a[0:3], v[4:7], v[20:23], a[0:3]
    ds_read_b128 v[36:39], v110 offset:0
    v_mfma_f32_16x16x32_bf16 a[4:7], v[4:7], v[24:27], a[4:7]
    v_mfma_f32_16x16x32_bf16 a[8:11], v[4:7], v[28:31], a[8:11]
    ds_read_b128 v[40:43], v110 offset:2048
    v_mfma_f32_16x16x32_bf16 a[12:15], v[4:7], v[32:35], a[12:15]
    v_mfma_f32_16x16x32_bf16 a[16:19], v[8:11], v[20:23], a[16:19]
    ds_read_b128 v[44:47], v110 offset:4096
    v_mfma_f32_16x16x32_bf16 a[20:23], v[8:11], v[24:27], a[20:23]
    v_mfma_f32_16x16x32_bf16 a[24:27], v[8:11], v[28:31], a[24:27]
    ds_read_b128 v[48:51], v110 offset:6144
    v_mfma_f32_16x16x32_bf16 a[28:31], v[8:11], v[32:35], a[28:31]
    v_mfma_f32_16x16x32_bf16 a[32:35], v[12:15], v[20:23], a[32:35]
    ds_read_b128 v[52:55], v112 offset:0
    v_mfma_f32_16x16x32_bf16 a[36:39], v[12:15], v[24:27], a[36:39]
    v_mfma_f32_16x16x32_bf16 a[40:43], v[12:15], v[28:31], a[40:43]
    ds_read_b128 v[56:59], v112 offset:2048
    v_mfma_f32_16x16x32_bf16 a[44:47], v[12:15], v[32:35], a[44:47]
    v_mfma_f32_16x16x32_bf16 a[48:51], v[16:19], v[20:23], a[48:51]
    ds_read_b128 v[60:63], v112 offset:4096
    v_mfma_f32_16x16x32_bf16 a[52:55], v[16:19], v[24:27], a[52:55]
    v_mfma_f32_16x16x32_bf16 a[56:59], v[16:19], v[28:31], a[56:59]
    ds_read_b128 v[64:67], v112 offset:6144
    v_mfma_f32_16x16x32_bf16 a[60:63], v[16:19], v[32:35], a[60:63]
    s_waitcnt lgkmcnt(0)
    v_mfma_f32_16x16x32_bf16 a[0:3], v[36:39], v[52:55], a[0:3]
    ds_read_b128 v[4:7], v109 offset:32768
    v_mfma_f32_16x16x32_bf16 a[4:7], v[36:39], v[56:59], a[4:7]
    v_mfma_f32_16x16x32_bf16 a[8:11], v[36:39], v[60:63], a[8:11]
    ds_read_b128 v[8:11], v109 offset:34816
    v_mfma_f32_16x16x32_bf16 a[12:15], v[36:39], v[64:67], a[12:15]
    v_mfma_f32_16x16x32_bf16 a[16:19], v[40:43], v[52:55], a[16:19]
    ds_read_b128 v[12:15], v109 offset:36864
    v_mfma_f32_16x16x32_bf16 a[20:23], v[40:43], v[56:59], a[20:23]
    v_mfma_f32_16x16x32_bf16 a[24:27], v[40:43], v[60:63], a[24:27]
    ds_read_b128 v[16:19], v109 offset:38912
    v_mfma_f32_16x16x32_bf16 a[28:31], v[40:43], v[64:67], a[28:31]
    v_mfma_f32_16x16x32_bf16 a[32:35], v[44:47], v[52:55], a[32:35]
    ds_read_b128 v[20:23], v111 offset:32768
    s_waitcnt vmcnt(0)
    ds_write_b128 v121, v[68:71] offset:16384
    ds_write_b128 v121, v[72:75] offset:20480
    v_mfma_f32_16x16x32_bf16 a[36:39], v[44:47], v[56:59], a[36:39]
    ds_write_b128 v121, v[76:79] offset:24576
    v_mfma_f32_16x16x32_bf16 a[40:43], v[44:47], v[60:63], a[40:43]
    ds_read_b128 v[24:27], v111 offset:34816
    ds_write_b128 v121, v[80:83] offset:28672
    v_mfma_f32_16x16x32_bf16 a[44:47], v[44:47], v[64:67], a[44:47]
    ds_write_b128 v121, v[84:87] offset:32768
    v_mfma_f32_16x16x32_bf16 a[48:51], v[48:51], v[52:55], a[48:51]
    ds_read_b128 v[28:31], v111 offset:36864
    ds_write_b128 v121, v[88:91] offset:36864
    v_mfma_f32_16x16x32_bf16 a[52:55], v[48:51], v[56:59], a[52:55]
    ds_write_b128 v121, v[92:95] offset:40960
    v_mfma_f32_16x16x32_bf16 a[56:59], v[48:51], v[60:63], a[56:59]
    ds_read_b128 v[32:35], v111 offset:38912
    ds_write_b128 v121, v[96:99] offset:45056
    v_mfma_f32_16x16x32_bf16 a[60:63], v[48:51], v[64:67], a[60:63]
    s_waitcnt lgkmcnt(0)
    s_barrier
    buffer_load_dwordx4 v[68:71], v100, s[4:7], s20 offen offset:384 sc1
    buffer_load_dwordx4 v[72:75], v101, s[4:7], s20 offen offset:384 sc1
    buffer_load_dwordx4 v[76:79], v102, s[4:7], s20 offen offset:384 sc1
    buffer_load_dwordx4 v[80:83], v103, s[4:7], s20 offen offset:384 sc1
    buffer_load_dwordx4 v[84:87], v104, s[4:7], s21 offen offset:384 sc1
    buffer_load_dwordx4 v[88:91], v105, s[4:7], s21 offen offset:384 sc1
    buffer_load_dwordx4 v[92:95], v106, s[4:7], s21 offen offset:384 sc1
    buffer_load_dwordx4 v[96:99], v107, s[4:7], s21 offen offset:384 sc1
    s_waitcnt lgkmcnt(0)
    v_mfma_f32_16x16x32_bf16 a[0:3], v[4:7], v[20:23], a[0:3]
    ds_read_b128 v[36:39], v110 offset:32768
    v_mfma_f32_16x16x32_bf16 a[4:7], v[4:7], v[24:27], a[4:7]
    v_mfma_f32_16x16x32_bf16 a[8:11], v[4:7], v[28:31], a[8:11]
    ds_read_b128 v[40:43], v110 offset:34816
    v_mfma_f32_16x16x32_bf16 a[12:15], v[4:7], v[32:35], a[12:15]
    v_mfma_f32_16x16x32_bf16 a[16:19], v[8:11], v[20:23], a[16:19]
    ds_read_b128 v[44:47], v110 offset:36864
    v_mfma_f32_16x16x32_bf16 a[20:23], v[8:11], v[24:27], a[20:23]
    v_mfma_f32_16x16x32_bf16 a[24:27], v[8:11], v[28:31], a[24:27]
    ds_read_b128 v[48:51], v110 offset:38912
    v_mfma_f32_16x16x32_bf16 a[28:31], v[8:11], v[32:35], a[28:31]
    v_mfma_f32_16x16x32_bf16 a[32:35], v[12:15], v[20:23], a[32:35]
    ds_read_b128 v[52:55], v112 offset:32768
    v_mfma_f32_16x16x32_bf16 a[36:39], v[12:15], v[24:27], a[36:39]
    v_mfma_f32_16x16x32_bf16 a[40:43], v[12:15], v[28:31], a[40:43]
    ds_read_b128 v[56:59], v112 offset:34816
    v_mfma_f32_16x16x32_bf16 a[44:47], v[12:15], v[32:35], a[44:47]
    v_mfma_f32_16x16x32_bf16 a[48:51], v[16:19], v[20:23], a[48:51]
    ds_read_b128 v[60:63], v112 offset:36864
    v_mfma_f32_16x16x32_bf16 a[52:55], v[16:19], v[24:27], a[52:55]
    v_mfma_f32_16x16x32_bf16 a[56:59], v[16:19], v[28:31], a[56:59]
    ds_read_b128 v[64:67], v112 offset:38912
    v_mfma_f32_16x16x32_bf16 a[60:63], v[16:19], v[32:35], a[60:63]
    s_waitcnt lgkmcnt(0)
    v_mfma_f32_16x16x32_bf16 a[0:3], v[36:39], v[52:55], a[0:3]
    ds_read_b128 v[4:7], v122 offset:16384
    v_mfma_f32_16x16x32_bf16 a[4:7], v[36:39], v[56:59], a[4:7]
    v_mfma_f32_16x16x32_bf16 a[8:11], v[36:39], v[60:63], a[8:11]
    ds_read_b128 v[8:11], v122 offset:18432
    v_mfma_f32_16x16x32_bf16 a[12:15], v[36:39], v[64:67], a[12:15]
    v_mfma_f32_16x16x32_bf16 a[16:19], v[40:43], v[52:55], a[16:19]
    ds_read_b128 v[12:15], v122 offset:20480
    v_mfma_f32_16x16x32_bf16 a[20:23], v[40:43], v[56:59], a[20:23]
    v_mfma_f32_16x16x32_bf16 a[24:27], v[40:43], v[60:63], a[24:27]
    ds_read_b128 v[16:19], v122 offset:22528
    v_mfma_f32_16x16x32_bf16 a[28:31], v[40:43], v[64:67], a[28:31]
    v_mfma_f32_16x16x32_bf16 a[32:35], v[44:47], v[52:55], a[32:35]
    ds_read_b128 v[20:23], v124 offset:16384
    s_waitcnt vmcnt(0)
    ds_write_b128 v108, v[68:71] offset:0
    ds_write_b128 v108, v[72:75] offset:4096
    v_mfma_f32_16x16x32_bf16 a[36:39], v[44:47], v[56:59], a[36:39]
    ds_write_b128 v108, v[76:79] offset:8192
    v_mfma_f32_16x16x32_bf16 a[40:43], v[44:47], v[60:63], a[40:43]
    ds_read_b128 v[24:27], v124 offset:18432
    ds_write_b128 v108, v[80:83] offset:12288
    v_mfma_f32_16x16x32_bf16 a[44:47], v[44:47], v[64:67], a[44:47]
    ds_write_b128 v108, v[84:87] offset:16384
    v_mfma_f32_16x16x32_bf16 a[48:51], v[48:51], v[52:55], a[48:51]
    ds_read_b128 v[28:31], v124 offset:20480
    ds_write_b128 v108, v[88:91] offset:20480
    v_mfma_f32_16x16x32_bf16 a[52:55], v[48:51], v[56:59], a[52:55]
    ds_write_b128 v108, v[92:95] offset:24576
    v_mfma_f32_16x16x32_bf16 a[56:59], v[48:51], v[60:63], a[56:59]
    ds_read_b128 v[32:35], v124 offset:22528
    ds_write_b128 v108, v[96:99] offset:28672
    v_mfma_f32_16x16x32_bf16 a[60:63], v[48:51], v[64:67], a[60:63]
    s_waitcnt lgkmcnt(0)
    s_barrier
    buffer_load_dwordx4 v[68:71], v100, s[4:7], s20 offen offset:512 sc1
    buffer_load_dwordx4 v[72:75], v101, s[4:7], s20 offen offset:512 sc1
    buffer_load_dwordx4 v[76:79], v102, s[4:7], s20 offen offset:512 sc1
    buffer_load_dwordx4 v[80:83], v103, s[4:7], s20 offen offset:512 sc1
    buffer_load_dwordx4 v[84:87], v104, s[4:7], s21 offen offset:512 sc1
    buffer_load_dwordx4 v[88:91], v105, s[4:7], s21 offen offset:512 sc1
    buffer_load_dwordx4 v[92:95], v106, s[4:7], s21 offen offset:512 sc1
    buffer_load_dwordx4 v[96:99], v107, s[4:7], s21 offen offset:512 sc1
    s_waitcnt lgkmcnt(0)
    v_mfma_f32_16x16x32_bf16 a[0:3], v[4:7], v[20:23], a[0:3]
    ds_read_b128 v[36:39], v123 offset:16384
    v_mfma_f32_16x16x32_bf16 a[4:7], v[4:7], v[24:27], a[4:7]
    v_mfma_f32_16x16x32_bf16 a[8:11], v[4:7], v[28:31], a[8:11]
    ds_read_b128 v[40:43], v123 offset:18432
    v_mfma_f32_16x16x32_bf16 a[12:15], v[4:7], v[32:35], a[12:15]
    v_mfma_f32_16x16x32_bf16 a[16:19], v[8:11], v[20:23], a[16:19]
    ds_read_b128 v[44:47], v123 offset:20480
    v_mfma_f32_16x16x32_bf16 a[20:23], v[8:11], v[24:27], a[20:23]
    v_mfma_f32_16x16x32_bf16 a[24:27], v[8:11], v[28:31], a[24:27]
    ds_read_b128 v[48:51], v123 offset:22528
    v_mfma_f32_16x16x32_bf16 a[28:31], v[8:11], v[32:35], a[28:31]
    v_mfma_f32_16x16x32_bf16 a[32:35], v[12:15], v[20:23], a[32:35]
    ds_read_b128 v[52:55], v125 offset:16384
    v_mfma_f32_16x16x32_bf16 a[36:39], v[12:15], v[24:27], a[36:39]
    v_mfma_f32_16x16x32_bf16 a[40:43], v[12:15], v[28:31], a[40:43]
    ds_read_b128 v[56:59], v125 offset:18432
    v_mfma_f32_16x16x32_bf16 a[44:47], v[12:15], v[32:35], a[44:47]
    v_mfma_f32_16x16x32_bf16 a[48:51], v[16:19], v[20:23], a[48:51]
    ds_read_b128 v[60:63], v125 offset:20480
    v_mfma_f32_16x16x32_bf16 a[52:55], v[16:19], v[24:27], a[52:55]
    v_mfma_f32_16x16x32_bf16 a[56:59], v[16:19], v[28:31], a[56:59]
    ds_read_b128 v[64:67], v125 offset:22528
    v_mfma_f32_16x16x32_bf16 a[60:63], v[16:19], v[32:35], a[60:63]
    s_waitcnt lgkmcnt(0)
    v_mfma_f32_16x16x32_bf16 a[0:3], v[36:39], v[52:55], a[0:3]
    ds_read_b128 v[4:7], v109 offset:0
    v_mfma_f32_16x16x32_bf16 a[4:7], v[36:39], v[56:59], a[4:7]
    v_mfma_f32_16x16x32_bf16 a[8:11], v[36:39], v[60:63], a[8:11]
    ds_read_b128 v[8:11], v109 offset:2048
    v_mfma_f32_16x16x32_bf16 a[12:15], v[36:39], v[64:67], a[12:15]
    v_mfma_f32_16x16x32_bf16 a[16:19], v[40:43], v[52:55], a[16:19]
    ds_read_b128 v[12:15], v109 offset:4096
    v_mfma_f32_16x16x32_bf16 a[20:23], v[40:43], v[56:59], a[20:23]
    v_mfma_f32_16x16x32_bf16 a[24:27], v[40:43], v[60:63], a[24:27]
    ds_read_b128 v[16:19], v109 offset:6144
    v_mfma_f32_16x16x32_bf16 a[28:31], v[40:43], v[64:67], a[28:31]
    v_mfma_f32_16x16x32_bf16 a[32:35], v[44:47], v[52:55], a[32:35]
    ds_read_b128 v[20:23], v111 offset:0
    s_waitcnt vmcnt(0)
    ds_write_b128 v108, v[68:71] offset:32768
    ds_write_b128 v108, v[72:75] offset:36864
    v_mfma_f32_16x16x32_bf16 a[36:39], v[44:47], v[56:59], a[36:39]
    ds_write_b128 v108, v[76:79] offset:40960
    v_mfma_f32_16x16x32_bf16 a[40:43], v[44:47], v[60:63], a[40:43]
    ds_read_b128 v[24:27], v111 offset:2048
    ds_write_b128 v108, v[80:83] offset:45056
    v_mfma_f32_16x16x32_bf16 a[44:47], v[44:47], v[64:67], a[44:47]
    ds_write_b128 v121, v[84:87] offset:0
    v_mfma_f32_16x16x32_bf16 a[48:51], v[48:51], v[52:55], a[48:51]
    ds_read_b128 v[28:31], v111 offset:4096
    ds_write_b128 v121, v[88:91] offset:4096
    v_mfma_f32_16x16x32_bf16 a[52:55], v[48:51], v[56:59], a[52:55]
    ds_write_b128 v121, v[92:95] offset:8192
    v_mfma_f32_16x16x32_bf16 a[56:59], v[48:51], v[60:63], a[56:59]
    ds_read_b128 v[32:35], v111 offset:6144
    ds_write_b128 v121, v[96:99] offset:12288
    v_mfma_f32_16x16x32_bf16 a[60:63], v[48:51], v[64:67], a[60:63]
    s_waitcnt lgkmcnt(0)
    s_barrier
    buffer_load_dwordx4 v[68:71], v100, s[4:7], s20 offen offset:640 sc1
    buffer_load_dwordx4 v[72:75], v101, s[4:7], s20 offen offset:640 sc1
    buffer_load_dwordx4 v[76:79], v102, s[4:7], s20 offen offset:640 sc1
    buffer_load_dwordx4 v[80:83], v103, s[4:7], s20 offen offset:640 sc1
    buffer_load_dwordx4 v[84:87], v104, s[4:7], s21 offen offset:640 sc1
    buffer_load_dwordx4 v[88:91], v105, s[4:7], s21 offen offset:640 sc1
    buffer_load_dwordx4 v[92:95], v106, s[4:7], s21 offen offset:640 sc1
    buffer_load_dwordx4 v[96:99], v107, s[4:7], s21 offen offset:640 sc1
    s_waitcnt lgkmcnt(0)
    v_mfma_f32_16x16x32_bf16 a[0:3], v[4:7], v[20:23], a[0:3]
    ds_read_b128 v[36:39], v110 offset:0
    v_mfma_f32_16x16x32_bf16 a[4:7], v[4:7], v[24:27], a[4:7]
    v_mfma_f32_16x16x32_bf16 a[8:11], v[4:7], v[28:31], a[8:11]
    ds_read_b128 v[40:43], v110 offset:2048
    v_mfma_f32_16x16x32_bf16 a[12:15], v[4:7], v[32:35], a[12:15]
    v_mfma_f32_16x16x32_bf16 a[16:19], v[8:11], v[20:23], a[16:19]
    ds_read_b128 v[44:47], v110 offset:4096
    v_mfma_f32_16x16x32_bf16 a[20:23], v[8:11], v[24:27], a[20:23]
    v_mfma_f32_16x16x32_bf16 a[24:27], v[8:11], v[28:31], a[24:27]
    ds_read_b128 v[48:51], v110 offset:6144
    v_mfma_f32_16x16x32_bf16 a[28:31], v[8:11], v[32:35], a[28:31]
    v_mfma_f32_16x16x32_bf16 a[32:35], v[12:15], v[20:23], a[32:35]
    ds_read_b128 v[52:55], v112 offset:0
    v_mfma_f32_16x16x32_bf16 a[36:39], v[12:15], v[24:27], a[36:39]
    v_mfma_f32_16x16x32_bf16 a[40:43], v[12:15], v[28:31], a[40:43]
    ds_read_b128 v[56:59], v112 offset:2048
    v_mfma_f32_16x16x32_bf16 a[44:47], v[12:15], v[32:35], a[44:47]
    v_mfma_f32_16x16x32_bf16 a[48:51], v[16:19], v[20:23], a[48:51]
    ds_read_b128 v[60:63], v112 offset:4096
    v_mfma_f32_16x16x32_bf16 a[52:55], v[16:19], v[24:27], a[52:55]
    v_mfma_f32_16x16x32_bf16 a[56:59], v[16:19], v[28:31], a[56:59]
    ds_read_b128 v[64:67], v112 offset:6144
    v_mfma_f32_16x16x32_bf16 a[60:63], v[16:19], v[32:35], a[60:63]
    s_waitcnt lgkmcnt(0)
    v_mfma_f32_16x16x32_bf16 a[0:3], v[36:39], v[52:55], a[0:3]
    ds_read_b128 v[4:7], v109 offset:32768
    v_mfma_f32_16x16x32_bf16 a[4:7], v[36:39], v[56:59], a[4:7]
    v_mfma_f32_16x16x32_bf16 a[8:11], v[36:39], v[60:63], a[8:11]
    ds_read_b128 v[8:11], v109 offset:34816
    v_mfma_f32_16x16x32_bf16 a[12:15], v[36:39], v[64:67], a[12:15]
    v_mfma_f32_16x16x32_bf16 a[16:19], v[40:43], v[52:55], a[16:19]
    ds_read_b128 v[12:15], v109 offset:36864
    v_mfma_f32_16x16x32_bf16 a[20:23], v[40:43], v[56:59], a[20:23]
    v_mfma_f32_16x16x32_bf16 a[24:27], v[40:43], v[60:63], a[24:27]
    ds_read_b128 v[16:19], v109 offset:38912
    v_mfma_f32_16x16x32_bf16 a[28:31], v[40:43], v[64:67], a[28:31]
    v_mfma_f32_16x16x32_bf16 a[32:35], v[44:47], v[52:55], a[32:35]
    ds_read_b128 v[20:23], v111 offset:32768
    s_waitcnt vmcnt(0)
    ds_write_b128 v121, v[68:71] offset:16384
    ds_write_b128 v121, v[72:75] offset:20480
    v_mfma_f32_16x16x32_bf16 a[36:39], v[44:47], v[56:59], a[36:39]
    ds_write_b128 v121, v[76:79] offset:24576
    v_mfma_f32_16x16x32_bf16 a[40:43], v[44:47], v[60:63], a[40:43]
    ds_read_b128 v[24:27], v111 offset:34816
    ds_write_b128 v121, v[80:83] offset:28672
    v_mfma_f32_16x16x32_bf16 a[44:47], v[44:47], v[64:67], a[44:47]
    ds_write_b128 v121, v[84:87] offset:32768
    v_mfma_f32_16x16x32_bf16 a[48:51], v[48:51], v[52:55], a[48:51]
    ds_read_b128 v[28:31], v111 offset:36864
    ds_write_b128 v121, v[88:91] offset:36864
    v_mfma_f32_16x16x32_bf16 a[52:55], v[48:51], v[56:59], a[52:55]
    ds_write_b128 v121, v[92:95] offset:40960
    v_mfma_f32_16x16x32_bf16 a[56:59], v[48:51], v[60:63], a[56:59]
    ds_read_b128 v[32:35], v111 offset:38912
    ds_write_b128 v121, v[96:99] offset:45056
    v_mfma_f32_16x16x32_bf16 a[60:63], v[48:51], v[64:67], a[60:63]
    s_waitcnt lgkmcnt(0)
    s_barrier
    buffer_load_dwordx4 v[68:71], v100, s[4:7], s20 offen offset:768 sc1
    buffer_load_dwordx4 v[72:75], v101, s[4:7], s20 offen offset:768 sc1
    buffer_load_dwordx4 v[76:79], v102, s[4:7], s20 offen offset:768 sc1
    buffer_load_dwordx4 v[80:83], v103, s[4:7], s20 offen offset:768 sc1
    buffer_load_dwordx4 v[84:87], v104, s[4:7], s21 offen offset:768 sc1
    buffer_load_dwordx4 v[88:91], v105, s[4:7], s21 offen offset:768 sc1
    buffer_load_dwordx4 v[92:95], v106, s[4:7], s21 offen offset:768 sc1
    buffer_load_dwordx4 v[96:99], v107, s[4:7], s21 offen offset:768 sc1
    s_waitcnt lgkmcnt(0)
    v_mfma_f32_16x16x32_bf16 a[0:3], v[4:7], v[20:23], a[0:3]
    ds_read_b128 v[36:39], v110 offset:32768
    v_mfma_f32_16x16x32_bf16 a[4:7], v[4:7], v[24:27], a[4:7]
    v_mfma_f32_16x16x32_bf16 a[8:11], v[4:7], v[28:31], a[8:11]
    ds_read_b128 v[40:43], v110 offset:34816
    v_mfma_f32_16x16x32_bf16 a[12:15], v[4:7], v[32:35], a[12:15]
    v_mfma_f32_16x16x32_bf16 a[16:19], v[8:11], v[20:23], a[16:19]
    ds_read_b128 v[44:47], v110 offset:36864
    v_mfma_f32_16x16x32_bf16 a[20:23], v[8:11], v[24:27], a[20:23]
    v_mfma_f32_16x16x32_bf16 a[24:27], v[8:11], v[28:31], a[24:27]
    ds_read_b128 v[48:51], v110 offset:38912
    v_mfma_f32_16x16x32_bf16 a[28:31], v[8:11], v[32:35], a[28:31]
    v_mfma_f32_16x16x32_bf16 a[32:35], v[12:15], v[20:23], a[32:35]
    ds_read_b128 v[52:55], v112 offset:32768
    v_mfma_f32_16x16x32_bf16 a[36:39], v[12:15], v[24:27], a[36:39]
    v_mfma_f32_16x16x32_bf16 a[40:43], v[12:15], v[28:31], a[40:43]
    ds_read_b128 v[56:59], v112 offset:34816
    v_mfma_f32_16x16x32_bf16 a[44:47], v[12:15], v[32:35], a[44:47]
    v_mfma_f32_16x16x32_bf16 a[48:51], v[16:19], v[20:23], a[48:51]
    ds_read_b128 v[60:63], v112 offset:36864
    v_mfma_f32_16x16x32_bf16 a[52:55], v[16:19], v[24:27], a[52:55]
    v_mfma_f32_16x16x32_bf16 a[56:59], v[16:19], v[28:31], a[56:59]
    ds_read_b128 v[64:67], v112 offset:38912
    v_mfma_f32_16x16x32_bf16 a[60:63], v[16:19], v[32:35], a[60:63]
    s_waitcnt lgkmcnt(0)
    v_mfma_f32_16x16x32_bf16 a[0:3], v[36:39], v[52:55], a[0:3]
    ds_read_b128 v[4:7], v122 offset:16384
    v_mfma_f32_16x16x32_bf16 a[4:7], v[36:39], v[56:59], a[4:7]
    v_mfma_f32_16x16x32_bf16 a[8:11], v[36:39], v[60:63], a[8:11]
    ds_read_b128 v[8:11], v122 offset:18432
    v_mfma_f32_16x16x32_bf16 a[12:15], v[36:39], v[64:67], a[12:15]
    v_mfma_f32_16x16x32_bf16 a[16:19], v[40:43], v[52:55], a[16:19]
    ds_read_b128 v[12:15], v122 offset:20480
    v_mfma_f32_16x16x32_bf16 a[20:23], v[40:43], v[56:59], a[20:23]
    v_mfma_f32_16x16x32_bf16 a[24:27], v[40:43], v[60:63], a[24:27]
    ds_read_b128 v[16:19], v122 offset:22528
    v_mfma_f32_16x16x32_bf16 a[28:31], v[40:43], v[64:67], a[28:31]
    v_mfma_f32_16x16x32_bf16 a[32:35], v[44:47], v[52:55], a[32:35]
    ds_read_b128 v[20:23], v124 offset:16384
    s_waitcnt vmcnt(0)
    ds_write_b128 v108, v[68:71] offset:0
    ds_write_b128 v108, v[72:75] offset:4096
    v_mfma_f32_16x16x32_bf16 a[36:39], v[44:47], v[56:59], a[36:39]
    ds_write_b128 v108, v[76:79] offset:8192
    v_mfma_f32_16x16x32_bf16 a[40:43], v[44:47], v[60:63], a[40:43]
    ds_read_b128 v[24:27], v124 offset:18432
    ds_write_b128 v108, v[80:83] offset:12288
    v_mfma_f32_16x16x32_bf16 a[44:47], v[44:47], v[64:67], a[44:47]
    ds_write_b128 v108, v[84:87] offset:16384
    v_mfma_f32_16x16x32_bf16 a[48:51], v[48:51], v[52:55], a[48:51]
    ds_read_b128 v[28:31], v124 offset:20480
    ds_write_b128 v108, v[88:91] offset:20480
    v_mfma_f32_16x16x32_bf16 a[52:55], v[48:51], v[56:59], a[52:55]
    ds_write_b128 v108, v[92:95] offset:24576
    v_mfma_f32_16x16x32_bf16 a[56:59], v[48:51], v[60:63], a[56:59]
    ds_read_b128 v[32:35], v124 offset:22528
    ds_write_b128 v108, v[96:99] offset:28672
    v_mfma_f32_16x16x32_bf16 a[60:63], v[48:51], v[64:67], a[60:63]
    s_waitcnt lgkmcnt(0)
    s_barrier
    buffer_load_dwordx4 v[68:71], v100, s[4:7], s20 offen offset:896 sc1
    buffer_load_dwordx4 v[72:75], v101, s[4:7], s20 offen offset:896 sc1
    buffer_load_dwordx4 v[76:79], v102, s[4:7], s20 offen offset:896 sc1
    buffer_load_dwordx4 v[80:83], v103, s[4:7], s20 offen offset:896 sc1
    buffer_load_dwordx4 v[84:87], v104, s[4:7], s21 offen offset:896 sc1
    buffer_load_dwordx4 v[88:91], v105, s[4:7], s21 offen offset:896 sc1
    buffer_load_dwordx4 v[92:95], v106, s[4:7], s21 offen offset:896 sc1
    buffer_load_dwordx4 v[96:99], v107, s[4:7], s21 offen offset:896 sc1
    s_waitcnt lgkmcnt(0)
    v_mfma_f32_16x16x32_bf16 a[0:3], v[4:7], v[20:23], a[0:3]
    ds_read_b128 v[36:39], v123 offset:16384
    v_mfma_f32_16x16x32_bf16 a[4:7], v[4:7], v[24:27], a[4:7]
    v_mfma_f32_16x16x32_bf16 a[8:11], v[4:7], v[28:31], a[8:11]
    ds_read_b128 v[40:43], v123 offset:18432
    v_mfma_f32_16x16x32_bf16 a[12:15], v[4:7], v[32:35], a[12:15]
    v_mfma_f32_16x16x32_bf16 a[16:19], v[8:11], v[20:23], a[16:19]
    ds_read_b128 v[44:47], v123 offset:20480
    v_mfma_f32_16x16x32_bf16 a[20:23], v[8:11], v[24:27], a[20:23]
    v_mfma_f32_16x16x32_bf16 a[24:27], v[8:11], v[28:31], a[24:27]
    ds_read_b128 v[48:51], v123 offset:22528
    v_mfma_f32_16x16x32_bf16 a[28:31], v[8:11], v[32:35], a[28:31]
    v_mfma_f32_16x16x32_bf16 a[32:35], v[12:15], v[20:23], a[32:35]
    ds_read_b128 v[52:55], v125 offset:16384
    v_mfma_f32_16x16x32_bf16 a[36:39], v[12:15], v[24:27], a[36:39]
    v_mfma_f32_16x16x32_bf16 a[40:43], v[12:15], v[28:31], a[40:43]
    ds_read_b128 v[56:59], v125 offset:18432
    v_mfma_f32_16x16x32_bf16 a[44:47], v[12:15], v[32:35], a[44:47]
    v_mfma_f32_16x16x32_bf16 a[48:51], v[16:19], v[20:23], a[48:51]
    ds_read_b128 v[60:63], v125 offset:20480
    v_mfma_f32_16x16x32_bf16 a[52:55], v[16:19], v[24:27], a[52:55]
    v_mfma_f32_16x16x32_bf16 a[56:59], v[16:19], v[28:31], a[56:59]
    ds_read_b128 v[64:67], v125 offset:22528
    v_mfma_f32_16x16x32_bf16 a[60:63], v[16:19], v[32:35], a[60:63]
    s_waitcnt lgkmcnt(0)
    v_mfma_f32_16x16x32_bf16 a[0:3], v[36:39], v[52:55], a[0:3]
    ds_read_b128 v[4:7], v109 offset:0
    v_mfma_f32_16x16x32_bf16 a[4:7], v[36:39], v[56:59], a[4:7]
    v_mfma_f32_16x16x32_bf16 a[8:11], v[36:39], v[60:63], a[8:11]
    ds_read_b128 v[8:11], v109 offset:2048
    v_mfma_f32_16x16x32_bf16 a[12:15], v[36:39], v[64:67], a[12:15]
    v_mfma_f32_16x16x32_bf16 a[16:19], v[40:43], v[52:55], a[16:19]
    ds_read_b128 v[12:15], v109 offset:4096
    v_mfma_f32_16x16x32_bf16 a[20:23], v[40:43], v[56:59], a[20:23]
    v_mfma_f32_16x16x32_bf16 a[24:27], v[40:43], v[60:63], a[24:27]
    ds_read_b128 v[16:19], v109 offset:6144
    v_mfma_f32_16x16x32_bf16 a[28:31], v[40:43], v[64:67], a[28:31]
    v_mfma_f32_16x16x32_bf16 a[32:35], v[44:47], v[52:55], a[32:35]
    ds_read_b128 v[20:23], v111 offset:0
    s_waitcnt vmcnt(0)
    ds_write_b128 v108, v[68:71] offset:32768
    ds_write_b128 v108, v[72:75] offset:36864
    v_mfma_f32_16x16x32_bf16 a[36:39], v[44:47], v[56:59], a[36:39]
    ds_write_b128 v108, v[76:79] offset:40960
    v_mfma_f32_16x16x32_bf16 a[40:43], v[44:47], v[60:63], a[40:43]
    ds_read_b128 v[24:27], v111 offset:2048
    ds_write_b128 v108, v[80:83] offset:45056
    v_mfma_f32_16x16x32_bf16 a[44:47], v[44:47], v[64:67], a[44:47]
    ds_write_b128 v121, v[84:87] offset:0
    v_mfma_f32_16x16x32_bf16 a[48:51], v[48:51], v[52:55], a[48:51]
    ds_read_b128 v[28:31], v111 offset:4096
    ds_write_b128 v121, v[88:91] offset:4096
    v_mfma_f32_16x16x32_bf16 a[52:55], v[48:51], v[56:59], a[52:55]
    ds_write_b128 v121, v[92:95] offset:8192
    v_mfma_f32_16x16x32_bf16 a[56:59], v[48:51], v[60:63], a[56:59]
    ds_read_b128 v[32:35], v111 offset:6144
    ds_write_b128 v121, v[96:99] offset:12288
    v_mfma_f32_16x16x32_bf16 a[60:63], v[48:51], v[64:67], a[60:63]
    s_waitcnt lgkmcnt(0)
    s_barrier
    buffer_load_dwordx4 v[68:71], v100, s[4:7], s20 offen offset:1024 sc1
    buffer_load_dwordx4 v[72:75], v101, s[4:7], s20 offen offset:1024 sc1
    buffer_load_dwordx4 v[76:79], v102, s[4:7], s20 offen offset:1024 sc1
    buffer_load_dwordx4 v[80:83], v103, s[4:7], s20 offen offset:1024 sc1
    buffer_load_dwordx4 v[84:87], v104, s[4:7], s21 offen offset:1024 sc1
    buffer_load_dwordx4 v[88:91], v105, s[4:7], s21 offen offset:1024 sc1
    buffer_load_dwordx4 v[92:95], v106, s[4:7], s21 offen offset:1024 sc1
    buffer_load_dwordx4 v[96:99], v107, s[4:7], s21 offen offset:1024 sc1
    s_waitcnt lgkmcnt(0)
    v_mfma_f32_16x16x32_bf16 a[0:3], v[4:7], v[20:23], a[0:3]
    ds_read_b128 v[36:39], v110 offset:0
    v_mfma_f32_16x16x32_bf16 a[4:7], v[4:7], v[24:27], a[4:7]
    v_mfma_f32_16x16x32_bf16 a[8:11], v[4:7], v[28:31], a[8:11]
    ds_read_b128 v[40:43], v110 offset:2048
    v_mfma_f32_16x16x32_bf16 a[12:15], v[4:7], v[32:35], a[12:15]
    v_mfma_f32_16x16x32_bf16 a[16:19], v[8:11], v[20:23], a[16:19]
    ds_read_b128 v[44:47], v110 offset:4096
    v_mfma_f32_16x16x32_bf16 a[20:23], v[8:11], v[24:27], a[20:23]
    v_mfma_f32_16x16x32_bf16 a[24:27], v[8:11], v[28:31], a[24:27]
    ds_read_b128 v[48:51], v110 offset:6144
    v_mfma_f32_16x16x32_bf16 a[28:31], v[8:11], v[32:35], a[28:31]
    v_mfma_f32_16x16x32_bf16 a[32:35], v[12:15], v[20:23], a[32:35]
    ds_read_b128 v[52:55], v112 offset:0
    v_mfma_f32_16x16x32_bf16 a[36:39], v[12:15], v[24:27], a[36:39]
    v_mfma_f32_16x16x32_bf16 a[40:43], v[12:15], v[28:31], a[40:43]
    ds_read_b128 v[56:59], v112 offset:2048
    v_mfma_f32_16x16x32_bf16 a[44:47], v[12:15], v[32:35], a[44:47]
    v_mfma_f32_16x16x32_bf16 a[48:51], v[16:19], v[20:23], a[48:51]
    ds_read_b128 v[60:63], v112 offset:4096
    v_mfma_f32_16x16x32_bf16 a[52:55], v[16:19], v[24:27], a[52:55]
    v_mfma_f32_16x16x32_bf16 a[56:59], v[16:19], v[28:31], a[56:59]
    ds_read_b128 v[64:67], v112 offset:6144
    v_mfma_f32_16x16x32_bf16 a[60:63], v[16:19], v[32:35], a[60:63]
    s_waitcnt lgkmcnt(0)
    v_mfma_f32_16x16x32_bf16 a[0:3], v[36:39], v[52:55], a[0:3]
    ds_read_b128 v[4:7], v109 offset:32768
    v_mfma_f32_16x16x32_bf16 a[4:7], v[36:39], v[56:59], a[4:7]
    v_mfma_f32_16x16x32_bf16 a[8:11], v[36:39], v[60:63], a[8:11]
    ds_read_b128 v[8:11], v109 offset:34816
    v_mfma_f32_16x16x32_bf16 a[12:15], v[36:39], v[64:67], a[12:15]
    v_mfma_f32_16x16x32_bf16 a[16:19], v[40:43], v[52:55], a[16:19]
    ds_read_b128 v[12:15], v109 offset:36864
    v_mfma_f32_16x16x32_bf16 a[20:23], v[40:43], v[56:59], a[20:23]
    v_mfma_f32_16x16x32_bf16 a[24:27], v[40:43], v[60:63], a[24:27]
    ds_read_b128 v[16:19], v109 offset:38912
    v_mfma_f32_16x16x32_bf16 a[28:31], v[40:43], v[64:67], a[28:31]
    v_mfma_f32_16x16x32_bf16 a[32:35], v[44:47], v[52:55], a[32:35]
    ds_read_b128 v[20:23], v111 offset:32768
    s_waitcnt vmcnt(0)
    ds_write_b128 v121, v[68:71] offset:16384
    ds_write_b128 v121, v[72:75] offset:20480
    v_mfma_f32_16x16x32_bf16 a[36:39], v[44:47], v[56:59], a[36:39]
    ds_write_b128 v121, v[76:79] offset:24576
    v_mfma_f32_16x16x32_bf16 a[40:43], v[44:47], v[60:63], a[40:43]
    ds_read_b128 v[24:27], v111 offset:34816
    ds_write_b128 v121, v[80:83] offset:28672
    v_mfma_f32_16x16x32_bf16 a[44:47], v[44:47], v[64:67], a[44:47]
    ds_write_b128 v121, v[84:87] offset:32768
    v_mfma_f32_16x16x32_bf16 a[48:51], v[48:51], v[52:55], a[48:51]
    ds_read_b128 v[28:31], v111 offset:36864
    ds_write_b128 v121, v[88:91] offset:36864
    v_mfma_f32_16x16x32_bf16 a[52:55], v[48:51], v[56:59], a[52:55]
    ds_write_b128 v121, v[92:95] offset:40960
    v_mfma_f32_16x16x32_bf16 a[56:59], v[48:51], v[60:63], a[56:59]
    ds_read_b128 v[32:35], v111 offset:38912
    ds_write_b128 v121, v[96:99] offset:45056
    v_mfma_f32_16x16x32_bf16 a[60:63], v[48:51], v[64:67], a[60:63]
    s_waitcnt lgkmcnt(0)
    s_barrier
    buffer_load_dwordx4 v[68:71], v100, s[4:7], s20 offen offset:1152 sc1
    buffer_load_dwordx4 v[72:75], v101, s[4:7], s20 offen offset:1152 sc1
    buffer_load_dwordx4 v[76:79], v102, s[4:7], s20 offen offset:1152 sc1
    buffer_load_dwordx4 v[80:83], v103, s[4:7], s20 offen offset:1152 sc1
    buffer_load_dwordx4 v[84:87], v104, s[4:7], s21 offen offset:1152 sc1
    buffer_load_dwordx4 v[88:91], v105, s[4:7], s21 offen offset:1152 sc1
    buffer_load_dwordx4 v[92:95], v106, s[4:7], s21 offen offset:1152 sc1
    buffer_load_dwordx4 v[96:99], v107, s[4:7], s21 offen offset:1152 sc1
    s_waitcnt lgkmcnt(0)
    v_mfma_f32_16x16x32_bf16 a[0:3], v[4:7], v[20:23], a[0:3]
    ds_read_b128 v[36:39], v110 offset:32768
    v_mfma_f32_16x16x32_bf16 a[4:7], v[4:7], v[24:27], a[4:7]
    v_mfma_f32_16x16x32_bf16 a[8:11], v[4:7], v[28:31], a[8:11]
    ds_read_b128 v[40:43], v110 offset:34816
    v_mfma_f32_16x16x32_bf16 a[12:15], v[4:7], v[32:35], a[12:15]
    v_mfma_f32_16x16x32_bf16 a[16:19], v[8:11], v[20:23], a[16:19]
    ds_read_b128 v[44:47], v110 offset:36864
    v_mfma_f32_16x16x32_bf16 a[20:23], v[8:11], v[24:27], a[20:23]
    v_mfma_f32_16x16x32_bf16 a[24:27], v[8:11], v[28:31], a[24:27]
    ds_read_b128 v[48:51], v110 offset:38912
    v_mfma_f32_16x16x32_bf16 a[28:31], v[8:11], v[32:35], a[28:31]
    v_mfma_f32_16x16x32_bf16 a[32:35], v[12:15], v[20:23], a[32:35]
    ds_read_b128 v[52:55], v112 offset:32768
    v_mfma_f32_16x16x32_bf16 a[36:39], v[12:15], v[24:27], a[36:39]
    v_mfma_f32_16x16x32_bf16 a[40:43], v[12:15], v[28:31], a[40:43]
    ds_read_b128 v[56:59], v112 offset:34816
    v_mfma_f32_16x16x32_bf16 a[44:47], v[12:15], v[32:35], a[44:47]
    v_mfma_f32_16x16x32_bf16 a[48:51], v[16:19], v[20:23], a[48:51]
    ds_read_b128 v[60:63], v112 offset:36864
    v_mfma_f32_16x16x32_bf16 a[52:55], v[16:19], v[24:27], a[52:55]
    v_mfma_f32_16x16x32_bf16 a[56:59], v[16:19], v[28:31], a[56:59]
    ds_read_b128 v[64:67], v112 offset:38912
    v_mfma_f32_16x16x32_bf16 a[60:63], v[16:19], v[32:35], a[60:63]
    s_waitcnt lgkmcnt(0)
    v_mfma_f32_16x16x32_bf16 a[0:3], v[36:39], v[52:55], a[0:3]
    ds_read_b128 v[4:7], v122 offset:16384
    v_mfma_f32_16x16x32_bf16 a[4:7], v[36:39], v[56:59], a[4:7]
    v_mfma_f32_16x16x32_bf16 a[8:11], v[36:39], v[60:63], a[8:11]
    ds_read_b128 v[8:11], v122 offset:18432
    v_mfma_f32_16x16x32_bf16 a[12:15], v[36:39], v[64:67], a[12:15]
    v_mfma_f32_16x16x32_bf16 a[16:19], v[40:43], v[52:55], a[16:19]
    ds_read_b128 v[12:15], v122 offset:20480
    v_mfma_f32_16x16x32_bf16 a[20:23], v[40:43], v[56:59], a[20:23]
    v_mfma_f32_16x16x32_bf16 a[24:27], v[40:43], v[60:63], a[24:27]
    ds_read_b128 v[16:19], v122 offset:22528
    v_mfma_f32_16x16x32_bf16 a[28:31], v[40:43], v[64:67], a[28:31]
    v_mfma_f32_16x16x32_bf16 a[32:35], v[44:47], v[52:55], a[32:35]
    ds_read_b128 v[20:23], v124 offset:16384
    s_waitcnt vmcnt(0)
    ds_write_b128 v108, v[68:71] offset:0
    ds_write_b128 v108, v[72:75] offset:4096
    v_mfma_f32_16x16x32_bf16 a[36:39], v[44:47], v[56:59], a[36:39]
    ds_write_b128 v108, v[76:79] offset:8192
    v_mfma_f32_16x16x32_bf16 a[40:43], v[44:47], v[60:63], a[40:43]
    ds_read_b128 v[24:27], v124 offset:18432
    ds_write_b128 v108, v[80:83] offset:12288
    v_mfma_f32_16x16x32_bf16 a[44:47], v[44:47], v[64:67], a[44:47]
    ds_write_b128 v108, v[84:87] offset:16384
    v_mfma_f32_16x16x32_bf16 a[48:51], v[48:51], v[52:55], a[48:51]
    ds_read_b128 v[28:31], v124 offset:20480
    ds_write_b128 v108, v[88:91] offset:20480
    v_mfma_f32_16x16x32_bf16 a[52:55], v[48:51], v[56:59], a[52:55]
    ds_write_b128 v108, v[92:95] offset:24576
    v_mfma_f32_16x16x32_bf16 a[56:59], v[48:51], v[60:63], a[56:59]
    ds_read_b128 v[32:35], v124 offset:22528
    ds_write_b128 v108, v[96:99] offset:28672
    v_mfma_f32_16x16x32_bf16 a[60:63], v[48:51], v[64:67], a[60:63]
    s_waitcnt lgkmcnt(0)
    s_barrier
    s_waitcnt lgkmcnt(0)
    v_mfma_f32_16x16x32_bf16 a[0:3], v[4:7], v[20:23], a[0:3]
    ds_read_b128 v[36:39], v123 offset:16384
    v_mfma_f32_16x16x32_bf16 a[4:7], v[4:7], v[24:27], a[4:7]
    v_mfma_f32_16x16x32_bf16 a[8:11], v[4:7], v[28:31], a[8:11]
    ds_read_b128 v[40:43], v123 offset:18432
    v_mfma_f32_16x16x32_bf16 a[12:15], v[4:7], v[32:35], a[12:15]
    v_mfma_f32_16x16x32_bf16 a[16:19], v[8:11], v[20:23], a[16:19]
    ds_read_b128 v[44:47], v123 offset:20480
    v_mfma_f32_16x16x32_bf16 a[20:23], v[8:11], v[24:27], a[20:23]
    v_mfma_f32_16x16x32_bf16 a[24:27], v[8:11], v[28:31], a[24:27]
    ds_read_b128 v[48:51], v123 offset:22528
    v_mfma_f32_16x16x32_bf16 a[28:31], v[8:11], v[32:35], a[28:31]
    v_mfma_f32_16x16x32_bf16 a[32:35], v[12:15], v[20:23], a[32:35]
    ds_read_b128 v[52:55], v125 offset:16384
    v_mfma_f32_16x16x32_bf16 a[36:39], v[12:15], v[24:27], a[36:39]
    v_mfma_f32_16x16x32_bf16 a[40:43], v[12:15], v[28:31], a[40:43]
    ds_read_b128 v[56:59], v125 offset:18432
    v_mfma_f32_16x16x32_bf16 a[44:47], v[12:15], v[32:35], a[44:47]
    v_mfma_f32_16x16x32_bf16 a[48:51], v[16:19], v[20:23], a[48:51]
    ds_read_b128 v[60:63], v125 offset:20480
    v_mfma_f32_16x16x32_bf16 a[52:55], v[16:19], v[24:27], a[52:55]
    v_mfma_f32_16x16x32_bf16 a[56:59], v[16:19], v[28:31], a[56:59]
    ds_read_b128 v[64:67], v125 offset:22528
    v_mfma_f32_16x16x32_bf16 a[60:63], v[16:19], v[32:35], a[60:63]
    s_waitcnt lgkmcnt(0)
    v_mfma_f32_16x16x32_bf16 a[0:3], v[36:39], v[52:55], a[0:3]
    ds_read_b128 v[4:7], v109 offset:0
    v_mfma_f32_16x16x32_bf16 a[4:7], v[36:39], v[56:59], a[4:7]
    v_mfma_f32_16x16x32_bf16 a[8:11], v[36:39], v[60:63], a[8:11]
    ds_read_b128 v[8:11], v109 offset:2048
    v_mfma_f32_16x16x32_bf16 a[12:15], v[36:39], v[64:67], a[12:15]
    v_mfma_f32_16x16x32_bf16 a[16:19], v[40:43], v[52:55], a[16:19]
    ds_read_b128 v[12:15], v109 offset:4096
    v_mfma_f32_16x16x32_bf16 a[20:23], v[40:43], v[56:59], a[20:23]
    v_mfma_f32_16x16x32_bf16 a[24:27], v[40:43], v[60:63], a[24:27]
    ds_read_b128 v[16:19], v109 offset:6144
    v_mfma_f32_16x16x32_bf16 a[28:31], v[40:43], v[64:67], a[28:31]
    v_mfma_f32_16x16x32_bf16 a[32:35], v[44:47], v[52:55], a[32:35]
    ds_read_b128 v[20:23], v111 offset:0
    v_mfma_f32_16x16x32_bf16 a[36:39], v[44:47], v[56:59], a[36:39]
    v_mfma_f32_16x16x32_bf16 a[40:43], v[44:47], v[60:63], a[40:43]
    ds_read_b128 v[24:27], v111 offset:2048
    v_mfma_f32_16x16x32_bf16 a[44:47], v[44:47], v[64:67], a[44:47]
    v_mfma_f32_16x16x32_bf16 a[48:51], v[48:51], v[52:55], a[48:51]
    ds_read_b128 v[28:31], v111 offset:4096
    v_mfma_f32_16x16x32_bf16 a[52:55], v[48:51], v[56:59], a[52:55]
    v_mfma_f32_16x16x32_bf16 a[56:59], v[48:51], v[60:63], a[56:59]
    ds_read_b128 v[32:35], v111 offset:6144
    v_mfma_f32_16x16x32_bf16 a[60:63], v[48:51], v[64:67], a[60:63]
    s_waitcnt lgkmcnt(0)
    s_barrier
    s_waitcnt lgkmcnt(0)
    v_mfma_f32_16x16x32_bf16 a[0:3], v[4:7], v[20:23], a[0:3]
    ds_read_b128 v[36:39], v110 offset:0
    v_mfma_f32_16x16x32_bf16 a[4:7], v[4:7], v[24:27], a[4:7]
    v_mfma_f32_16x16x32_bf16 a[8:11], v[4:7], v[28:31], a[8:11]
    ds_read_b128 v[40:43], v110 offset:2048
    v_mfma_f32_16x16x32_bf16 a[12:15], v[4:7], v[32:35], a[12:15]
    v_mfma_f32_16x16x32_bf16 a[16:19], v[8:11], v[20:23], a[16:19]
    ds_read_b128 v[44:47], v110 offset:4096
    v_mfma_f32_16x16x32_bf16 a[20:23], v[8:11], v[24:27], a[20:23]
    v_mfma_f32_16x16x32_bf16 a[24:27], v[8:11], v[28:31], a[24:27]
    ds_read_b128 v[48:51], v110 offset:6144
    v_mfma_f32_16x16x32_bf16 a[28:31], v[8:11], v[32:35], a[28:31]
    v_mfma_f32_16x16x32_bf16 a[32:35], v[12:15], v[20:23], a[32:35]
    ds_read_b128 v[52:55], v112 offset:0
    v_mfma_f32_16x16x32_bf16 a[36:39], v[12:15], v[24:27], a[36:39]
    v_mfma_f32_16x16x32_bf16 a[40:43], v[12:15], v[28:31], a[40:43]
    ds_read_b128 v[56:59], v112 offset:2048
    v_mfma_f32_16x16x32_bf16 a[44:47], v[12:15], v[32:35], a[44:47]
    v_mfma_f32_16x16x32_bf16 a[48:51], v[16:19], v[20:23], a[48:51]
    ds_read_b128 v[60:63], v112 offset:4096
    v_mfma_f32_16x16x32_bf16 a[52:55], v[16:19], v[24:27], a[52:55]
    v_mfma_f32_16x16x32_bf16 a[56:59], v[16:19], v[28:31], a[56:59]
    ds_read_b128 v[64:67], v112 offset:6144
    v_mfma_f32_16x16x32_bf16 a[60:63], v[16:19], v[32:35], a[60:63]
    s_waitcnt lgkmcnt(0)
    v_mfma_f32_16x16x32_bf16 a[0:3], v[36:39], v[52:55], a[0:3]
    v_mfma_f32_16x16x32_bf16 a[4:7], v[36:39], v[56:59], a[4:7]
    v_mfma_f32_16x16x32_bf16 a[8:11], v[36:39], v[60:63], a[8:11]
    v_mfma_f32_16x16x32_bf16 a[12:15], v[36:39], v[64:67], a[12:15]
    v_mfma_f32_16x16x32_bf16 a[16:19], v[40:43], v[52:55], a[16:19]
    v_mfma_f32_16x16x32_bf16 a[20:23], v[40:43], v[56:59], a[20:23]
    v_mfma_f32_16x16x32_bf16 a[24:27], v[40:43], v[60:63], a[24:27]
    v_mfma_f32_16x16x32_bf16 a[28:31], v[40:43], v[64:67], a[28:31]
    v_mfma_f32_16x16x32_bf16 a[32:35], v[44:47], v[52:55], a[32:35]
    v_mfma_f32_16x16x32_bf16 a[36:39], v[44:47], v[56:59], a[36:39]
    v_mfma_f32_16x16x32_bf16 a[40:43], v[44:47], v[60:63], a[40:43]
    v_mfma_f32_16x16x32_bf16 a[44:47], v[44:47], v[64:67], a[44:47]
    v_mfma_f32_16x16x32_bf16 a[48:51], v[48:51], v[52:55], a[48:51]
    v_mfma_f32_16x16x32_bf16 a[52:55], v[48:51], v[56:59], a[52:55]
    v_mfma_f32_16x16x32_bf16 a[56:59], v[48:51], v[60:63], a[56:59]
    v_mfma_f32_16x16x32_bf16 a[60:63], v[48:51], v[64:67], a[60:63]
    s_nop 7
    s_mul_i32 s22, s16, 128
    s_mul_i32 s23, s17, 128
    v_mul_u32_u24 v4, 64, v114
    v_lshl_add_u32 v4, v117, 2, v4
    v_add_u32 v4, s22, v4
    v_mul_u32_u24 v5, 64, v115
    v_add_u32 v5, v5, v116
    v_add_u32 v5, s23, v5
    v_mul_u32_u24 v6, 32, v114
    v_lshl_add_u32 v6, v117, 2, v6
    s_mul_i32 s22, s16, 64
    v_add_u32 v6, s22, v6
    v_mul_u32_u24 v7, 3072, v5
    v_lshl_add_u32 v7, v6, 1, v7
    s_mov_b32 s24, 241139712
    s_mov_b32 s26, 0x3d372713
    s_mov_b32 s27, 0x40135761
    s_add_u32 s25, s24, 0
    v_accvgpr_read_b32 v44, a0
    v_accvgpr_read_b32 v45, a1
    v_accvgpr_read_b32 v46, a2
    v_accvgpr_read_b32 v47, a3
    v_accvgpr_read_b32 v48, a16
    v_accvgpr_read_b32 v49, a17
    v_accvgpr_read_b32 v50, a18
    v_accvgpr_read_b32 v51, a19
    v_cvt_pk_bf16_f32 v12, v44, v45
    v_cvt_pk_bf16_f32 v13, v46, v47
    v_cvt_pk_bf16_f32 v14, v48, v49
    v_cvt_pk_bf16_f32 v15, v50, v51
    v_lshlrev_b32 v16, 16, v12
    v_lshlrev_b32 v20, 16, v14
    v_and_b32 v17, 0xffff0000, v12
    v_and_b32 v21, 0xffff0000, v14
    v_lshlrev_b32 v18, 16, v13
    v_lshlrev_b32 v22, 16, v15
    v_and_b32 v19, 0xffff0000, v13
    v_and_b32 v23, 0xffff0000, v15
    v_mul_f32 v24, v16, v16
    v_mul_f32 v24, s26, v24
    v_fma_f32 v24, v24, v16, v16
    v_mul_f32 v24, s27, v24
    v_sub_f32 v24, 0, v24
    v_min_f32 v24, 0x42fc0000, v24
    v_mul_f32 v25, v17, v17
    v_mul_f32 v25, s26, v25
    v_fma_f32 v25, v25, v17, v17
    v_mul_f32 v25, s27, v25
    v_sub_f32 v25, 0, v25
    v_min_f32 v25, 0x42fc0000, v25
    v_mul_f32 v26, v18, v18
    v_mul_f32 v26, s26, v26
    v_fma_f32 v26, v26, v18, v18
    v_mul_f32 v26, s27, v26
    v_sub_f32 v26, 0, v26
    v_min_f32 v26, 0x42fc0000, v26
    v_mul_f32 v27, v19, v19
    v_mul_f32 v27, s26, v27
    v_fma_f32 v27, v27, v19, v19
    v_mul_f32 v27, s27, v27
    v_sub_f32 v27, 0, v27
    v_min_f32 v27, 0x42fc0000, v27
    v_exp_f32 v24, v24
    v_exp_f32 v25, v25
    v_exp_f32 v26, v26
    v_exp_f32 v27, v27
    v_add_f32 v24, 1.0, v24
    v_add_f32 v25, 1.0, v25
    v_add_f32 v26, 1.0, v26
    v_add_f32 v27, 1.0, v27
    v_rcp_f32 v24, v24
    v_rcp_f32 v25, v25
    v_rcp_f32 v26, v26
    v_rcp_f32 v27, v27
    s_nop 0
    v_mul_f32 v16, v16, v24
    v_mul_f32 v17, v17, v25
    v_mul_f32 v18, v18, v26
    v_mul_f32 v19, v19, v27
    v_cvt_pk_bf16_f32 v12, v16, v17
    v_cvt_pk_bf16_f32 v13, v18, v19
    v_lshlrev_b32 v16, 16, v12
    v_mul_f32 v16, v16, v20
    v_and_b32 v17, 0xffff0000, v12
    v_mul_f32 v17, v17, v21
    v_lshlrev_b32 v18, 16, v13
    v_mul_f32 v18, v18, v22
    v_and_b32 v19, 0xffff0000, v13
    v_mul_f32 v19, v19, v23
    v_cvt_pk_bf16_f32 v8, v16, v17
    v_cvt_pk_bf16_f32 v9, v18, v19
    buffer_store_dwordx2 v[8:9], v7, s[4:7], s25 offen offset:0 sc1
    v_accvgpr_read_b32 v44, a32
    v_accvgpr_read_b32 v45, a33
    v_accvgpr_read_b32 v46, a34
    v_accvgpr_read_b32 v47, a35
    v_accvgpr_read_b32 v48, a48
    v_accvgpr_read_b32 v49, a49
    v_accvgpr_read_b32 v50, a50
    v_accvgpr_read_b32 v51, a51
    v_cvt_pk_bf16_f32 v12, v44, v45
    v_cvt_pk_bf16_f32 v13, v46, v47
    v_cvt_pk_bf16_f32 v14, v48, v49
    v_cvt_pk_bf16_f32 v15, v50, v51
    v_lshlrev_b32 v16, 16, v12
    v_lshlrev_b32 v20, 16, v14
    v_and_b32 v17, 0xffff0000, v12
    v_and_b32 v21, 0xffff0000, v14
    v_lshlrev_b32 v18, 16, v13
    v_lshlrev_b32 v22, 16, v15
    v_and_b32 v19, 0xffff0000, v13
    v_and_b32 v23, 0xffff0000, v15
    v_mul_f32 v24, v16, v16
    v_mul_f32 v24, s26, v24
    v_fma_f32 v24, v24, v16, v16
    v_mul_f32 v24, s27, v24
    v_sub_f32 v24, 0, v24
    v_min_f32 v24, 0x42fc0000, v24
    v_mul_f32 v25, v17, v17
    v_mul_f32 v25, s26, v25
    v_fma_f32 v25, v25, v17, v17
    v_mul_f32 v25, s27, v25
    v_sub_f32 v25, 0, v25
    v_min_f32 v25, 0x42fc0000, v25
    v_mul_f32 v26, v18, v18
    v_mul_f32 v26, s26, v26
    v_fma_f32 v26, v26, v18, v18
    v_mul_f32 v26, s27, v26
    v_sub_f32 v26, 0, v26
    v_min_f32 v26, 0x42fc0000, v26
    v_mul_f32 v27, v19, v19
    v_mul_f32 v27, s26, v27
    v_fma_f32 v27, v27, v19, v19
    v_mul_f32 v27, s27, v27
    v_sub_f32 v27, 0, v27
    v_min_f32 v27, 0x42fc0000, v27
    v_exp_f32 v24, v24
    v_exp_f32 v25, v25
    v_exp_f32 v26, v26
    v_exp_f32 v27, v27
    v_add_f32 v24, 1.0, v24
    v_add_f32 v25, 1.0, v25
    v_add_f32 v26, 1.0, v26
    v_add_f32 v27, 1.0, v27
    v_rcp_f32 v24, v24
    v_rcp_f32 v25, v25
    v_rcp_f32 v26, v26
    v_rcp_f32 v27, v27
    s_nop 0
    v_mul_f32 v16, v16, v24
    v_mul_f32 v17, v17, v25
    v_mul_f32 v18, v18, v26
    v_mul_f32 v19, v19, v27
    v_cvt_pk_bf16_f32 v12, v16, v17
    v_cvt_pk_bf16_f32 v13, v18, v19
    v_lshlrev_b32 v16, 16, v12
    v_mul_f32 v16, v16, v20
    v_and_b32 v17, 0xffff0000, v12
    v_mul_f32 v17, v17, v21
    v_lshlrev_b32 v18, 16, v13
    v_mul_f32 v18, v18, v22
    v_and_b32 v19, 0xffff0000, v13
    v_mul_f32 v19, v19, v23
    v_cvt_pk_bf16_f32 v10, v16, v17
    v_cvt_pk_bf16_f32 v11, v18, v19
    buffer_store_dwordx2 v[10:11], v7, s[4:7], s25 offen offset:32 sc1
    s_add_u32 s25, s24, 49152
    v_accvgpr_read_b32 v44, a4
    v_accvgpr_read_b32 v45, a5
    v_accvgpr_read_b32 v46, a6
    v_accvgpr_read_b32 v47, a7
    v_accvgpr_read_b32 v48, a20
    v_accvgpr_read_b32 v49, a21
    v_accvgpr_read_b32 v50, a22
    v_accvgpr_read_b32 v51, a23
    v_cvt_pk_bf16_f32 v12, v44, v45
    v_cvt_pk_bf16_f32 v13, v46, v47
    v_cvt_pk_bf16_f32 v14, v48, v49
    v_cvt_pk_bf16_f32 v15, v50, v51
    v_lshlrev_b32 v16, 16, v12
    v_lshlrev_b32 v20, 16, v14
    v_and_b32 v17, 0xffff0000, v12
    v_and_b32 v21, 0xffff0000, v14
    v_lshlrev_b32 v18, 16, v13
    v_lshlrev_b32 v22, 16, v15
    v_and_b32 v19, 0xffff0000, v13
    v_and_b32 v23, 0xffff0000, v15
    v_mul_f32 v24, v16, v16
    v_mul_f32 v24, s26, v24
    v_fma_f32 v24, v24, v16, v16
    v_mul_f32 v24, s27, v24
    v_sub_f32 v24, 0, v24
    v_min_f32 v24, 0x42fc0000, v24
    v_mul_f32 v25, v17, v17
    v_mul_f32 v25, s26, v25
    v_fma_f32 v25, v25, v17, v17
    v_mul_f32 v25, s27, v25
    v_sub_f32 v25, 0, v25
    v_min_f32 v25, 0x42fc0000, v25
    v_mul_f32 v26, v18, v18
    v_mul_f32 v26, s26, v26
    v_fma_f32 v26, v26, v18, v18
    v_mul_f32 v26, s27, v26
    v_sub_f32 v26, 0, v26
    v_min_f32 v26, 0x42fc0000, v26
    v_mul_f32 v27, v19, v19
    v_mul_f32 v27, s26, v27
    v_fma_f32 v27, v27, v19, v19
    v_mul_f32 v27, s27, v27
    v_sub_f32 v27, 0, v27
    v_min_f32 v27, 0x42fc0000, v27
    v_exp_f32 v24, v24
    v_exp_f32 v25, v25
    v_exp_f32 v26, v26
    v_exp_f32 v27, v27
    v_add_f32 v24, 1.0, v24
    v_add_f32 v25, 1.0, v25
    v_add_f32 v26, 1.0, v26
    v_add_f32 v27, 1.0, v27
    v_rcp_f32 v24, v24
    v_rcp_f32 v25, v25
    v_rcp_f32 v26, v26
    v_rcp_f32 v27, v27
    s_nop 0
    v_mul_f32 v16, v16, v24
    v_mul_f32 v17, v17, v25
    v_mul_f32 v18, v18, v26
    v_mul_f32 v19, v19, v27
    v_cvt_pk_bf16_f32 v12, v16, v17
    v_cvt_pk_bf16_f32 v13, v18, v19
    v_lshlrev_b32 v16, 16, v12
    v_mul_f32 v16, v16, v20
    v_and_b32 v17, 0xffff0000, v12
    v_mul_f32 v17, v17, v21
    v_lshlrev_b32 v18, 16, v13
    v_mul_f32 v18, v18, v22
    v_and_b32 v19, 0xffff0000, v13
    v_mul_f32 v19, v19, v23
    v_cvt_pk_bf16_f32 v8, v16, v17
    v_cvt_pk_bf16_f32 v9, v18, v19
    buffer_store_dwordx2 v[8:9], v7, s[4:7], s25 offen offset:0 sc1
    v_accvgpr_read_b32 v44, a36
    v_accvgpr_read_b32 v45, a37
    v_accvgpr_read_b32 v46, a38
    v_accvgpr_read_b32 v47, a39
    v_accvgpr_read_b32 v48, a52
    v_accvgpr_read_b32 v49, a53
    v_accvgpr_read_b32 v50, a54
    v_accvgpr_read_b32 v51, a55
    v_cvt_pk_bf16_f32 v12, v44, v45
    v_cvt_pk_bf16_f32 v13, v46, v47
    v_cvt_pk_bf16_f32 v14, v48, v49
    v_cvt_pk_bf16_f32 v15, v50, v51
    v_lshlrev_b32 v16, 16, v12
    v_lshlrev_b32 v20, 16, v14
    v_and_b32 v17, 0xffff0000, v12
    v_and_b32 v21, 0xffff0000, v14
    v_lshlrev_b32 v18, 16, v13
    v_lshlrev_b32 v22, 16, v15
    v_and_b32 v19, 0xffff0000, v13
    v_and_b32 v23, 0xffff0000, v15
    v_mul_f32 v24, v16, v16
    v_mul_f32 v24, s26, v24
    v_fma_f32 v24, v24, v16, v16
    v_mul_f32 v24, s27, v24
    v_sub_f32 v24, 0, v24
    v_min_f32 v24, 0x42fc0000, v24
    v_mul_f32 v25, v17, v17
    v_mul_f32 v25, s26, v25
    v_fma_f32 v25, v25, v17, v17
    v_mul_f32 v25, s27, v25
    v_sub_f32 v25, 0, v25
    v_min_f32 v25, 0x42fc0000, v25
    v_mul_f32 v26, v18, v18
    v_mul_f32 v26, s26, v26
    v_fma_f32 v26, v26, v18, v18
    v_mul_f32 v26, s27, v26
    v_sub_f32 v26, 0, v26
    v_min_f32 v26, 0x42fc0000, v26
    v_mul_f32 v27, v19, v19
    v_mul_f32 v27, s26, v27
    v_fma_f32 v27, v27, v19, v19
    v_mul_f32 v27, s27, v27
    v_sub_f32 v27, 0, v27
    v_min_f32 v27, 0x42fc0000, v27
    v_exp_f32 v24, v24
    v_exp_f32 v25, v25
    v_exp_f32 v26, v26
    v_exp_f32 v27, v27
    v_add_f32 v24, 1.0, v24
    v_add_f32 v25, 1.0, v25
    v_add_f32 v26, 1.0, v26
    v_add_f32 v27, 1.0, v27
    v_rcp_f32 v24, v24
    v_rcp_f32 v25, v25
    v_rcp_f32 v26, v26
    v_rcp_f32 v27, v27
    s_nop 0
    v_mul_f32 v16, v16, v24
    v_mul_f32 v17, v17, v25
    v_mul_f32 v18, v18, v26
    v_mul_f32 v19, v19, v27
    v_cvt_pk_bf16_f32 v12, v16, v17
    v_cvt_pk_bf16_f32 v13, v18, v19
    v_lshlrev_b32 v16, 16, v12
    v_mul_f32 v16, v16, v20
    v_and_b32 v17, 0xffff0000, v12
    v_mul_f32 v17, v17, v21
    v_lshlrev_b32 v18, 16, v13
    v_mul_f32 v18, v18, v22
    v_and_b32 v19, 0xffff0000, v13
    v_mul_f32 v19, v19, v23
    v_cvt_pk_bf16_f32 v10, v16, v17
    v_cvt_pk_bf16_f32 v11, v18, v19
    buffer_store_dwordx2 v[10:11], v7, s[4:7], s25 offen offset:32 sc1
    s_add_u32 s25, s24, 98304
    v_accvgpr_read_b32 v44, a8
    v_accvgpr_read_b32 v45, a9
    v_accvgpr_read_b32 v46, a10
    v_accvgpr_read_b32 v47, a11
    v_accvgpr_read_b32 v48, a24
    v_accvgpr_read_b32 v49, a25
    v_accvgpr_read_b32 v50, a26
    v_accvgpr_read_b32 v51, a27
    v_cvt_pk_bf16_f32 v12, v44, v45
    v_cvt_pk_bf16_f32 v13, v46, v47
    v_cvt_pk_bf16_f32 v14, v48, v49
    v_cvt_pk_bf16_f32 v15, v50, v51
    v_lshlrev_b32 v16, 16, v12
    v_lshlrev_b32 v20, 16, v14
    v_and_b32 v17, 0xffff0000, v12
    v_and_b32 v21, 0xffff0000, v14
    v_lshlrev_b32 v18, 16, v13
    v_lshlrev_b32 v22, 16, v15
    v_and_b32 v19, 0xffff0000, v13
    v_and_b32 v23, 0xffff0000, v15
    v_mul_f32 v24, v16, v16
    v_mul_f32 v24, s26, v24
    v_fma_f32 v24, v24, v16, v16
    v_mul_f32 v24, s27, v24
    v_sub_f32 v24, 0, v24
    v_min_f32 v24, 0x42fc0000, v24
    v_mul_f32 v25, v17, v17
    v_mul_f32 v25, s26, v25
    v_fma_f32 v25, v25, v17, v17
    v_mul_f32 v25, s27, v25
    v_sub_f32 v25, 0, v25
    v_min_f32 v25, 0x42fc0000, v25
    v_mul_f32 v26, v18, v18
    v_mul_f32 v26, s26, v26
    v_fma_f32 v26, v26, v18, v18
    v_mul_f32 v26, s27, v26
    v_sub_f32 v26, 0, v26
    v_min_f32 v26, 0x42fc0000, v26
    v_mul_f32 v27, v19, v19
    v_mul_f32 v27, s26, v27
    v_fma_f32 v27, v27, v19, v19
    v_mul_f32 v27, s27, v27
    v_sub_f32 v27, 0, v27
    v_min_f32 v27, 0x42fc0000, v27
    v_exp_f32 v24, v24
    v_exp_f32 v25, v25
    v_exp_f32 v26, v26
    v_exp_f32 v27, v27
    v_add_f32 v24, 1.0, v24
    v_add_f32 v25, 1.0, v25
    v_add_f32 v26, 1.0, v26
    v_add_f32 v27, 1.0, v27
    v_rcp_f32 v24, v24
    v_rcp_f32 v25, v25
    v_rcp_f32 v26, v26
    v_rcp_f32 v27, v27
    s_nop 0
    v_mul_f32 v16, v16, v24
    v_mul_f32 v17, v17, v25
    v_mul_f32 v18, v18, v26
    v_mul_f32 v19, v19, v27
    v_cvt_pk_bf16_f32 v12, v16, v17
    v_cvt_pk_bf16_f32 v13, v18, v19
    v_lshlrev_b32 v16, 16, v12
    v_mul_f32 v16, v16, v20
    v_and_b32 v17, 0xffff0000, v12
    v_mul_f32 v17, v17, v21
    v_lshlrev_b32 v18, 16, v13
    v_mul_f32 v18, v18, v22
    v_and_b32 v19, 0xffff0000, v13
    v_mul_f32 v19, v19, v23
    v_cvt_pk_bf16_f32 v8, v16, v17
    v_cvt_pk_bf16_f32 v9, v18, v19
    buffer_store_dwordx2 v[8:9], v7, s[4:7], s25 offen offset:0 sc1
    v_accvgpr_read_b32 v44, a40
    v_accvgpr_read_b32 v45, a41
    v_accvgpr_read_b32 v46, a42
    v_accvgpr_read_b32 v47, a43
    v_accvgpr_read_b32 v48, a56
    v_accvgpr_read_b32 v49, a57
    v_accvgpr_read_b32 v50, a58
    v_accvgpr_read_b32 v51, a59
    v_cvt_pk_bf16_f32 v12, v44, v45
    v_cvt_pk_bf16_f32 v13, v46, v47
    v_cvt_pk_bf16_f32 v14, v48, v49
    v_cvt_pk_bf16_f32 v15, v50, v51
    v_lshlrev_b32 v16, 16, v12
    v_lshlrev_b32 v20, 16, v14
    v_and_b32 v17, 0xffff0000, v12
    v_and_b32 v21, 0xffff0000, v14
    v_lshlrev_b32 v18, 16, v13
    v_lshlrev_b32 v22, 16, v15
    v_and_b32 v19, 0xffff0000, v13
    v_and_b32 v23, 0xffff0000, v15
    v_mul_f32 v24, v16, v16
    v_mul_f32 v24, s26, v24
    v_fma_f32 v24, v24, v16, v16
    v_mul_f32 v24, s27, v24
    v_sub_f32 v24, 0, v24
    v_min_f32 v24, 0x42fc0000, v24
    v_mul_f32 v25, v17, v17
    v_mul_f32 v25, s26, v25
    v_fma_f32 v25, v25, v17, v17
    v_mul_f32 v25, s27, v25
    v_sub_f32 v25, 0, v25
    v_min_f32 v25, 0x42fc0000, v25
    v_mul_f32 v26, v18, v18
    v_mul_f32 v26, s26, v26
    v_fma_f32 v26, v26, v18, v18
    v_mul_f32 v26, s27, v26
    v_sub_f32 v26, 0, v26
    v_min_f32 v26, 0x42fc0000, v26
    v_mul_f32 v27, v19, v19
    v_mul_f32 v27, s26, v27
    v_fma_f32 v27, v27, v19, v19
    v_mul_f32 v27, s27, v27
    v_sub_f32 v27, 0, v27
    v_min_f32 v27, 0x42fc0000, v27
    v_exp_f32 v24, v24
    v_exp_f32 v25, v25
    v_exp_f32 v26, v26
    v_exp_f32 v27, v27
    v_add_f32 v24, 1.0, v24
    v_add_f32 v25, 1.0, v25
    v_add_f32 v26, 1.0, v26
    v_add_f32 v27, 1.0, v27
    v_rcp_f32 v24, v24
    v_rcp_f32 v25, v25
    v_rcp_f32 v26, v26
    v_rcp_f32 v27, v27
    s_nop 0
    v_mul_f32 v16, v16, v24
    v_mul_f32 v17, v17, v25
    v_mul_f32 v18, v18, v26
    v_mul_f32 v19, v19, v27
    v_cvt_pk_bf16_f32 v12, v16, v17
    v_cvt_pk_bf16_f32 v13, v18, v19
    v_lshlrev_b32 v16, 16, v12
    v_mul_f32 v16, v16, v20
    v_and_b32 v17, 0xffff0000, v12
    v_mul_f32 v17, v17, v21
    v_lshlrev_b32 v18, 16, v13
    v_mul_f32 v18, v18, v22
    v_and_b32 v19, 0xffff0000, v13
    v_mul_f32 v19, v19, v23
    v_cvt_pk_bf16_f32 v10, v16, v17
    v_cvt_pk_bf16_f32 v11, v18, v19
    buffer_store_dwordx2 v[10:11], v7, s[4:7], s25 offen offset:32 sc1
    s_add_u32 s25, s24, 147456
    v_accvgpr_read_b32 v44, a12
    v_accvgpr_read_b32 v45, a13
    v_accvgpr_read_b32 v46, a14
    v_accvgpr_read_b32 v47, a15
    v_accvgpr_read_b32 v48, a28
    v_accvgpr_read_b32 v49, a29
    v_accvgpr_read_b32 v50, a30
    v_accvgpr_read_b32 v51, a31
    v_cvt_pk_bf16_f32 v12, v44, v45
    v_cvt_pk_bf16_f32 v13, v46, v47
    v_cvt_pk_bf16_f32 v14, v48, v49
    v_cvt_pk_bf16_f32 v15, v50, v51
    v_lshlrev_b32 v16, 16, v12
    v_lshlrev_b32 v20, 16, v14
    v_and_b32 v17, 0xffff0000, v12
    v_and_b32 v21, 0xffff0000, v14
    v_lshlrev_b32 v18, 16, v13
    v_lshlrev_b32 v22, 16, v15
    v_and_b32 v19, 0xffff0000, v13
    v_and_b32 v23, 0xffff0000, v15
    v_mul_f32 v24, v16, v16
    v_mul_f32 v24, s26, v24
    v_fma_f32 v24, v24, v16, v16
    v_mul_f32 v24, s27, v24
    v_sub_f32 v24, 0, v24
    v_min_f32 v24, 0x42fc0000, v24
    v_mul_f32 v25, v17, v17
    v_mul_f32 v25, s26, v25
    v_fma_f32 v25, v25, v17, v17
    v_mul_f32 v25, s27, v25
    v_sub_f32 v25, 0, v25
    v_min_f32 v25, 0x42fc0000, v25
    v_mul_f32 v26, v18, v18
    v_mul_f32 v26, s26, v26
    v_fma_f32 v26, v26, v18, v18
    v_mul_f32 v26, s27, v26
    v_sub_f32 v26, 0, v26
    v_min_f32 v26, 0x42fc0000, v26
    v_mul_f32 v27, v19, v19
    v_mul_f32 v27, s26, v27
    v_fma_f32 v27, v27, v19, v19
    v_mul_f32 v27, s27, v27
    v_sub_f32 v27, 0, v27
    v_min_f32 v27, 0x42fc0000, v27
    v_exp_f32 v24, v24
    v_exp_f32 v25, v25
    v_exp_f32 v26, v26
    v_exp_f32 v27, v27
    v_add_f32 v24, 1.0, v24
    v_add_f32 v25, 1.0, v25
    v_add_f32 v26, 1.0, v26
    v_add_f32 v27, 1.0, v27
    v_rcp_f32 v24, v24
    v_rcp_f32 v25, v25
    v_rcp_f32 v26, v26
    v_rcp_f32 v27, v27
    s_nop 0
    v_mul_f32 v16, v16, v24
    v_mul_f32 v17, v17, v25
    v_mul_f32 v18, v18, v26
    v_mul_f32 v19, v19, v27
    v_cvt_pk_bf16_f32 v12, v16, v17
    v_cvt_pk_bf16_f32 v13, v18, v19
    v_lshlrev_b32 v16, 16, v12
    v_mul_f32 v16, v16, v20
    v_and_b32 v17, 0xffff0000, v12
    v_mul_f32 v17, v17, v21
    v_lshlrev_b32 v18, 16, v13
    v_mul_f32 v18, v18, v22
    v_and_b32 v19, 0xffff0000, v13
    v_mul_f32 v19, v19, v23
    v_cvt_pk_bf16_f32 v8, v16, v17
    v_cvt_pk_bf16_f32 v9, v18, v19
    buffer_store_dwordx2 v[8:9], v7, s[4:7], s25 offen offset:0 sc1
    v_accvgpr_read_b32 v44, a44
    v_accvgpr_read_b32 v45, a45
    v_accvgpr_read_b32 v46, a46
    v_accvgpr_read_b32 v47, a47
    v_accvgpr_read_b32 v48, a60
    v_accvgpr_read_b32 v49, a61
    v_accvgpr_read_b32 v50, a62
    v_accvgpr_read_b32 v51, a63
    v_cvt_pk_bf16_f32 v12, v44, v45
    v_cvt_pk_bf16_f32 v13, v46, v47
    v_cvt_pk_bf16_f32 v14, v48, v49
    v_cvt_pk_bf16_f32 v15, v50, v51
    v_lshlrev_b32 v16, 16, v12
    v_lshlrev_b32 v20, 16, v14
    v_and_b32 v17, 0xffff0000, v12
    v_and_b32 v21, 0xffff0000, v14
    v_lshlrev_b32 v18, 16, v13
    v_lshlrev_b32 v22, 16, v15
    v_and_b32 v19, 0xffff0000, v13
    v_and_b32 v23, 0xffff0000, v15
    v_mul_f32 v24, v16, v16
    v_mul_f32 v24, s26, v24
    v_fma_f32 v24, v24, v16, v16
    v_mul_f32 v24, s27, v24
    v_sub_f32 v24, 0, v24
    v_min_f32 v24, 0x42fc0000, v24
    v_mul_f32 v25, v17, v17
    v_mul_f32 v25, s26, v25
    v_fma_f32 v25, v25, v17, v17
    v_mul_f32 v25, s27, v25
    v_sub_f32 v25, 0, v25
    v_min_f32 v25, 0x42fc0000, v25
    v_mul_f32 v26, v18, v18
    v_mul_f32 v26, s26, v26
    v_fma_f32 v26, v26, v18, v18
    v_mul_f32 v26, s27, v26
    v_sub_f32 v26, 0, v26
    v_min_f32 v26, 0x42fc0000, v26
    v_mul_f32 v27, v19, v19
    v_mul_f32 v27, s26, v27
    v_fma_f32 v27, v27, v19, v19
    v_mul_f32 v27, s27, v27
    v_sub_f32 v27, 0, v27
    v_min_f32 v27, 0x42fc0000, v27
    v_exp_f32 v24, v24
    v_exp_f32 v25, v25
    v_exp_f32 v26, v26
    v_exp_f32 v27, v27
    v_add_f32 v24, 1.0, v24
    v_add_f32 v25, 1.0, v25
    v_add_f32 v26, 1.0, v26
    v_add_f32 v27, 1.0, v27
    v_rcp_f32 v24, v24
    v_rcp_f32 v25, v25
    v_rcp_f32 v26, v26
    v_rcp_f32 v27, v27
    s_nop 0
    v_mul_f32 v16, v16, v24
    v_mul_f32 v17, v17, v25
    v_mul_f32 v18, v18, v26
    v_mul_f32 v19, v19, v27
    v_cvt_pk_bf16_f32 v12, v16, v17
    v_cvt_pk_bf16_f32 v13, v18, v19
    v_lshlrev_b32 v16, 16, v12
    v_mul_f32 v16, v16, v20
    v_and_b32 v17, 0xffff0000, v12
    v_mul_f32 v17, v17, v21
    v_lshlrev_b32 v18, 16, v13
    v_mul_f32 v18, v18, v22
    v_and_b32 v19, 0xffff0000, v13
    v_mul_f32 v19, v19, v23
    v_cvt_pk_bf16_f32 v10, v16, v17
    v_cvt_pk_bf16_f32 v11, v18, v19
    buffer_store_dwordx2 v[10:11], v7, s[4:7], s25 offen offset:32 sc1
    s_branch wk_fin
wk_ffn2_big:
    s_mul_i32 s20, s16, 196608
    s_add_u32 s20, s20, 38010880
    s_mul_i32 s21, s17, 196608
    s_add_u32 s21, s21, 241139712
    v_lshrrev_b32 v61, 3, v0
    v_and_b32 v62, 7, v0
    v_add_u32 v63, 0, v61
    v_mul_u32_u24 v52, 3072, v63
    v_lshl_add_u32 v52, v62, 4, v52
    v_mul_u32_u24 v54, 3072, v63
    v_lshl_add_u32 v54, v62, 4, v54
    v_add_u32 v63, 32, v61
    v_mul_u32_u24 v53, 3072, v63
    v_lshl_add_u32 v53, v62, 4, v53
    v_mul_u32_u24 v55, 3072, v63
    v_lshl_add_u32 v55, v62, 4, v55
    v_and_b32 v63, 7, v61
    v_xor_b32 v63, v63, v62
    v_lshlrev_b32 v63, 4, v63
    v_lshl_add_u32 v56, v61, 7, v63
    v_lshrrev_b32 v61, 6, v0
    v_lshrrev_b32 v62, 1, v61
    v_and_b32 v63, 1, v61
    v_and_b32 v64, 15, v0
    v_bfe_u32 v65, v0, 4, 2
    v_and_b32 v66, 7, v0
    v_xor_b32 v66, v66, v65
    v_lshlrev_b32 v66, 4, v66
    v_mul_u32_u24 v67, 32, v62
    v_add_u32 v67, v67, v64
    v_lshl_add_u32 v57, v67, 7, v66
    v_xor_b32 v58, 64, v57
    v_mul_u32_u24 v67, 32, v63
    v_add_u32 v67, v67, v64
    v_lshl_add_u32 v59, v67, 7, v66
    v_add_u32 v59, 8192, v59
    v_xor_b32 v60, 64, v59
    v_accvgpr_write_b32 a0, 0
    v_accvgpr_write_b32 a1, 0
    v_accvgpr_write_b32 a2, 0
    v_accvgpr_write_b32 a3, 0
    v_accvgpr_write_b32 a4, 0
    v_accvgpr_write_b32 a5, 0
    v_accvgpr_write_b32 a6, 0
    v_accvgpr_write_b32 a7, 0
    v_accvgpr_write_b32 a8, 0
    v_accvgpr_write_b32 a9, 0
    v_accvgpr_write_b32 a10, 0
    v_accvgpr_write_b32 a11, 0
    v_accvgpr_write_b32 a12, 0
    v_accvgpr_write_b32 a13, 0
    v_accvgpr_write_b32 a14, 0
    v_accvgpr_write_b32 a15, 0
    v_add_u32 v69, 0xc000, v56
    v_add_u32 v74, 0x18000, v56
    v_add_u32 v70, 0xc000, v57
    v_add_u32 v75, 0x18000, v57
    v_add_u32 v71, 0xc000, v58
    v_add_u32 v76, 0x18000, v58
    v_add_u32 v72, 0xc000, v59
    v_add_u32 v77, 0x18000, v59
    v_add_u32 v73, 0xc000, v60
    v_add_u32 v78, 0x18000, v60
    buffer_load_dwordx4 v[36:39], v52, s[4:7], s20 offen offset:0 sc1
    buffer_load_dwordx4 v[40:43], v53, s[4:7], s20 offen offset:0 sc1
    buffer_load_dwordx4 v[44:47], v54, s[4:7], s21 offen offset:0 sc1
    buffer_load_dwordx4 v[48:51], v55, s[4:7], s21 offen offset:0 sc1
    s_waitcnt vmcnt(0)
    ds_write_b128 v56, v[36:39] offset:0
    ds_write_b128 v56, v[40:43] offset:4096
    ds_write_b128 v56, v[44:47] offset:8192
    ds_write_b128 v56, v[48:51] offset:12288
    buffer_load_dwordx4 v[36:39], v52, s[4:7], s20 offen offset:128 sc1
    buffer_load_dwordx4 v[40:43], v53, s[4:7], s20 offen offset:128 sc1
    buffer_load_dwordx4 v[44:47], v54, s[4:7], s21 offen offset:128 sc1
    buffer_load_dwordx4 v[48:51], v55, s[4:7], s21 offen offset:128 sc1
    s_waitcnt vmcnt(0)
    ds_write_b128 v56, v[36:39] offset:16384
    ds_write_b128 v56, v[40:43] offset:20480
    ds_write_b128 v56, v[44:47] offset:24576
    ds_write_b128 v56, v[48:51] offset:28672
    s_waitcnt lgkmcnt(0)
    s_barrier
    ds_read_b128 v[4:7], v57 offset:0
    ds_read_b128 v[8:11], v57 offset:2048
    ds_read_b128 v[12:15], v59 offset:0
    ds_read_b128 v[16:19], v59 offset:2048
    buffer_load_dwordx4 v[36:39], v52, s[4:7], s20 offen offset:256 sc1
    buffer_load_dwordx4 v[40:43], v53, s[4:7], s20 offen offset:256 sc1
    buffer_load_dwordx4 v[44:47], v54, s[4:7], s21 offen offset:256 sc1
    buffer_load_dwordx4 v[48:51], v55, s[4:7], s21 offen offset:256 sc1
    s_waitcnt lgkmcnt(0)
    v_mfma_f32_16x16x32_bf16 a[0:3], v[4:7], v[12:15], a[0:3]
    ds_read_b128 v[20:23], v58 offset:0
    v_mfma_f32_16x16x32_bf16 a[4:7], v[4:7], v[16:19], a[4:7]
    ds_read_b128 v[24:27], v58 offset:2048
    v_mfma_f32_16x16x32_bf16 a[8:11], v[8:11], v[12:15], a[8:11]
    ds_read_b128 v[28:31], v60 offset:0
    v_mfma_f32_16x16x32_bf16 a[12:15], v[8:11], v[16:19], a[12:15]
    ds_read_b128 v[32:35], v60 offset:2048
    s_waitcnt lgkmcnt(0)
    v_mfma_f32_16x16x32_bf16 a[0:3], v[20:23], v[28:31], a[0:3]
    ds_read_b128 v[4:7], v57 offset:16384
    v_mfma_f32_16x16x32_bf16 a[4:7], v[20:23], v[32:35], a[4:7]
    ds_read_b128 v[8:11], v57 offset:18432
    v_mfma_f32_16x16x32_bf16 a[8:11], v[24:27], v[28:31], a[8:11]
    ds_read_b128 v[12:15], v59 offset:16384
    s_waitcnt vmcnt(0)
    ds_write_b128 v56, v[36:39] offset:32768
    ds_write_b128 v56, v[40:43] offset:36864
    ds_write_b128 v56, v[44:47] offset:40960
    ds_write_b128 v56, v[48:51] offset:45056
    v_mfma_f32_16x16x32_bf16 a[12:15], v[24:27], v[32:35], a[12:15]
    ds_read_b128 v[16:19], v59 offset:18432
    s_waitcnt lgkmcnt(0)
    s_barrier
    buffer_load_dwordx4 v[36:39], v52, s[4:7], s20 offen offset:384 sc1
    buffer_load_dwordx4 v[40:43], v53, s[4:7], s20 offen offset:384 sc1
    buffer_load_dwordx4 v[44:47], v54, s[4:7], s21 offen offset:384 sc1
    buffer_load_dwordx4 v[48:51], v55, s[4:7], s21 offen offset:384 sc1
    s_waitcnt lgkmcnt(0)
    v_mfma_f32_16x16x32_bf16 a[0:3], v[4:7], v[12:15], a[0:3]
    ds_read_b128 v[20:23], v58 offset:16384
    v_mfma_f32_16x16x32_bf16 a[4:7], v[4:7], v[16:19], a[4:7]
    ds_read_b128 v[24:27], v58 offset:18432
    v_mfma_f32_16x16x32_bf16 a[8:11], v[8:11], v[12:15], a[8:11]
    ds_read_b128 v[28:31], v60 offset:16384
    v_mfma_f32_16x16x32_bf16 a[12:15], v[8:11], v[16:19], a[12:15]
    ds_read_b128 v[32:35], v60 offset:18432
    s_waitcnt lgkmcnt(0)
    v_mfma_f32_16x16x32_bf16 a[0:3], v[20:23], v[28:31], a[0:3]
    ds_read_b128 v[4:7], v57 offset:32768
    v_mfma_f32_16x16x32_bf16 a[4:7], v[20:23], v[32:35], a[4:7]
    ds_read_b128 v[8:11], v57 offset:34816
    v_mfma_f32_16x16x32_bf16 a[8:11], v[24:27], v[28:31], a[8:11]
    ds_read_b128 v[12:15], v59 offset:32768
    s_waitcnt vmcnt(0)
    ds_write_b128 v56, v[36:39] offset:0
    ds_write_b128 v56, v[40:43] offset:4096
    ds_write_b128 v56, v[44:47] offset:8192
    ds_write_b128 v56, v[48:51] offset:12288
    v_mfma_f32_16x16x32_bf16 a[12:15], v[24:27], v[32:35], a[12:15]
    ds_read_b128 v[16:19], v59 offset:34816
    s_waitcnt lgkmcnt(0)
    s_barrier
    buffer_load_dwordx4 v[36:39], v52, s[4:7], s20 offen offset:512 sc1
    buffer_load_dwordx4 v[40:43], v53, s[4:7], s20 offen offset:512 sc1
    buffer_load_dwordx4 v[44:47], v54, s[4:7], s21 offen offset:512 sc1
    buffer_load_dwordx4 v[48:51], v55, s[4:7], s21 offen offset:512 sc1
    s_waitcnt lgkmcnt(0)
    v_mfma_f32_16x16x32_bf16 a[0:3], v[4:7], v[12:15], a[0:3]
    ds_read_b128 v[20:23], v58 offset:32768
    v_mfma_f32_16x16x32_bf16 a[4:7], v[4:7], v[16:19], a[4:7]
    ds_read_b128 v[24:27], v58 offset:34816
    v_mfma_f32_16x16x32_bf16 a[8:11], v[8:11], v[12:15], a[8:11]
    ds_read_b128 v[28:31], v60 offset:32768
    v_mfma_f32_16x16x32_bf16 a[12:15], v[8:11], v[16:19], a[12:15]
    ds_read_b128 v[32:35], v60 offset:34816
    s_waitcnt lgkmcnt(0)
    v_mfma_f32_16x16x32_bf16 a[0:3], v[20:23], v[28:31], a[0:3]
    ds_read_b128 v[4:7], v57 offset:0
    v_mfma_f32_16x16x32_bf16 a[4:7], v[20:23], v[32:35], a[4:7]
    ds_read_b128 v[8:11], v57 offset:2048
    v_mfma_f32_16x16x32_bf16 a[8:11], v[24:27], v[28:31], a[8:11]
    ds_read_b128 v[12:15], v59 offset:0
    s_waitcnt vmcnt(0)
    ds_write_b128 v56, v[36:39] offset:16384
    ds_write_b128 v56, v[40:43] offset:20480
    ds_write_b128 v56, v[44:47] offset:24576
    ds_write_b128 v56, v[48:51] offset:28672
    v_mfma_f32_16x16x32_bf16 a[12:15], v[24:27], v[32:35], a[12:15]
    ds_read_b128 v[16:19], v59 offset:2048
    s_waitcnt lgkmcnt(0)
    s_barrier
    buffer_load_dwordx4 v[36:39], v52, s[4:7], s20 offen offset:640 sc1
    buffer_load_dwordx4 v[40:43], v53, s[4:7], s20 offen offset:640 sc1
    buffer_load_dwordx4 v[44:47], v54, s[4:7], s21 offen offset:640 sc1
    buffer_load_dwordx4 v[48:51], v55, s[4:7], s21 offen offset:640 sc1
    s_waitcnt lgkmcnt(0)
    v_mfma_f32_16x16x32_bf16 a[0:3], v[4:7], v[12:15], a[0:3]
    ds_read_b128 v[20:23], v58 offset:0
    v_mfma_f32_16x16x32_bf16 a[4:7], v[4:7], v[16:19], a[4:7]
    ds_read_b128 v[24:27], v58 offset:2048
    v_mfma_f32_16x16x32_bf16 a[8:11], v[8:11], v[12:15], a[8:11]
    ds_read_b128 v[28:31], v60 offset:0
    v_mfma_f32_16x16x32_bf16 a[12:15], v[8:11], v[16:19], a[12:15]
    ds_read_b128 v[32:35], v60 offset:2048
    s_waitcnt lgkmcnt(0)
    v_mfma_f32_16x16x32_bf16 a[0:3], v[20:23], v[28:31], a[0:3]
    ds_read_b128 v[4:7], v57 offset:16384
    v_mfma_f32_16x16x32_bf16 a[4:7], v[20:23], v[32:35], a[4:7]
    ds_read_b128 v[8:11], v57 offset:18432
    v_mfma_f32_16x16x32_bf16 a[8:11], v[24:27], v[28:31], a[8:11]
    ds_read_b128 v[12:15], v59 offset:16384
    s_waitcnt vmcnt(0)
    ds_write_b128 v56, v[36:39] offset:32768
    ds_write_b128 v56, v[40:43] offset:36864
    ds_write_b128 v56, v[44:47] offset:40960
    ds_write_b128 v56, v[48:51] offset:45056
    v_mfma_f32_16x16x32_bf16 a[12:15], v[24:27], v[32:35], a[12:15]
    ds_read_b128 v[16:19], v59 offset:18432
    s_waitcnt lgkmcnt(0)
    s_barrier
    buffer_load_dwordx4 v[36:39], v52, s[4:7], s20 offen offset:768 sc1
    buffer_load_dwordx4 v[40:43], v53, s[4:7], s20 offen offset:768 sc1
    buffer_load_dwordx4 v[44:47], v54, s[4:7], s21 offen offset:768 sc1
    buffer_load_dwordx4 v[48:51], v55, s[4:7], s21 offen offset:768 sc1
    s_waitcnt lgkmcnt(0)
    v_mfma_f32_16x16x32_bf16 a[0:3], v[4:7], v[12:15], a[0:3]
    ds_read_b128 v[20:23], v58 offset:16384
    v_mfma_f32_16x16x32_bf16 a[4:7], v[4:7], v[16:19], a[4:7]
    ds_read_b128 v[24:27], v58 offset:18432
    v_mfma_f32_16x16x32_bf16 a[8:11], v[8:11], v[12:15], a[8:11]
    ds_read_b128 v[28:31], v60 offset:16384
    v_mfma_f32_16x16x32_bf16 a[12:15], v[8:11], v[16:19], a[12:15]
    ds_read_b128 v[32:35], v60 offset:18432
    s_waitcnt lgkmcnt(0)
    v_mfma_f32_16x16x32_bf16 a[0:3], v[20:23], v[28:31], a[0:3]
    ds_read_b128 v[4:7], v57 offset:32768
    v_mfma_f32_16x16x32_bf16 a[4:7], v[20:23], v[32:35], a[4:7]
    ds_read_b128 v[8:11], v57 offset:34816
    v_mfma_f32_16x16x32_bf16 a[8:11], v[24:27], v[28:31], a[8:11]
    ds_read_b128 v[12:15], v59 offset:32768
    s_waitcnt vmcnt(0)
    ds_write_b128 v56, v[36:39] offset:0
    ds_write_b128 v56, v[40:43] offset:4096
    ds_write_b128 v56, v[44:47] offset:8192
    ds_write_b128 v56, v[48:51] offset:12288
    v_mfma_f32_16x16x32_bf16 a[12:15], v[24:27], v[32:35], a[12:15]
    ds_read_b128 v[16:19], v59 offset:34816
    s_waitcnt lgkmcnt(0)
    s_barrier
    buffer_load_dwordx4 v[36:39], v52, s[4:7], s20 offen offset:896 sc1
    buffer_load_dwordx4 v[40:43], v53, s[4:7], s20 offen offset:896 sc1
    buffer_load_dwordx4 v[44:47], v54, s[4:7], s21 offen offset:896 sc1
    buffer_load_dwordx4 v[48:51], v55, s[4:7], s21 offen offset:896 sc1
    s_waitcnt lgkmcnt(0)
    v_mfma_f32_16x16x32_bf16 a[0:3], v[4:7], v[12:15], a[0:3]
    ds_read_b128 v[20:23], v58 offset:32768
    v_mfma_f32_16x16x32_bf16 a[4:7], v[4:7], v[16:19], a[4:7]
    ds_read_b128 v[24:27], v58 offset:34816
    v_mfma_f32_16x16x32_bf16 a[8:11], v[8:11], v[12:15], a[8:11]
    ds_read_b128 v[28:31], v60 offset:32768
    v_mfma_f32_16x16x32_bf16 a[12:15], v[8:11], v[16:19], a[12:15]
    ds_read_b128 v[32:35], v60 offset:34816
    s_waitcnt lgkmcnt(0)
    v_mfma_f32_16x16x32_bf16 a[0:3], v[20:23], v[28:31], a[0:3]
    ds_read_b128 v[4:7], v57 offset:0
    v_mfma_f32_16x16x32_bf16 a[4:7], v[20:23], v[32:35], a[4:7]
    ds_read_b128 v[8:11], v57 offset:2048
    v_mfma_f32_16x16x32_bf16 a[8:11], v[24:27], v[28:31], a[8:11]
    ds_read_b128 v[12:15], v59 offset:0
    s_waitcnt vmcnt(0)
    ds_write_b128 v56, v[36:39] offset:16384
    ds_write_b128 v56, v[40:43] offset:20480
    ds_write_b128 v56, v[44:47] offset:24576
    ds_write_b128 v56, v[48:51] offset:28672
    v_mfma_f32_16x16x32_bf16 a[12:15], v[24:27], v[32:35], a[12:15]
    ds_read_b128 v[16:19], v59 offset:2048
    s_waitcnt lgkmcnt(0)
    s_barrier
    buffer_load_dwordx4 v[36:39], v52, s[4:7], s20 offen offset:1024 sc1
    buffer_load_dwordx4 v[40:43], v53, s[4:7], s20 offen offset:1024 sc1
    buffer_load_dwordx4 v[44:47], v54, s[4:7], s21 offen offset:1024 sc1
    buffer_load_dwordx4 v[48:51], v55, s[4:7], s21 offen offset:1024 sc1
    s_waitcnt lgkmcnt(0)
    v_mfma_f32_16x16x32_bf16 a[0:3], v[4:7], v[12:15], a[0:3]
    ds_read_b128 v[20:23], v58 offset:0
    v_mfma_f32_16x16x32_bf16 a[4:7], v[4:7], v[16:19], a[4:7]
    ds_read_b128 v[24:27], v58 offset:2048
    v_mfma_f32_16x16x32_bf16 a[8:11], v[8:11], v[12:15], a[8:11]
    ds_read_b128 v[28:31], v60 offset:0
    v_mfma_f32_16x16x32_bf16 a[12:15], v[8:11], v[16:19], a[12:15]
    ds_read_b128 v[32:35], v60 offset:2048
    s_waitcnt lgkmcnt(0)
    v_mfma_f32_16x16x32_bf16 a[0:3], v[20:23], v[28:31], a[0:3]
    ds_read_b128 v[4:7], v57 offset:16384
    v_mfma_f32_16x16x32_bf16 a[4:7], v[20:23], v[32:35], a[4:7]
    ds_read_b128 v[8:11], v57 offset:18432
    v_mfma_f32_16x16x32_bf16 a[8:11], v[24:27], v[28:31], a[8:11]
    ds_read_b128 v[12:15], v59 offset:16384
    s_waitcnt vmcnt(0)
    ds_write_b128 v56, v[36:39] offset:32768
    ds_write_b128 v56, v[40:43] offset:36864
    ds_write_b128 v56, v[44:47] offset:40960
    ds_write_b128 v56, v[48:51] offset:45056
    v_mfma_f32_16x16x32_bf16 a[12:15], v[24:27], v[32:35], a[12:15]
    ds_read_b128 v[16:19], v59 offset:18432
    s_waitcnt lgkmcnt(0)
    s_barrier
    buffer_load_dwordx4 v[36:39], v52, s[4:7], s20 offen offset:1152 sc1
    buffer_load_dwordx4 v[40:43], v53, s[4:7], s20 offen offset:1152 sc1
    buffer_load_dwordx4 v[44:47], v54, s[4:7], s21 offen offset:1152 sc1
    buffer_load_dwordx4 v[48:51], v55, s[4:7], s21 offen offset:1152 sc1
    s_waitcnt lgkmcnt(0)
    v_mfma_f32_16x16x32_bf16 a[0:3], v[4:7], v[12:15], a[0:3]
    ds_read_b128 v[20:23], v58 offset:16384
    v_mfma_f32_16x16x32_bf16 a[4:7], v[4:7], v[16:19], a[4:7]
    ds_read_b128 v[24:27], v58 offset:18432
    v_mfma_f32_16x16x32_bf16 a[8:11], v[8:11], v[12:15], a[8:11]
    ds_read_b128 v[28:31], v60 offset:16384
    v_mfma_f32_16x16x32_bf16 a[12:15], v[8:11], v[16:19], a[12:15]
    ds_read_b128 v[32:35], v60 offset:18432
    s_waitcnt lgkmcnt(0)
    v_mfma_f32_16x16x32_bf16 a[0:3], v[20:23], v[28:31], a[0:3]
    ds_read_b128 v[4:7], v57 offset:32768
    v_mfma_f32_16x16x32_bf16 a[4:7], v[20:23], v[32:35], a[4:7]
    ds_read_b128 v[8:11], v57 offset:34816
    v_mfma_f32_16x16x32_bf16 a[8:11], v[24:27], v[28:31], a[8:11]
    ds_read_b128 v[12:15], v59 offset:32768
    s_waitcnt vmcnt(0)
    ds_write_b128 v56, v[36:39] offset:0
    ds_write_b128 v56, v[40:43] offset:4096
    ds_write_b128 v56, v[44:47] offset:8192
    ds_write_b128 v56, v[48:51] offset:12288
    v_mfma_f32_16x16x32_bf16 a[12:15], v[24:27], v[32:35], a[12:15]
    ds_read_b128 v[16:19], v59 offset:34816
    s_waitcnt lgkmcnt(0)
    s_barrier
    buffer_load_dwordx4 v[36:39], v52, s[4:7], s20 offen offset:1280 sc1
    buffer_load_dwordx4 v[40:43], v53, s[4:7], s20 offen offset:1280 sc1
    buffer_load_dwordx4 v[44:47], v54, s[4:7], s21 offen offset:1280 sc1
    buffer_load_dwordx4 v[48:51], v55, s[4:7], s21 offen offset:1280 sc1
    s_waitcnt lgkmcnt(0)
    v_mfma_f32_16x16x32_bf16 a[0:3], v[4:7], v[12:15], a[0:3]
    ds_read_b128 v[20:23], v58 offset:32768
    v_mfma_f32_16x16x32_bf16 a[4:7], v[4:7], v[16:19], a[4:7]
    ds_read_b128 v[24:27], v58 offset:34816
    v_mfma_f32_16x16x32_bf16 a[8:11], v[8:11], v[12:15], a[8:11]
    ds_read_b128 v[28:31], v60 offset:32768
    v_mfma_f32_16x16x32_bf16 a[12:15], v[8:11], v[16:19], a[12:15]
    ds_read_b128 v[32:35], v60 offset:34816
    s_waitcnt lgkmcnt(0)
    v_mfma_f32_16x16x32_bf16 a[0:3], v[20:23], v[28:31], a[0:3]
    ds_read_b128 v[4:7], v57 offset:0
    v_mfma_f32_16x16x32_bf16 a[4:7], v[20:23], v[32:35], a[4:7]
    ds_read_b128 v[8:11], v57 offset:2048
    v_mfma_f32_16x16x32_bf16 a[8:11], v[24:27], v[28:31], a[8:11]
    ds_read_b128 v[12:15], v59 offset:0
    s_waitcnt vmcnt(0)
    ds_write_b128 v56, v[36:39] offset:16384
    ds_write_b128 v56, v[40:43] offset:20480
    ds_write_b128 v56, v[44:47] offset:24576
    ds_write_b128 v56, v[48:51] offset:28672
    v_mfma_f32_16x16x32_bf16 a[12:15], v[24:27], v[32:35], a[12:15]
    ds_read_b128 v[16:19], v59 offset:2048
    s_waitcnt lgkmcnt(0)
    s_barrier
    buffer_load_dwordx4 v[36:39], v52, s[4:7], s20 offen offset:1408 sc1
    buffer_load_dwordx4 v[40:43], v53, s[4:7], s20 offen offset:1408 sc1
    buffer_load_dwordx4 v[44:47], v54, s[4:7], s21 offen offset:1408 sc1
    buffer_load_dwordx4 v[48:51], v55, s[4:7], s21 offen offset:1408 sc1
    s_waitcnt lgkmcnt(0)
    v_mfma_f32_16x16x32_bf16 a[0:3], v[4:7], v[12:15], a[0:3]
    ds_read_b128 v[20:23], v58 offset:0
    v_mfma_f32_16x16x32_bf16 a[4:7], v[4:7], v[16:19], a[4:7]
    ds_read_b128 v[24:27], v58 offset:2048
    v_mfma_f32_16x16x32_bf16 a[8:11], v[8:11], v[12:15], a[8:11]
    ds_read_b128 v[28:31], v60 offset:0
    v_mfma_f32_16x16x32_bf16 a[12:15], v[8:11], v[16:19], a[12:15]
    ds_read_b128 v[32:35], v60 offset:2048
    s_waitcnt lgkmcnt(0)
    v_mfma_f32_16x16x32_bf16 a[0:3], v[20:23], v[28:31], a[0:3]
    ds_read_b128 v[4:7], v57 offset:16384
    v_mfma_f32_16x16x32_bf16 a[4:7], v[20:23], v[32:35], a[4:7]
    ds_read_b128 v[8:11], v57 offset:18432
    v_mfma_f32_16x16x32_bf16 a[8:11], v[24:27], v[28:31], a[8:11]
    ds_read_b128 v[12:15], v59 offset:16384
    s_waitcnt vmcnt(0)
    ds_write_b128 v56, v[36:39] offset:32768
    ds_write_b128 v56, v[40:43] offset:36864
    ds_write_b128 v56, v[44:47] offset:40960
    ds_write_b128 v56, v[48:51] offset:45056
    v_mfma_f32_16x16x32_bf16 a[12:15], v[24:27], v[32:35], a[12:15]
    ds_read_b128 v[16:19], v59 offset:18432
    s_waitcnt lgkmcnt(0)
    s_barrier
    buffer_load_dwordx4 v[36:39], v52, s[4:7], s20 offen offset:1536 sc1
    buffer_load_dwordx4 v[40:43], v53, s[4:7], s20 offen offset:1536 sc1
    buffer_load_dwordx4 v[44:47], v54, s[4:7], s21 offen offset:1536 sc1
    buffer_load_dwordx4 v[48:51], v55, s[4:7], s21 offen offset:1536 sc1
    s_waitcnt lgkmcnt(0)
    v_mfma_f32_16x16x32_bf16 a[0:3], v[4:7], v[12:15], a[0:3]
    ds_read_b128 v[20:23], v58 offset:16384
    v_mfma_f32_16x16x32_bf16 a[4:7], v[4:7], v[16:19], a[4:7]
    ds_read_b128 v[24:27], v58 offset:18432
    v_mfma_f32_16x16x32_bf16 a[8:11], v[8:11], v[12:15], a[8:11]
    ds_read_b128 v[28:31], v60 offset:16384
    v_mfma_f32_16x16x32_bf16 a[12:15], v[8:11], v[16:19], a[12:15]
    ds_read_b128 v[32:35], v60 offset:18432
    s_waitcnt lgkmcnt(0)
    v_mfma_f32_16x16x32_bf16 a[0:3], v[20:23], v[28:31], a[0:3]
    ds_read_b128 v[4:7], v57 offset:32768
    v_mfma_f32_16x16x32_bf16 a[4:7], v[20:23], v[32:35], a[4:7]
    ds_read_b128 v[8:11], v57 offset:34816
    v_mfma_f32_16x16x32_bf16 a[8:11], v[24:27], v[28:31], a[8:11]
    ds_read_b128 v[12:15], v59 offset:32768
    s_waitcnt vmcnt(0)
    ds_write_b128 v56, v[36:39] offset:0
    ds_write_b128 v56, v[40:43] offset:4096
    ds_write_b128 v56, v[44:47] offset:8192
    ds_write_b128 v56, v[48:51] offset:12288
    v_mfma_f32_16x16x32_bf16 a[12:15], v[24:27], v[32:35], a[12:15]
    ds_read_b128 v[16:19], v59 offset:34816
    s_waitcnt lgkmcnt(0)
    s_barrier
    buffer_load_dwordx4 v[36:39], v52, s[4:7], s20 offen offset:1664 sc1
    buffer_load_dwordx4 v[40:43], v53, s[4:7], s20 offen offset:1664 sc1
    buffer_load_dwordx4 v[44:47], v54, s[4:7], s21 offen offset:1664 sc1
    buffer_load_dwordx4 v[48:51], v55, s[4:7], s21 offen offset:1664 sc1
    s_waitcnt lgkmcnt(0)
    v_mfma_f32_16x16x32_bf16 a[0:3], v[4:7], v[12:15], a[0:3]
    ds_read_b128 v[20:23], v58 offset:32768
    v_mfma_f32_16x16x32_bf16 a[4:7], v[4:7], v[16:19], a[4:7]
    ds_read_b128 v[24:27], v58 offset:34816
    v_mfma_f32_16x16x32_bf16 a[8:11], v[8:11], v[12:15], a[8:11]
    ds_read_b128 v[28:31], v60 offset:32768
    v_mfma_f32_16x16x32_bf16 a[12:15], v[8:11], v[16:19], a[12:15]
    ds_read_b128 v[32:35], v60 offset:34816
    s_waitcnt lgkmcnt(0)
    v_mfma_f32_16x16x32_bf16 a[0:3], v[20:23], v[28:31], a[0:3]
    ds_read_b128 v[4:7], v57 offset:0
    v_mfma_f32_16x16x32_bf16 a[4:7], v[20:23], v[32:35], a[4:7]
    ds_read_b128 v[8:11], v57 offset:2048
    v_mfma_f32_16x16x32_bf16 a[8:11], v[24:27], v[28:31], a[8:11]
    ds_read_b128 v[12:15], v59 offset:0
    s_waitcnt vmcnt(0)
    ds_write_b128 v56, v[36:39] offset:16384
    ds_write_b128 v56, v[40:43] offset:20480
    ds_write_b128 v56, v[44:47] offset:24576
    ds_write_b128 v56, v[48:51] offset:28672
    v_mfma_f32_16x16x32_bf16 a[12:15], v[24:27], v[32:35], a[12:15]
    ds_read_b128 v[16:19], v59 offset:2048
    s_waitcnt lgkmcnt(0)
    s_barrier
    buffer_load_dwordx4 v[36:39], v52, s[4:7], s20 offen offset:1792 sc1
    buffer_load_dwordx4 v[40:43], v53, s[4:7], s20 offen offset:1792 sc1
    buffer_load_dwordx4 v[44:47], v54, s[4:7], s21 offen offset:1792 sc1
    buffer_load_dwordx4 v[48:51], v55, s[4:7], s21 offen offset:1792 sc1
    s_waitcnt lgkmcnt(0)
    v_mfma_f32_16x16x32_bf16 a[0:3], v[4:7], v[12:15], a[0:3]
    ds_read_b128 v[20:23], v58 offset:0
    v_mfma_f32_16x16x32_bf16 a[4:7], v[4:7], v[16:19], a[4:7]
    ds_read_b128 v[24:27], v58 offset:2048
    v_mfma_f32_16x16x32_bf16 a[8:11], v[8:11], v[12:15], a[8:11]
    ds_read_b128 v[28:31], v60 offset:0
    v_mfma_f32_16x16x32_bf16 a[12:15], v[8:11], v[16:19], a[12:15]
    ds_read_b128 v[32:35], v60 offset:2048
    s_waitcnt lgkmcnt(0)
    v_mfma_f32_16x16x32_bf16 a[0:3], v[20:23], v[28:31], a[0:3]
    ds_read_b128 v[4:7], v57 offset:16384
    v_mfma_f32_16x16x32_bf16 a[4:7], v[20:23], v[32:35], a[4:7]
    ds_read_b128 v[8:11], v57 offset:18432
    v_mfma_f32_16x16x32_bf16 a[8:11], v[24:27], v[28:31], a[8:11]
    ds_read_b128 v[12:15], v59 offset:16384
    s_waitcnt vmcnt(0)
    ds_write_b128 v56, v[36:39] offset:32768
    ds_write_b128 v56, v[40:43] offset:36864
    ds_write_b128 v56, v[44:47] offset:40960
    ds_write_b128 v56, v[48:51] offset:45056
    v_mfma_f32_16x16x32_bf16 a[12:15], v[24:27], v[32:35], a[12:15]
    ds_read_b128 v[16:19], v59 offset:18432
    s_waitcnt lgkmcnt(0)
    s_barrier
    buffer_load_dwordx4 v[36:39], v52, s[4:7], s20 offen offset:1920 sc1
    buffer_load_dwordx4 v[40:43], v53, s[4:7], s20 offen offset:1920 sc1
    buffer_load_dwordx4 v[44:47], v54, s[4:7], s21 offen offset:1920 sc1
    buffer_load_dwordx4 v[48:51], v55, s[4:7], s21 offen offset:1920 sc1
    s_waitcnt lgkmcnt(0)
    v_mfma_f32_16x16x32_bf16 a[0:3], v[4:7], v[12:15], a[0:3]
    ds_read_b128 v[20:23], v58 offset:16384
    v_mfma_f32_16x16x32_bf16 a[4:7], v[4:7], v[16:19], a[4:7]
    ds_read_b128 v[24:27], v58 offset:18432
    v_mfma_f32_16x16x32_bf16 a[8:11], v[8:11], v[12:15], a[8:11]
    ds_read_b128 v[28:31], v60 offset:16384
    v_mfma_f32_16x16x32_bf16 a[12:15], v[8:11], v[16:19], a[12:15]
    ds_read_b128 v[32:35], v60 offset:18432
    s_waitcnt lgkmcnt(0)
    v_mfma_f32_16x16x32_bf16 a[0:3], v[20:23], v[28:31], a[0:3]
    ds_read_b128 v[4:7], v57 offset:32768
    v_mfma_f32_16x16x32_bf16 a[4:7], v[20:23], v[32:35], a[4:7]
    ds_read_b128 v[8:11], v57 offset:34816
    v_mfma_f32_16x16x32_bf16 a[8:11], v[24:27], v[28:31], a[8:11]
    ds_read_b128 v[12:15], v59 offset:32768
    s_waitcnt vmcnt(0)
    ds_write_b128 v56, v[36:39] offset:0
    ds_write_b128 v56, v[40:43] offset:4096
    ds_write_b128 v56, v[44:47] offset:8192
    ds_write_b128 v56, v[48:51] offset:12288
    v_mfma_f32_16x16x32_bf16 a[12:15], v[24:27], v[32:35], a[12:15]
    ds_read_b128 v[16:19], v59 offset:34816
    s_waitcnt lgkmcnt(0)
    s_barrier
    buffer_load_dwordx4 v[36:39], v52, s[4:7], s20 offen offset:2048 sc1
    buffer_load_dwordx4 v[40:43], v53, s[4:7], s20 offen offset:2048 sc1
    buffer_load_dwordx4 v[44:47], v54, s[4:7], s21 offen offset:2048 sc1
    buffer_load_dwordx4 v[48:51], v55, s[4:7], s21 offen offset:2048 sc1
    s_waitcnt lgkmcnt(0)
    v_mfma_f32_16x16x32_bf16 a[0:3], v[4:7], v[12:15], a[0:3]
    ds_read_b128 v[20:23], v58 offset:32768
    v_mfma_f32_16x16x32_bf16 a[4:7], v[4:7], v[16:19], a[4:7]
    ds_read_b128 v[24:27], v58 offset:34816
    v_mfma_f32_16x16x32_bf16 a[8:11], v[8:11], v[12:15], a[8:11]
    ds_read_b128 v[28:31], v60 offset:32768
    v_mfma_f32_16x16x32_bf16 a[12:15], v[8:11], v[16:19], a[12:15]
    ds_read_b128 v[32:35], v60 offset:34816
    s_waitcnt lgkmcnt(0)
    v_mfma_f32_16x16x32_bf16 a[0:3], v[20:23], v[28:31], a[0:3]
    ds_read_b128 v[4:7], v57 offset:0
    v_mfma_f32_16x16x32_bf16 a[4:7], v[20:23], v[32:35], a[4:7]
    ds_read_b128 v[8:11], v57 offset:2048
    v_mfma_f32_16x16x32_bf16 a[8:11], v[24:27], v[28:31], a[8:11]
    ds_read_b128 v[12:15], v59 offset:0
    s_waitcnt vmcnt(0)
    ds_write_b128 v56, v[36:39] offset:16384
    ds_write_b128 v56, v[40:43] offset:20480
    ds_write_b128 v56, v[44:47] offset:24576
    ds_write_b128 v56, v[48:51] offset:28672
    v_mfma_f32_16x16x32_bf16 a[12:15], v[24:27], v[32:35], a[12:15]
    ds_read_b128 v[16:19], v59 offset:2048
    s_waitcnt lgkmcnt(0)
    s_barrier
    buffer_load_dwordx4 v[36:39], v52, s[4:7], s20 offen offset:2176 sc1
    buffer_load_dwordx4 v[40:43], v53, s[4:7], s20 offen offset:2176 sc1
    buffer_load_dwordx4 v[44:47], v54, s[4:7], s21 offen offset:2176 sc1
    buffer_load_dwordx4 v[48:51], v55, s[4:7], s21 offen offset:2176 sc1
    s_waitcnt lgkmcnt(0)
    v_mfma_f32_16x16x32_bf16 a[0:3], v[4:7], v[12:15], a[0:3]
    ds_read_b128 v[20:23], v58 offset:0
    v_mfma_f32_16x16x32_bf16 a[4:7], v[4:7], v[16:19], a[4:7]
    ds_read_b128 v[24:27], v58 offset:2048
    v_mfma_f32_16x16x32_bf16 a[8:11], v[8:11], v[12:15], a[8:11]
    ds_read_b128 v[28:31], v60 offset:0
    v_mfma_f32_16x16x32_bf16 a[12:15], v[8:11], v[16:19], a[12:15]
    ds_read_b128 v[32:35], v60 offset:2048
    s_waitcnt lgkmcnt(0)
    v_mfma_f32_16x16x32_bf16 a[0:3], v[20:23], v[28:31], a[0:3]
    ds_read_b128 v[4:7], v57 offset:16384
    v_mfma_f32_16x16x32_bf16 a[4:7], v[20:23], v[32:35], a[4:7]
    ds_read_b128 v[8:11], v57 offset:18432
    v_mfma_f32_16x16x32_bf16 a[8:11], v[24:27], v[28:31], a[8:11]
    ds_read_b128 v[12:15], v59 offset:16384
    s_waitcnt vmcnt(0)
    ds_write_b128 v56, v[36:39] offset:32768
    ds_write_b128 v56, v[40:43] offset:36864
    ds_write_b128 v56, v[44:47] offset:40960
    ds_write_b128 v56, v[48:51] offset:45056
    v_mfma_f32_16x16x32_bf16 a[12:15], v[24:27], v[32:35], a[12:15]
    ds_read_b128 v[16:19], v59 offset:18432
    s_waitcnt lgkmcnt(0)
    s_barrier
    buffer_load_dwordx4 v[36:39], v52, s[4:7], s20 offen offset:2304 sc1
    buffer_load_dwordx4 v[40:43], v53, s[4:7], s20 offen offset:2304 sc1
    buffer_load_dwordx4 v[44:47], v54, s[4:7], s21 offen offset:2304 sc1
    buffer_load_dwordx4 v[48:51], v55, s[4:7], s21 offen offset:2304 sc1
    s_waitcnt lgkmcnt(0)
    v_mfma_f32_16x16x32_bf16 a[0:3], v[4:7], v[12:15], a[0:3]
    ds_read_b128 v[20:23], v58 offset:16384
    v_mfma_f32_16x16x32_bf16 a[4:7], v[4:7], v[16:19], a[4:7]
    ds_read_b128 v[24:27], v58 offset:18432
    v_mfma_f32_16x16x32_bf16 a[8:11], v[8:11], v[12:15], a[8:11]
    ds_read_b128 v[28:31], v60 offset:16384
    v_mfma_f32_16x16x32_bf16 a[12:15], v[8:11], v[16:19], a[12:15]
    ds_read_b128 v[32:35], v60 offset:18432
    s_waitcnt lgkmcnt(0)
    v_mfma_f32_16x16x32_bf16 a[0:3], v[20:23], v[28:31], a[0:3]
    ds_read_b128 v[4:7], v57 offset:32768
    v_mfma_f32_16x16x32_bf16 a[4:7], v[20:23], v[32:35], a[4:7]
    ds_read_b128 v[8:11], v57 offset:34816
    v_mfma_f32_16x16x32_bf16 a[8:11], v[24:27], v[28:31], a[8:11]
    ds_read_b128 v[12:15], v59 offset:32768
    s_waitcnt vmcnt(0)
    ds_write_b128 v56, v[36:39] offset:0
    ds_write_b128 v56, v[40:43] offset:4096
    ds_write_b128 v56, v[44:47] offset:8192
    ds_write_b128 v56, v[48:51] offset:12288
    v_mfma_f32_16x16x32_bf16 a[12:15], v[24:27], v[32:35], a[12:15]
    ds_read_b128 v[16:19], v59 offset:34816
    s_waitcnt lgkmcnt(0)
    s_barrier
    buffer_load_dwordx4 v[36:39], v52, s[4:7], s20 offen offset:2432 sc1
    buffer_load_dwordx4 v[40:43], v53, s[4:7], s20 offen offset:2432 sc1
    buffer_load_dwordx4 v[44:47], v54, s[4:7], s21 offen offset:2432 sc1
    buffer_load_dwordx4 v[48:51], v55, s[4:7], s21 offen offset:2432 sc1
    s_waitcnt lgkmcnt(0)
    v_mfma_f32_16x16x32_bf16 a[0:3], v[4:7], v[12:15], a[0:3]
    ds_read_b128 v[20:23], v58 offset:32768
    v_mfma_f32_16x16x32_bf16 a[4:7], v[4:7], v[16:19], a[4:7]
    ds_read_b128 v[24:27], v58 offset:34816
    v_mfma_f32_16x16x32_bf16 a[8:11], v[8:11], v[12:15], a[8:11]
    ds_read_b128 v[28:31], v60 offset:32768
    v_mfma_f32_16x16x32_bf16 a[12:15], v[8:11], v[16:19], a[12:15]
    ds_read_b128 v[32:35], v60 offset:34816
    s_waitcnt lgkmcnt(0)
    v_mfma_f32_16x16x32_bf16 a[0:3], v[20:23], v[28:31], a[0:3]
    ds_read_b128 v[4:7], v57 offset:0
    v_mfma_f32_16x16x32_bf16 a[4:7], v[20:23], v[32:35], a[4:7]
    ds_read_b128 v[8:11], v57 offset:2048
    v_mfma_f32_16x16x32_bf16 a[8:11], v[24:27], v[28:31], a[8:11]
    ds_read_b128 v[12:15], v59 offset:0
    s_waitcnt vmcnt(0)
    ds_write_b128 v56, v[36:39] offset:16384
    ds_write_b128 v56, v[40:43] offset:20480
    ds_write_b128 v56, v[44:47] offset:24576
    ds_write_b128 v56, v[48:51] offset:28672
    v_mfma_f32_16x16x32_bf16 a[12:15], v[24:27], v[32:35], a[12:15]
    ds_read_b128 v[16:19], v59 offset:2048
    s_waitcnt lgkmcnt(0)
    s_barrier
    buffer_load_dwordx4 v[36:39], v52, s[4:7], s20 offen offset:2560 sc1
    buffer_load_dwordx4 v[40:43], v53, s[4:7], s20 offen offset:2560 sc1
    buffer_load_dwordx4 v[44:47], v54, s[4:7], s21 offen offset:2560 sc1
    buffer_load_dwordx4 v[48:51], v55, s[4:7], s21 offen offset:2560 sc1
    s_waitcnt lgkmcnt(0)
    v_mfma_f32_16x16x32_bf16 a[0:3], v[4:7], v[12:15], a[0:3]
    ds_read_b128 v[20:23], v58 offset:0
    v_mfma_f32_16x16x32_bf16 a[4:7], v[4:7], v[16:19], a[4:7]
    ds_read_b128 v[24:27], v58 offset:2048
    v_mfma_f32_16x16x32_bf16 a[8:11], v[8:11], v[12:15], a[8:11]
    ds_read_b128 v[28:31], v60 offset:0
    v_mfma_f32_16x16x32_bf16 a[12:15], v[8:11], v[16:19], a[12:15]
    ds_read_b128 v[32:35], v60 offset:2048
    s_waitcnt lgkmcnt(0)
    v_mfma_f32_16x16x32_bf16 a[0:3], v[20:23], v[28:31], a[0:3]
    ds_read_b128 v[4:7], v57 offset:16384
    v_mfma_f32_16x16x32_bf16 a[4:7], v[20:23], v[32:35], a[4:7]
    ds_read_b128 v[8:11], v57 offset:18432
    v_mfma_f32_16x16x32_bf16 a[8:11], v[24:27], v[28:31], a[8:11]
    ds_read_b128 v[12:15], v59 offset:16384
    s_waitcnt vmcnt(0)
    ds_write_b128 v56, v[36:39] offset:32768
    ds_write_b128 v56, v[40:43] offset:36864
    ds_write_b128 v56, v[44:47] offset:40960
    ds_write_b128 v56, v[48:51] offset:45056
    v_mfma_f32_16x16x32_bf16 a[12:15], v[24:27], v[32:35], a[12:15]
    ds_read_b128 v[16:19], v59 offset:18432
    s_waitcnt lgkmcnt(0)
    s_barrier
    buffer_load_dwordx4 v[36:39], v52, s[4:7], s20 offen offset:2688 sc1
    buffer_load_dwordx4 v[40:43], v53, s[4:7], s20 offen offset:2688 sc1
    buffer_load_dwordx4 v[44:47], v54, s[4:7], s21 offen offset:2688 sc1
    buffer_load_dwordx4 v[48:51], v55, s[4:7], s21 offen offset:2688 sc1
    s_waitcnt lgkmcnt(0)
    v_mfma_f32_16x16x32_bf16 a[0:3], v[4:7], v[12:15], a[0:3]
    ds_read_b128 v[20:23], v58 offset:16384
    v_mfma_f32_16x16x32_bf16 a[4:7], v[4:7], v[16:19], a[4:7]
    ds_read_b128 v[24:27], v58 offset:18432
    v_mfma_f32_16x16x32_bf16 a[8:11], v[8:11], v[12:15], a[8:11]
    ds_read_b128 v[28:31], v60 offset:16384
    v_mfma_f32_16x16x32_bf16 a[12:15], v[8:11], v[16:19], a[12:15]
    ds_read_b128 v[32:35], v60 offset:18432
    s_waitcnt lgkmcnt(0)
    v_mfma_f32_16x16x32_bf16 a[0:3], v[20:23], v[28:31], a[0:3]
    ds_read_b128 v[4:7], v57 offset:32768
    v_mfma_f32_16x16x32_bf16 a[4:7], v[20:23], v[32:35], a[4:7]
    ds_read_b128 v[8:11], v57 offset:34816
    v_mfma_f32_16x16x32_bf16 a[8:11], v[24:27], v[28:31], a[8:11]
    ds_read_b128 v[12:15], v59 offset:32768
    s_waitcnt vmcnt(0)
    ds_write_b128 v56, v[36:39] offset:0
    ds_write_b128 v56, v[40:43] offset:4096
    ds_write_b128 v56, v[44:47] offset:8192
    ds_write_b128 v56, v[48:51] offset:12288
    v_mfma_f32_16x16x32_bf16 a[12:15], v[24:27], v[32:35], a[12:15]
    ds_read_b128 v[16:19], v59 offset:34816
    s_waitcnt lgkmcnt(0)
    s_barrier
    buffer_load_dwordx4 v[36:39], v52, s[4:7], s20 offen offset:2816 sc1
    buffer_load_dwordx4 v[40:43], v53, s[4:7], s20 offen offset:2816 sc1
    buffer_load_dwordx4 v[44:47], v54, s[4:7], s21 offen offset:2816 sc1
    buffer_load_dwordx4 v[48:51], v55, s[4:7], s21 offen offset:2816 sc1
    s_waitcnt lgkmcnt(0)
    v_mfma_f32_16x16x32_bf16 a[0:3], v[4:7], v[12:15], a[0:3]
    ds_read_b128 v[20:23], v58 offset:32768
    v_mfma_f32_16x16x32_bf16 a[4:7], v[4:7], v[16:19], a[4:7]
    ds_read_b128 v[24:27], v58 offset:34816
    v_mfma_f32_16x16x32_bf16 a[8:11], v[8:11], v[12:15], a[8:11]
    ds_read_b128 v[28:31], v60 offset:32768
    v_mfma_f32_16x16x32_bf16 a[12:15], v[8:11], v[16:19], a[12:15]
    ds_read_b128 v[32:35], v60 offset:34816
    s_waitcnt lgkmcnt(0)
    v_mfma_f32_16x16x32_bf16 a[0:3], v[20:23], v[28:31], a[0:3]
    ds_read_b128 v[4:7], v57 offset:0
    v_mfma_f32_16x16x32_bf16 a[4:7], v[20:23], v[32:35], a[4:7]
    ds_read_b128 v[8:11], v57 offset:2048
    v_mfma_f32_16x16x32_bf16 a[8:11], v[24:27], v[28:31], a[8:11]
    ds_read_b128 v[12:15], v59 offset:0
    s_waitcnt vmcnt(0)
    ds_write_b128 v56, v[36:39] offset:16384
    ds_write_b128 v56, v[40:43] offset:20480
    ds_write_b128 v56, v[44:47] offset:24576
    ds_write_b128 v56, v[48:51] offset:28672
    v_mfma_f32_16x16x32_bf16 a[12:15], v[24:27], v[32:35], a[12:15]
    ds_read_b128 v[16:19], v59 offset:2048
    s_waitcnt lgkmcnt(0)
    s_barrier
    buffer_load_dwordx4 v[36:39], v52, s[4:7], s20 offen offset:2944 sc1
    buffer_load_dwordx4 v[40:43], v53, s[4:7], s20 offen offset:2944 sc1
    buffer_load_dwordx4 v[44:47], v54, s[4:7], s21 offen offset:2944 sc1
    buffer_load_dwordx4 v[48:51], v55, s[4:7], s21 offen offset:2944 sc1
    s_waitcnt lgkmcnt(0)
    v_mfma_f32_16x16x32_bf16 a[0:3], v[4:7], v[12:15], a[0:3]
    ds_read_b128 v[20:23], v58 offset:0
    v_mfma_f32_16x16x32_bf16 a[4:7], v[4:7], v[16:19], a[4:7]
    ds_read_b128 v[24:27], v58 offset:2048
    v_mfma_f32_16x16x32_bf16 a[8:11], v[8:11], v[12:15], a[8:11]
    ds_read_b128 v[28:31], v60 offset:0
    v_mfma_f32_16x16x32_bf16 a[12:15], v[8:11], v[16:19], a[12:15]
    ds_read_b128 v[32:35], v60 offset:2048
    s_waitcnt lgkmcnt(0)
    v_mfma_f32_16x16x32_bf16 a[0:3], v[20:23], v[28:31], a[0:3]
    ds_read_b128 v[4:7], v57 offset:16384
    v_mfma_f32_16x16x32_bf16 a[4:7], v[20:23], v[32:35], a[4:7]
    ds_read_b128 v[8:11], v57 offset:18432
    v_mfma_f32_16x16x32_bf16 a[8:11], v[24:27], v[28:31], a[8:11]
    ds_read_b128 v[12:15], v59 offset:16384
    s_waitcnt vmcnt(0)
    ds_write_b128 v56, v[36:39] offset:32768
    ds_write_b128 v56, v[40:43] offset:36864
    ds_write_b128 v56, v[44:47] offset:40960
    ds_write_b128 v56, v[48:51] offset:45056
    v_mfma_f32_16x16x32_bf16 a[12:15], v[24:27], v[32:35], a[12:15]
    ds_read_b128 v[16:19], v59 offset:18432
    s_waitcnt lgkmcnt(0)
    s_barrier
    s_waitcnt lgkmcnt(0)
    v_mfma_f32_16x16x32_bf16 a[0:3], v[4:7], v[12:15], a[0:3]
    ds_read_b128 v[20:23], v58 offset:16384
    v_mfma_f32_16x16x32_bf16 a[4:7], v[4:7], v[16:19], a[4:7]
    ds_read_b128 v[24:27], v58 offset:18432
    v_mfma_f32_16x16x32_bf16 a[8:11], v[8:11], v[12:15], a[8:11]
    ds_read_b128 v[28:31], v60 offset:16384
    v_mfma_f32_16x16x32_bf16 a[12:15], v[8:11], v[16:19], a[12:15]
    ds_read_b128 v[32:35], v60 offset:18432
    s_waitcnt lgkmcnt(0)
    v_mfma_f32_16x16x32_bf16 a[0:3], v[20:23], v[28:31], a[0:3]
    ds_read_b128 v[4:7], v57 offset:32768
    v_mfma_f32_16x16x32_bf16 a[4:7], v[20:23], v[32:35], a[4:7]
    ds_read_b128 v[8:11], v57 offset:34816
    v_mfma_f32_16x16x32_bf16 a[8:11], v[24:27], v[28:31], a[8:11]
    ds_read_b128 v[12:15], v59 offset:32768
    v_mfma_f32_16x16x32_bf16 a[12:15], v[24:27], v[32:35], a[12:15]
    ds_read_b128 v[16:19], v59 offset:34816
    s_waitcnt lgkmcnt(0)
    s_barrier
    s_waitcnt lgkmcnt(0)
    v_mfma_f32_16x16x32_bf16 a[0:3], v[4:7], v[12:15], a[0:3]
    ds_read_b128 v[20:23], v58 offset:32768
    v_mfma_f32_16x16x32_bf16 a[4:7], v[4:7], v[16:19], a[4:7]
    ds_read_b128 v[24:27], v58 offset:34816
    v_mfma_f32_16x16x32_bf16 a[8:11], v[8:11], v[12:15], a[8:11]
    ds_read_b128 v[28:31], v60 offset:32768
    v_mfma_f32_16x16x32_bf16 a[12:15], v[8:11], v[16:19], a[12:15]
    ds_read_b128 v[32:35], v60 offset:34816
    s_waitcnt lgkmcnt(0)
    v_mfma_f32_16x16x32_bf16 a[0:3], v[20:23], v[28:31], a[0:3]
    v_mfma_f32_16x16x32_bf16 a[4:7], v[20:23], v[32:35], a[4:7]
    v_mfma_f32_16x16x32_bf16 a[8:11], v[24:27], v[28:31], a[8:11]
    v_mfma_f32_16x16x32_bf16 a[12:15], v[24:27], v[32:35], a[12:15]
    s_nop 7
    s_mul_i32 s22, s16, 64
    s_mul_i32 s23, s17, 64
    v_mul_u32_u24 v4, 32, v62
    v_lshl_add_u32 v4, v65, 2, v4
    v_add_u32 v4, s22, v4
    v_mul_u32_u24 v5, 32, v63
    v_add_u32 v5, v5, v64
    v_add_u32 v5, s23, v5
    v_mul_u32_u24 v6, 1280, v5
    v_lshl_add_u32 v6, v4, 1, v6
    s_mov_b32 s24, 235896832
    s_add_u32 s25, s24, 0
    s_mov_b32 s26, 0
    buffer_load_dwordx2 v[56:57], v6, s[4:7], s25 offen offset:0 sc1
    buffer_load_dwordx2 v[58:59], v6, s[4:7], s25 offen offset:32 sc1
    s_waitcnt vmcnt(0)
    v_accvgpr_read_b32 v44, a0
    v_accvgpr_read_b32 v45, a1
    v_accvgpr_read_b32 v46, a2
    v_accvgpr_read_b32 v47, a3
    v_cvt_pk_bf16_f32 v20, v44, v45
    v_cvt_pk_bf16_f32 v21, v46, v47
    v_lshlrev_b32 v22, 16, v20
    v_lshlrev_b32 v26, 16, v56
    v_add_f32 v22, v22, v26
    v_and_b32 v23, 0xffff0000, v20
    v_and_b32 v27, 0xffff0000, v56
    v_add_f32 v23, v23, v27
    v_lshlrev_b32 v24, 16, v21
    v_lshlrev_b32 v28, 16, v57
    v_add_f32 v24, v24, v28
    v_and_b32 v25, 0xffff0000, v21
    v_and_b32 v29, 0xffff0000, v57
    v_add_f32 v25, v25, v29
    v_cvt_pk_bf16_f32 v8, v22, v23
    v_cvt_pk_bf16_f32 v9, v24, v25
    buffer_store_dwordx2 v[8:9], v6, s[12:15], s26 offen offset:0
    v_accvgpr_read_b32 v44, a8
    v_accvgpr_read_b32 v45, a9
    v_accvgpr_read_b32 v46, a10
    v_accvgpr_read_b32 v47, a11
    v_cvt_pk_bf16_f32 v20, v44, v45
    v_cvt_pk_bf16_f32 v21, v46, v47
    v_lshlrev_b32 v22, 16, v20
    v_lshlrev_b32 v26, 16, v58
    v_add_f32 v22, v22, v26
    v_and_b32 v23, 0xffff0000, v20
    v_and_b32 v27, 0xffff0000, v58
    v_add_f32 v23, v23, v27
    v_lshlrev_b32 v24, 16, v21
    v_lshlrev_b32 v28, 16, v59
    v_add_f32 v24, v24, v28
    v_and_b32 v25, 0xffff0000, v21
    v_and_b32 v29, 0xffff0000, v59
    v_add_f32 v25, v25, v29
    v_cvt_pk_bf16_f32 v10, v22, v23
    v_cvt_pk_bf16_f32 v11, v24, v25
    buffer_store_dwordx2 v[10:11], v6, s[12:15], s26 offen offset:32
    s_add_u32 s25, s24, 20480
    s_mov_b32 s26, 20480
    buffer_load_dwordx2 v[56:57], v6, s[4:7], s25 offen offset:0 sc1
    buffer_load_dwordx2 v[58:59], v6, s[4:7], s25 offen offset:32 sc1
    s_waitcnt vmcnt(0)
    v_accvgpr_read_b32 v44, a4
    v_accvgpr_read_b32 v45, a5
    v_accvgpr_read_b32 v46, a6
    v_accvgpr_read_b32 v47, a7
    v_cvt_pk_bf16_f32 v20, v44, v45
    v_cvt_pk_bf16_f32 v21, v46, v47
    v_lshlrev_b32 v22, 16, v20
    v_lshlrev_b32 v26, 16, v56
    v_add_f32 v22, v22, v26
    v_and_b32 v23, 0xffff0000, v20
    v_and_b32 v27, 0xffff0000, v56
    v_add_f32 v23, v23, v27
    v_lshlrev_b32 v24, 16, v21
    v_lshlrev_b32 v28, 16, v57
    v_add_f32 v24, v24, v28
    v_and_b32 v25, 0xffff0000, v21
    v_and_b32 v29, 0xffff0000, v57
    v_add_f32 v25, v25, v29
    v_cvt_pk_bf16_f32 v8, v22, v23
    v_cvt_pk_bf16_f32 v9, v24, v25
    buffer_store_dwordx2 v[8:9], v6, s[12:15], s26 offen offset:0
    v_accvgpr_read_b32 v44, a12
    v_accvgpr_read_b32 v45, a13
    v_accvgpr_read_b32 v46, a14
    v_accvgpr_read_b32 v47, a15
    v_cvt_pk_bf16_f32 v20, v44, v45
    v_cvt_pk_bf16_f32 v21, v46, v47
    v_lshlrev_b32 v22, 16, v20
    v_lshlrev_b32 v26, 16, v58
    v_add_f32 v22, v22, v26
    v_and_b32 v23, 0xffff0000, v20
    v_and_b32 v27, 0xffff0000, v58
    v_add_f32 v23, v23, v27
    v_lshlrev_b32 v24, 16, v21
    v_lshlrev_b32 v28, 16, v59
    v_add_f32 v24, v24, v28
    v_and_b32 v25, 0xffff0000, v21
    v_and_b32 v29, 0xffff0000, v59
    v_add_f32 v25, v25, v29
    v_cvt_pk_bf16_f32 v10, v22, v23
    v_cvt_pk_bf16_f32 v11, v24, v25
    buffer_store_dwordx2 v[10:11], v6, s[12:15], s26 offen offset:32
    s_branch wk_fin
wk_ln2:
    v_lshrrev_b32 v1, 6, v0
    v_lshlrev_b32 v1, 2, v1
    v_add_u32 v1, s16, v1
    v_add_u32 v1, 0, v1
    v_mul_u32_u24 v1, 1280, v1
    v_and_b32 v2, 63, v0
    v_lshl_add_u32 v1, v2, 2, v1
    v_add_u32 v2, 238518272, v1
    v_add_u32 v1, 235896832, v1
    buffer_load_dword v3, v1, s[4:7], 0 offen offset:0 sc1
    buffer_load_dword v4, v1, s[4:7], 0 offen offset:256 sc1
    buffer_load_dword v5, v1, s[4:7], 0 offen offset:512 sc1
    buffer_load_dword v6, v1, s[4:7], 0 offen offset:768 sc1
    buffer_load_dword v7, v1, s[4:7], 0 offen offset:1024 sc1
    s_waitcnt vmcnt(0)
    v_lshlrev_b32 v8, 16, v3
    v_and_b32 v9, 0xffff0000, v3
    v_lshlrev_b32 v10, 16, v4
    v_and_b32 v11, 0xffff0000, v4
    v_lshlrev_b32 v12, 16, v5
    v_and_b32 v13, 0xffff0000, v5
    v_lshlrev_b32 v14, 16, v6
    v_and_b32 v15, 0xffff0000, v6
    v_lshlrev_b32 v16, 16, v7
    v_and_b32 v17, 0xffff0000, v7
    v_add_f32 v18, v8, v9
    v_add_f32 v18, v18, v10
    v_add_f32 v18, v18, v11
    v_add_f32 v18, v18, v12
    v_add_f32 v18, v18, v13
    v_add_f32 v18, v18, v14
    v_add_f32 v18, v18, v15
    v_add_f32 v18, v18, v16
    v_add_f32 v18, v18, v17
    s_nop 1
    v_add_f32_dpp v18, v18, v18 row_shr:1 row_mask:0xf bank_mask:0xf bound_ctrl:0
    s_nop 1
    v_add_f32_dpp v18, v18, v18 row_shr:2 row_mask:0xf bank_mask:0xf bound_ctrl:0
    s_nop 1
    v_add_f32_dpp v18, v18, v18 row_shr:4 row_mask:0xf bank_mask:0xf bound_ctrl:0
    s_nop 1
    v_add_f32_dpp v18, v18, v18 row_shr:8 row_mask:0xf bank_mask:0xf bound_ctrl:0
    s_nop 1
    v_add_f32_dpp v18, v18, v18 row_bcast:15 row_mask:0xa bank_mask:0xf
    s_nop 1
    v_add_f32_dpp v18, v18, v18 row_bcast:31 row_mask:0xc bank_mask:0xf
    s_nop 0
    v_readlane_b32 s20, v18, 63
    s_nop 1
    v_mov_b32 v19, 0x3acccccd
    v_mul_f32 v19, s20, v19
    v_sub_f32 v20, v8, v19
    v_mul_f32 v18, v20, v20
    v_sub_f32 v20, v9, v19
    v_fmac_f32 v18, v20, v20
    v_sub_f32 v20, v10, v19
    v_fmac_f32 v18, v20, v20
    v_sub_f32 v20, v11, v19
    v_fmac_f32 v18, v20, v20
    v_sub_f32 v20, v12, v19
    v_fmac_f32 v18, v20, v20
    v_sub_f32 v20, v13, v19
    v_fmac_f32 v18, v20, v20
    v_sub_f32 v20, v14, v19
    v_fmac_f32 v18, v20, v20
    v_sub_f32 v20, v15, v19
    v_fmac_f32 v18, v20, v20
    v_sub_f32 v20, v16, v19
    v_fmac_f32 v18, v20, v20
    v_sub_f32 v20, v17, v19
    v_fmac_f32 v18, v20, v20
    s_nop 1
    v_add_f32_dpp v18, v18, v18 row_shr:1 row_mask:0xf bank_mask:0xf bound_ctrl:0
    s_nop 1
    v_add_f32_dpp v18, v18, v18 row_shr:2 row_mask:0xf bank_mask:0xf bound_ctrl:0
    s_nop 1
    v_add_f32_dpp v18, v18, v18 row_shr:4 row_mask:0xf bank_mask:0xf bound_ctrl:0
    s_nop 1
    v_add_f32_dpp v18, v18, v18 row_shr:8 row_mask:0xf bank_mask:0xf bound_ctrl:0
    s_nop 1
    v_add_f32_dpp v18, v18, v18 row_bcast:15 row_mask:0xa bank_mask:0xf
    s_nop 1
    v_add_f32_dpp v18, v18, v18 row_bcast:31 row_mask:0xc bank_mask:0xf
    s_nop 0
    v_readlane_b32 s21, v18, 63
    s_nop 1
    v_mov_b32 v20, 0x3acccccd
    v_mul_f32 v20, s21, v20
    v_cvt_pk_bf16_f32 v21, v19, v20
    v_lshlrev_b32 v19, 16, v21
    v_and_b32 v20, 0xffff0000, v21
    v_add_f32 v20, 0x3727c5ac, v20
    v_cvt_pk_bf16_f32 v20, v20, v20
    v_lshlrev_b32 v20, 16, v20
    v_sqrt_f32 v20, v20
    s_nop 0
    v_cvt_pk_bf16_f32 v20, v20, v20
    v_lshlrev_b32 v20, 16, v20
    v_rcp_f32 v20, v20
    s_nop 0
    v_sub_f32 v22, v8, v19
    v_sub_f32 v23, v9, v19
    v_cvt_pk_bf16_f32 v24, v22, v23
    v_lshlrev_b32 v22, 16, v24
    v_and_b32 v23, 0xffff0000, v24
    v_mul_f32 v22, v22, v20
    v_mul_f32 v23, v23, v20
    v_cvt_pk_bf16_f32 v25, v22, v23
    v_sub_f32 v22, v10, v19
    v_sub_f32 v23, v11, v19
    v_cvt_pk_bf16_f32 v24, v22, v23
    v_lshlrev_b32 v22, 16, v24
    v_and_b32 v23, 0xffff0000, v24
    v_mul_f32 v22, v22, v20
    v_mul_f32 v23, v23, v20
    v_cvt_pk_bf16_f32 v26, v22, v23
    v_sub_f32 v22, v12, v19
    v_sub_f32 v23, v13, v19
    v_cvt_pk_bf16_f32 v24, v22, v23
    v_lshlrev_b32 v22, 16, v24
    v_and_b32 v23, 0xffff0000, v24
    v_mul_f32 v22, v22, v20
    v_mul_f32 v23, v23, v20
    v_cvt_pk_bf16_f32 v27, v22, v23
    v_sub_f32 v22, v14, v19
    v_sub_f32 v23, v15, v19
    v_cvt_pk_bf16_f32 v24, v22, v23
    v_lshlrev_b32 v22, 16, v24
    v_and_b32 v23, 0xffff0000, v24
    v_mul_f32 v22, v22, v20
    v_mul_f32 v23, v23, v20
    v_cvt_pk_bf16_f32 v28, v22, v23
    v_sub_f32 v22, v16, v19
    v_sub_f32 v23, v17, v19
    v_cvt_pk_bf16_f32 v24, v22, v23
    v_lshlrev_b32 v22, 16, v24
    v_and_b32 v23, 0xffff0000, v24
    v_mul_f32 v22, v22, v20
    v_mul_f32 v23, v23, v20
    v_cvt_pk_bf16_f32 v29, v22, v23
    buffer_store_dword v25, v2, s[4:7], 0 offen offset:0 sc1
    buffer_store_dword v26, v2, s[4:7], 0 offen offset:256 sc1
    buffer_store_dword v27, v2, s[4:7], 0 offen offset:512 sc1
    buffer_store_dword v28, v2, s[4:7], 0 offen offset:768 sc1
    buffer_store_dword v29, v2, s[4:7], 0 offen offset:1024 sc1
    v_lshrrev_b32 v1, 6, v0
    v_lshlrev_b32 v1, 2, v1
    v_add_u32 v1, s16, v1
    v_add_u32 v1, 1, v1
    v_mul_u32_u24 v1, 1280, v1
    v_and_b32 v2, 63, v0
    v_lshl_add_u32 v1, v2, 2, v1
    v_add_u32 v2, 238518272, v1
    v_add_u32 v1, 235896832, v1
    buffer_load_dword v3, v1, s[4:7], 0 offen offset:0 sc1
    buffer_load_dword v4, v1, s[4:7], 0 offen offset:256 sc1
    buffer_load_dword v5, v1, s[4:7], 0 offen offset:512 sc1
    buffer_load_dword v6, v1, s[4:7], 0 offen offset:768 sc1
    buffer_load_dword v7, v1, s[4:7], 0 offen offset:1024 sc1
    s_waitcnt vmcnt(0)
    v_lshlrev_b32 v8, 16, v3
    v_and_b32 v9, 0xffff0000, v3
    v_lshlrev_b32 v10, 16, v4
    v_and_b32 v11, 0xffff0000, v4
    v_lshlrev_b32 v12, 16, v5
    v_and_b32 v13, 0xffff0000, v5
    v_lshlrev_b32 v14, 16, v6
    v_and_b32 v15, 0xffff0000, v6
    v_lshlrev_b32 v16, 16, v7
    v_and_b32 v17, 0xffff0000, v7
    v_add_f32 v18, v8, v9
    v_add_f32 v18, v18, v10
    v_add_f32 v18, v18, v11
    v_add_f32 v18, v18, v12
    v_add_f32 v18, v18, v13
    v_add_f32 v18, v18, v14
    v_add_f32 v18, v18, v15
    v_add_f32 v18, v18, v16
    v_add_f32 v18, v18, v17
    s_nop 1
    v_add_f32_dpp v18, v18, v18 row_shr:1 row_mask:0xf bank_mask:0xf bound_ctrl:0
    s_nop 1
    v_add_f32_dpp v18, v18, v18 row_shr:2 row_mask:0xf bank_mask:0xf bound_ctrl:0
    s_nop 1
    v_add_f32_dpp v18, v18, v18 row_shr:4 row_mask:0xf bank_mask:0xf bound_ctrl:0
    s_nop 1
    v_add_f32_dpp v18, v18, v18 row_shr:8 row_mask:0xf bank_mask:0xf bound_ctrl:0
    s_nop 1
    v_add_f32_dpp v18, v18, v18 row_bcast:15 row_mask:0xa bank_mask:0xf
    s_nop 1
    v_add_f32_dpp v18, v18, v18 row_bcast:31 row_mask:0xc bank_mask:0xf
    s_nop 0
    v_readlane_b32 s20, v18, 63
    s_nop 1
    v_mov_b32 v19, 0x3acccccd
    v_mul_f32 v19, s20, v19
    v_sub_f32 v20, v8, v19
    v_mul_f32 v18, v20, v20
    v_sub_f32 v20, v9, v19
    v_fmac_f32 v18, v20, v20
    v_sub_f32 v20, v10, v19
    v_fmac_f32 v18, v20, v20
    v_sub_f32 v20, v11, v19
    v_fmac_f32 v18, v20, v20
    v_sub_f32 v20, v12, v19
    v_fmac_f32 v18, v20, v20
    v_sub_f32 v20, v13, v19
    v_fmac_f32 v18, v20, v20
    v_sub_f32 v20, v14, v19
    v_fmac_f32 v18, v20, v20
    v_sub_f32 v20, v15, v19
    v_fmac_f32 v18, v20, v20
    v_sub_f32 v20, v16, v19
    v_fmac_f32 v18, v20, v20
    v_sub_f32 v20, v17, v19
    v_fmac_f32 v18, v20, v20
    s_nop 1
    v_add_f32_dpp v18, v18, v18 row_shr:1 row_mask:0xf bank_mask:0xf bound_ctrl:0
    s_nop 1
    v_add_f32_dpp v18, v18, v18 row_shr:2 row_mask:0xf bank_mask:0xf bound_ctrl:0
    s_nop 1
    v_add_f32_dpp v18, v18, v18 row_shr:4 row_mask:0xf bank_mask:0xf bound_ctrl:0
    s_nop 1
    v_add_f32_dpp v18, v18, v18 row_shr:8 row_mask:0xf bank_mask:0xf bound_ctrl:0
    s_nop 1
    v_add_f32_dpp v18, v18, v18 row_bcast:15 row_mask:0xa bank_mask:0xf
    s_nop 1
    v_add_f32_dpp v18, v18, v18 row_bcast:31 row_mask:0xc bank_mask:0xf
    s_nop 0
    v_readlane_b32 s21, v18, 63
    s_nop 1
    v_mov_b32 v20, 0x3acccccd
    v_mul_f32 v20, s21, v20
    v_cvt_pk_bf16_f32 v21, v19, v20
    v_lshlrev_b32 v19, 16, v21
    v_and_b32 v20, 0xffff0000, v21
    v_add_f32 v20, 0x3727c5ac, v20
    v_cvt_pk_bf16_f32 v20, v20, v20
    v_lshlrev_b32 v20, 16, v20
    v_sqrt_f32 v20, v20
    s_nop 0
    v_cvt_pk_bf16_f32 v20, v20, v20
    v_lshlrev_b32 v20, 16, v20
    v_rcp_f32 v20, v20
    s_nop 0
    v_sub_f32 v22, v8, v19
    v_sub_f32 v23, v9, v19
    v_cvt_pk_bf16_f32 v24, v22, v23
    v_lshlrev_b32 v22, 16, v24
    v_and_b32 v23, 0xffff0000, v24
    v_mul_f32 v22, v22, v20
    v_mul_f32 v23, v23, v20
    v_cvt_pk_bf16_f32 v25, v22, v23
    v_sub_f32 v22, v10, v19
    v_sub_f32 v23, v11, v19
    v_cvt_pk_bf16_f32 v24, v22, v23
    v_lshlrev_b32 v22, 16, v24
    v_and_b32 v23, 0xffff0000, v24
    v_mul_f32 v22, v22, v20
    v_mul_f32 v23, v23, v20
    v_cvt_pk_bf16_f32 v26, v22, v23
    v_sub_f32 v22, v12, v19
    v_sub_f32 v23, v13, v19
    v_cvt_pk_bf16_f32 v24, v22, v23
    v_lshlrev_b32 v22, 16, v24
    v_and_b32 v23, 0xffff0000, v24
    v_mul_f32 v22, v22, v20
    v_mul_f32 v23, v23, v20
    v_cvt_pk_bf16_f32 v27, v22, v23
    v_sub_f32 v22, v14, v19
    v_sub_f32 v23, v15, v19
    v_cvt_pk_bf16_f32 v24, v22, v23
    v_lshlrev_b32 v22, 16, v24
    v_and_b32 v23, 0xffff0000, v24
    v_mul_f32 v22, v22, v20
    v_mul_f32 v23, v23, v20
    v_cvt_pk_bf16_f32 v28, v22, v23
    v_sub_f32 v22, v16, v19
    v_sub_f32 v23, v17, v19
    v_cvt_pk_bf16_f32 v24, v22, v23
    v_lshlrev_b32 v22, 16, v24
    v_and_b32 v23, 0xffff0000, v24
    v_mul_f32 v22, v22, v20
    v_mul_f32 v23, v23, v20
    v_cvt_pk_bf16_f32 v29, v22, v23
    buffer_store_dword v25, v2, s[4:7], 0 offen offset:0 sc1
    buffer_store_dword v26, v2, s[4:7], 0 offen offset:256 sc1
    buffer_store_dword v27, v2, s[4:7], 0 offen offset:512 sc1
    buffer_store_dword v28, v2, s[4:7], 0 offen offset:768 sc1
    buffer_store_dword v29, v2, s[4:7], 0 offen offset:1024 sc1
    v_lshrrev_b32 v1, 6, v0
    v_lshlrev_b32 v1, 2, v1
    v_add_u32 v1, s16, v1
    v_add_u32 v1, 2, v1
    v_mul_u32_u24 v1, 1280, v1
    v_and_b32 v2, 63, v0
    v_lshl_add_u32 v1, v2, 2, v1
    v_add_u32 v2, 238518272, v1
    v_add_u32 v1, 235896832, v1
    buffer_load_dword v3, v1, s[4:7], 0 offen offset:0 sc1
    buffer_load_dword v4, v1, s[4:7], 0 offen offset:256 sc1
    buffer_load_dword v5, v1, s[4:7], 0 offen offset:512 sc1
    buffer_load_dword v6, v1, s[4:7], 0 offen offset:768 sc1
    buffer_load_dword v7, v1, s[4:7], 0 offen offset:1024 sc1
    s_waitcnt vmcnt(0)
    v_lshlrev_b32 v8, 16, v3
    v_and_b32 v9, 0xffff0000, v3
    v_lshlrev_b32 v10, 16, v4
    v_and_b32 v11, 0xffff0000, v4
    v_lshlrev_b32 v12, 16, v5
    v_and_b32 v13, 0xffff0000, v5
    v_lshlrev_b32 v14, 16, v6
    v_and_b32 v15, 0xffff0000, v6
    v_lshlrev_b32 v16, 16, v7
    v_and_b32 v17, 0xffff0000, v7
    v_add_f32 v18, v8, v9
    v_add_f32 v18, v18, v10
    v_add_f32 v18, v18, v11
    v_add_f32 v18, v18, v12
    v_add_f32 v18, v18, v13
    v_add_f32 v18, v18, v14
    v_add_f32 v18, v18, v15
    v_add_f32 v18, v18, v16
    v_add_f32 v18, v18, v17
    s_nop 1
    v_add_f32_dpp v18, v18, v18 row_shr:1 row_mask:0xf bank_mask:0xf bound_ctrl:0
    s_nop 1
    v_add_f32_dpp v18, v18, v18 row_shr:2 row_mask:0xf bank_mask:0xf bound_ctrl:0
    s_nop 1
    v_add_f32_dpp v18, v18, v18 row_shr:4 row_mask:0xf bank_mask:0xf bound_ctrl:0
    s_nop 1
    v_add_f32_dpp v18, v18, v18 row_shr:8 row_mask:0xf bank_mask:0xf bound_ctrl:0
    s_nop 1
    v_add_f32_dpp v18, v18, v18 row_bcast:15 row_mask:0xa bank_mask:0xf
    s_nop 1
    v_add_f32_dpp v18, v18, v18 row_bcast:31 row_mask:0xc bank_mask:0xf
    s_nop 0
    v_readlane_b32 s20, v18, 63
    s_nop 1
    v_mov_b32 v19, 0x3acccccd
    v_mul_f32 v19, s20, v19
    v_sub_f32 v20, v8, v19
    v_mul_f32 v18, v20, v20
    v_sub_f32 v20, v9, v19
    v_fmac_f32 v18, v20, v20
    v_sub_f32 v20, v10, v19
    v_fmac_f32 v18, v20, v20
    v_sub_f32 v20, v11, v19
    v_fmac_f32 v18, v20, v20
    v_sub_f32 v20, v12, v19
    v_fmac_f32 v18, v20, v20
    v_sub_f32 v20, v13, v19
    v_fmac_f32 v18, v20, v20
    v_sub_f32 v20, v14, v19
    v_fmac_f32 v18, v20, v20
    v_sub_f32 v20, v15, v19
    v_fmac_f32 v18, v20, v20
    v_sub_f32 v20, v16, v19
    v_fmac_f32 v18, v20, v20
    v_sub_f32 v20, v17, v19
    v_fmac_f32 v18, v20, v20
    s_nop 1
    v_add_f32_dpp v18, v18, v18 row_shr:1 row_mask:0xf bank_mask:0xf bound_ctrl:0
    s_nop 1
    v_add_f32_dpp v18, v18, v18 row_shr:2 row_mask:0xf bank_mask:0xf bound_ctrl:0
    s_nop 1
    v_add_f32_dpp v18, v18, v18 row_shr:4 row_mask:0xf bank_mask:0xf bound_ctrl:0
    s_nop 1
    v_add_f32_dpp v18, v18, v18 row_shr:8 row_mask:0xf bank_mask:0xf bound_ctrl:0
    s_nop 1
    v_add_f32_dpp v18, v18, v18 row_bcast:15 row_mask:0xa bank_mask:0xf
    s_nop 1
    v_add_f32_dpp v18, v18, v18 row_bcast:31 row_mask:0xc bank_mask:0xf
    s_nop 0
    v_readlane_b32 s21, v18, 63
    s_nop 1
    v_mov_b32 v20, 0x3acccccd
    v_mul_f32 v20, s21, v20
    v_cvt_pk_bf16_f32 v21, v19, v20
    v_lshlrev_b32 v19, 16, v21
    v_and_b32 v20, 0xffff0000, v21
    v_add_f32 v20, 0x3727c5ac, v20
    v_cvt_pk_bf16_f32 v20, v20, v20
    v_lshlrev_b32 v20, 16, v20
    v_sqrt_f32 v20, v20
    s_nop 0
    v_cvt_pk_bf16_f32 v20, v20, v20
    v_lshlrev_b32 v20, 16, v20
    v_rcp_f32 v20, v20
    s_nop 0
    v_sub_f32 v22, v8, v19
    v_sub_f32 v23, v9, v19
    v_cvt_pk_bf16_f32 v24, v22, v23
    v_lshlrev_b32 v22, 16, v24
    v_and_b32 v23, 0xffff0000, v24
    v_mul_f32 v22, v22, v20
    v_mul_f32 v23, v23, v20
    v_cvt_pk_bf16_f32 v25, v22, v23
    v_sub_f32 v22, v10, v19
    v_sub_f32 v23, v11, v19
    v_cvt_pk_bf16_f32 v24, v22, v23
    v_lshlrev_b32 v22, 16, v24
    v_and_b32 v23, 0xffff0000, v24
    v_mul_f32 v22, v22, v20
    v_mul_f32 v23, v23, v20
    v_cvt_pk_bf16_f32 v26, v22, v23
    v_sub_f32 v22, v12, v19
    v_sub_f32 v23, v13, v19
    v_cvt_pk_bf16_f32 v24, v22, v23
    v_lshlrev_b32 v22, 16, v24
    v_and_b32 v23, 0xffff0000, v24
    v_mul_f32 v22, v22, v20
    v_mul_f32 v23, v23, v20
    v_cvt_pk_bf16_f32 v27, v22, v23
    v_sub_f32 v22, v14, v19
    v_sub_f32 v23, v15, v19
    v_cvt_pk_bf16_f32 v24, v22, v23
    v_lshlrev_b32 v22, 16, v24
    v_and_b32 v23, 0xffff0000, v24
    v_mul_f32 v22, v22, v20
    v_mul_f32 v23, v23, v20
    v_cvt_pk_bf16_f32 v28, v22, v23
    v_sub_f32 v22, v16, v19
    v_sub_f32 v23, v17, v19
    v_cvt_pk_bf16_f32 v24, v22, v23
    v_lshlrev_b32 v22, 16, v24
    v_and_b32 v23, 0xffff0000, v24
    v_mul_f32 v22, v22, v20
    v_mul_f32 v23, v23, v20
    v_cvt_pk_bf16_f32 v29, v22, v23
    buffer_store_dword v25, v2, s[4:7], 0 offen offset:0 sc1
    buffer_store_dword v26, v2, s[4:7], 0 offen offset:256 sc1
    buffer_store_dword v27, v2, s[4:7], 0 offen offset:512 sc1
    buffer_store_dword v28, v2, s[4:7], 0 offen offset:768 sc1
    buffer_store_dword v29, v2, s[4:7], 0 offen offset:1024 sc1
    v_lshrrev_b32 v1, 6, v0
    v_lshlrev_b32 v1, 2, v1
    v_add_u32 v1, s16, v1
    v_add_u32 v1, 3, v1
    v_mul_u32_u24 v1, 1280, v1
    v_and_b32 v2, 63, v0
    v_lshl_add_u32 v1, v2, 2, v1
    v_add_u32 v2, 238518272, v1
    v_add_u32 v1, 235896832, v1
    buffer_load_dword v3, v1, s[4:7], 0 offen offset:0 sc1
    buffer_load_dword v4, v1, s[4:7], 0 offen offset:256 sc1
    buffer_load_dword v5, v1, s[4:7], 0 offen offset:512 sc1
    buffer_load_dword v6, v1, s[4:7], 0 offen offset:768 sc1
    buffer_load_dword v7, v1, s[4:7], 0 offen offset:1024 sc1
    s_waitcnt vmcnt(0)
    v_lshlrev_b32 v8, 16, v3
    v_and_b32 v9, 0xffff0000, v3
    v_lshlrev_b32 v10, 16, v4
    v_and_b32 v11, 0xffff0000, v4
    v_lshlrev_b32 v12, 16, v5
    v_and_b32 v13, 0xffff0000, v5
    v_lshlrev_b32 v14, 16, v6
    v_and_b32 v15, 0xffff0000, v6
    v_lshlrev_b32 v16, 16, v7
    v_and_b32 v17, 0xffff0000, v7
    v_add_f32 v18, v8, v9
    v_add_f32 v18, v18, v10
    v_add_f32 v18, v18, v11
    v_add_f32 v18, v18, v12
    v_add_f32 v18, v18, v13
    v_add_f32 v18, v18, v14
    v_add_f32 v18, v18, v15
    v_add_f32 v18, v18, v16
    v_add_f32 v18, v18, v17
    s_nop 1
    v_add_f32_dpp v18, v18, v18 row_shr:1 row_mask:0xf bank_mask:0xf bound_ctrl:0
    s_nop 1
    v_add_f32_dpp v18, v18, v18 row_shr:2 row_mask:0xf bank_mask:0xf bound_ctrl:0
    s_nop 1
    v_add_f32_dpp v18, v18, v18 row_shr:4 row_mask:0xf bank_mask:0xf bound_ctrl:0
    s_nop 1
    v_add_f32_dpp v18, v18, v18 row_shr:8 row_mask:0xf bank_mask:0xf bound_ctrl:0
    s_nop 1
    v_add_f32_dpp v18, v18, v18 row_bcast:15 row_mask:0xa bank_mask:0xf
    s_nop 1
    v_add_f32_dpp v18, v18, v18 row_bcast:31 row_mask:0xc bank_mask:0xf
    s_nop 0
    v_readlane_b32 s20, v18, 63
    s_nop 1
    v_mov_b32 v19, 0x3acccccd
    v_mul_f32 v19, s20, v19
    v_sub_f32 v20, v8, v19
    v_mul_f32 v18, v20, v20
    v_sub_f32 v20, v9, v19
    v_fmac_f32 v18, v20, v20
    v_sub_f32 v20, v10, v19
    v_fmac_f32 v18, v20, v20
    v_sub_f32 v20, v11, v19
    v_fmac_f32 v18, v20, v20
    v_sub_f32 v20, v12, v19
    v_fmac_f32 v18, v20, v20
    v_sub_f32 v20, v13, v19
    v_fmac_f32 v18, v20, v20
    v_sub_f32 v20, v14, v19
    v_fmac_f32 v18, v20, v20
    v_sub_f32 v20, v15, v19
    v_fmac_f32 v18, v20, v20
    v_sub_f32 v20, v16, v19
    v_fmac_f32 v18, v20, v20
    v_sub_f32 v20, v17, v19
    v_fmac_f32 v18, v20, v20
    s_nop 1
    v_add_f32_dpp v18, v18, v18 row_shr:1 row_mask:0xf bank_mask:0xf bound_ctrl:0
    s_nop 1
    v_add_f32_dpp v18, v18, v18 row_shr:2 row_mask:0xf bank_mask:0xf bound_ctrl:0
    s_nop 1
    v_add_f32_dpp v18, v18, v18 row_shr:4 row_mask:0xf bank_mask:0xf bound_ctrl:0
    s_nop 1
    v_add_f32_dpp v18, v18, v18 row_shr:8 row_mask:0xf bank_mask:0xf bound_ctrl:0
    s_nop 1
    v_add_f32_dpp v18, v18, v18 row_bcast:15 row_mask:0xa bank_mask:0xf
    s_nop 1
    v_add_f32_dpp v18, v18, v18 row_bcast:31 row_mask:0xc bank_mask:0xf
    s_nop 0
    v_readlane_b32 s21, v18, 63
    s_nop 1
    v_mov_b32 v20, 0x3acccccd
    v_mul_f32 v20, s21, v20
    v_cvt_pk_bf16_f32 v21, v19, v20
    v_lshlrev_b32 v19, 16, v21
    v_and_b32 v20, 0xffff0000, v21
    v_add_f32 v20, 0x3727c5ac, v20
    v_cvt_pk_bf16_f32 v20, v20, v20
    v_lshlrev_b32 v20, 16, v20
    v_sqrt_f32 v20, v20
    s_nop 0
    v_cvt_pk_bf16_f32 v20, v20, v20
    v_lshlrev_b32 v20, 16, v20
    v_rcp_f32 v20, v20
    s_nop 0
    v_sub_f32 v22, v8, v19
    v_sub_f32 v23, v9, v19
    v_cvt_pk_bf16_f32 v24, v22, v23
    v_lshlrev_b32 v22, 16, v24
    v_and_b32 v23, 0xffff0000, v24
    v_mul_f32 v22, v22, v20
    v_mul_f32 v23, v23, v20
    v_cvt_pk_bf16_f32 v25, v22, v23
    v_sub_f32 v22, v10, v19
    v_sub_f32 v23, v11, v19
    v_cvt_pk_bf16_f32 v24, v22, v23
    v_lshlrev_b32 v22, 16, v24
    v_and_b32 v23, 0xffff0000, v24
    v_mul_f32 v22, v22, v20
    v_mul_f32 v23, v23, v20
    v_cvt_pk_bf16_f32 v26, v22, v23
    v_sub_f32 v22, v12, v19
    v_sub_f32 v23, v13, v19
    v_cvt_pk_bf16_f32 v24, v22, v23
    v_lshlrev_b32 v22, 16, v24
    v_and_b32 v23, 0xffff0000, v24
    v_mul_f32 v22, v22, v20
    v_mul_f32 v23, v23, v20
    v_cvt_pk_bf16_f32 v27, v22, v23
    v_sub_f32 v22, v14, v19
    v_sub_f32 v23, v15, v19
    v_cvt_pk_bf16_f32 v24, v22, v23
    v_lshlrev_b32 v22, 16, v24
    v_and_b32 v23, 0xffff0000, v24
    v_mul_f32 v22, v22, v20
    v_mul_f32 v23, v23, v20
    v_cvt_pk_bf16_f32 v28, v22, v23
    v_sub_f32 v22, v16, v19
    v_sub_f32 v23, v17, v19
    v_cvt_pk_bf16_f32 v24, v22, v23
    v_lshlrev_b32 v22, 16, v24
    v_and_b32 v23, 0xffff0000, v24
    v_mul_f32 v22, v22, v20
    v_mul_f32 v23, v23, v20
    v_cvt_pk_bf16_f32 v29, v22, v23
    buffer_store_dword v25, v2, s[4:7], 0 offen offset:0 sc1
    buffer_store_dword v26, v2, s[4:7], 0 offen offset:256 sc1
    buffer_store_dword v27, v2, s[4:7], 0 offen offset:512 sc1
    buffer_store_dword v28, v2, s[4:7], 0 offen offset:768 sc1
    buffer_store_dword v29, v2, s[4:7], 0 offen offset:1024 sc1
    s_branch wk_fin
wk_ffn1:
    v_and_b32 v1, 15, v0
    v_bfe_u32 v2, v0, 4, 2
    v_mul_u32_u24 v4, 1280, v1
    v_lshl_add_u32 v4, v2, 4, v4
    v_mul_u32_u24 v5, 1280, v1
    v_lshl_add_u32 v5, v2, 4, v5
    s_mul_i32 s20, s16, 81920
    s_add_u32 s20, s20, 34078720
    s_mul_i32 s21, s17, 81920
    s_add_u32 s21, s21, 238518272
    s_mul_i32 s22, s52, 320
    s_add_u32 s20, s20, s22
    s_add_u32 s21, s21, s22
    s_add_u32 s24, s20, 0
    s_add_u32 s25, s20, 20480
    s_add_u32 s26, s20, 40960
    s_add_u32 s27, s20, 61440
    s_add_u32 s28, s21, 0
    s_add_u32 s29, s21, 20480
    s_add_u32 s30, s21, 40960
    s_add_u32 s31, s21, 61440
    buffer_load_dwordx4 v[80:83], v4, s[4:7], s24 offen offset:0 sc1
    buffer_load_dwordx4 v[84:87], v4, s[4:7], s25 offen offset:0 sc1
    buffer_load_dwordx4 v[88:91], v4, s[4:7], s26 offen offset:0 sc1
    buffer_load_dwordx4 v[92:95], v4, s[4:7], s27 offen offset:0 sc1
    buffer_load_dwordx4 v[112:115], v4, s[4:7], s24 offen offset:64 sc1
    buffer_load_dwordx4 v[116:119], v4, s[4:7], s25 offen offset:64 sc1
    buffer_load_dwordx4 v[120:123], v4, s[4:7], s26 offen offset:64 sc1
    buffer_load_dwordx4 v[124:127], v4, s[4:7], s27 offen offset:64 sc1
    buffer_load_dwordx4 v[144:147], v4, s[4:7], s24 offen offset:128 sc1
    buffer_load_dwordx4 v[148:151], v4, s[4:7], s25 offen offset:128 sc1
    buffer_load_dwordx4 v[152:155], v4, s[4:7], s26 offen offset:128 sc1
    buffer_load_dwordx4 v[156:159], v4, s[4:7], s27 offen offset:128 sc1
    buffer_load_dwordx4 v[176:179], v4, s[4:7], s24 offen offset:192 sc1
    buffer_load_dwordx4 v[180:183], v4, s[4:7], s25 offen offset:192 sc1
    buffer_load_dwordx4 v[184:187], v4, s[4:7], s26 offen offset:192 sc1
    buffer_load_dwordx4 v[188:191], v4, s[4:7], s27 offen offset:192 sc1
    buffer_load_dwordx4 v[208:211], v4, s[4:7], s24 offen offset:256 sc1
    buffer_load_dwordx4 v[212:215], v4, s[4:7], s25 offen offset:256 sc1
    buffer_load_dwordx4 v[216:219], v4, s[4:7], s26 offen offset:256 sc1
    buffer_load_dwordx4 v[220:223], v4, s[4:7], s27 offen offset:256 sc1
    s_mov_b32 s36, 0
wk_wl:
    buffer_load_dword v6, off, s[4:7], s66 sc1
    s_waitcnt vmcnt(0)
    v_readfirstlane_b32 s35, v6
    s_add_u32 s36, s36, 1
    s_cmp_ge_u32 s36, 262144
    s_cbranch_scc1 chain_done
    s_cmp_ge_u32 s35, 8
    s_cbranch_scc1 wk_wl_ok
    s_sleep 4
    s_branch wk_wl
wk_wl_ok:
    buffer_load_dwordx4 v[96:99], v5, s[4:7], s28 offen offset:0 sc1
    buffer_load_dwordx4 v[100:103], v5, s[4:7], s29 offen offset:0 sc1
    buffer_load_dwordx4 v[104:107], v5, s[4:7], s30 offen offset:0 sc1
    buffer_load_dwordx4 v[108:111], v5, s[4:7], s31 offen offset:0 sc1
    buffer_load_dwordx4 v[128:131], v5, s[4:7], s28 offen offset:64 sc1
    buffer_load_dwordx4 v[132:135], v5, s[4:7], s29 offen offset:64 sc1
    buffer_load_dwordx4 v[136:139], v5, s[4:7], s30 offen offset:64 sc1
    buffer_load_dwordx4 v[140:143], v5, s[4:7], s31 offen offset:64 sc1
    buffer_load_dwordx4 v[160:163], v5, s[4:7], s28 offen offset:128 sc1
    buffer_load_dwordx4 v[164:167], v5, s[4:7], s29 offen offset:128 sc1
    buffer_load_dwordx4 v[168:171], v5, s[4:7], s30 offen offset:128 sc1
    buffer_load_dwordx4 v[172:175], v5, s[4:7], s31 offen offset:128 sc1
    buffer_load_dwordx4 v[192:195], v5, s[4:7], s28 offen offset:192 sc1
    buffer_load_dwordx4 v[196:199], v5, s[4:7], s29 offen offset:192 sc1
    buffer_load_dwordx4 v[200:203], v5, s[4:7], s30 offen offset:192 sc1
    buffer_load_dwordx4 v[204:207], v5, s[4:7], s31 offen offset:192 sc1
    buffer_load_dwordx4 v[224:227], v5, s[4:7], s28 offen offset:256 sc1
    buffer_load_dwordx4 v[228:231], v5, s[4:7], s29 offen offset:256 sc1
    buffer_load_dwordx4 v[232:235], v5, s[4:7], s30 offen offset:256 sc1
    buffer_load_dwordx4 v[236:239], v5, s[4:7], s31 offen offset:256 sc1
    v_mov_b32 v16, 0
    v_mov_b32 v17, 0
    v_mov_b32 v18, 0
    v_mov_b32 v19, 0
    v_mov_b32 v20, 0
    v_mov_b32 v21, 0
    v_mov_b32 v22, 0
    v_mov_b32 v23, 0
    v_mov_b32 v24, 0
    v_mov_b32 v25, 0
    v_mov_b32 v26, 0
    v_mov_b32 v27, 0
    v_mov_b32 v28, 0
    v_mov_b32 v29, 0
    v_mov_b32 v30, 0
    v_mov_b32 v31, 0
    v_mov_b32 v32, 0
    v_mov_b32 v33, 0
    v_mov_b32 v34, 0
    v_mov_b32 v35, 0
    v_mov_b32 v36, 0
    v_mov_b32 v37, 0
    v_mov_b32 v38, 0
    v_mov_b32 v39, 0
    v_mov_b32 v40, 0
    v_mov_b32 v41, 0
    v_mov_b32 v42, 0
    v_mov_b32 v43, 0
    v_mov_b32 v44, 0
    v_mov_b32 v45, 0
    v_mov_b32 v46, 0
    v_mov_b32 v47, 0
    v_mov_b32 v48, 0
    v_mov_b32 v49, 0
    v_mov_b32 v50, 0
    v_mov_b32 v51, 0
    v_mov_b32 v52, 0
    v_mov_b32 v53, 0
    v_mov_b32 v54, 0
    v_mov_b32 v55, 0
    v_mov_b32 v56, 0
    v_mov_b32 v57, 0
    v_mov_b32 v58, 0
    v_mov_b32 v59, 0
    v_mov_b32 v60, 0
    v_mov_b32 v61, 0
    v_mov_b32 v62, 0
    v_mov_b32 v63, 0
    v_mov_b32 v64, 0
    v_mov_b32 v65, 0
    v_mov_b32 v66, 0
    v_mov_b32 v67, 0
    v_mov_b32 v68, 0
    v_mov_b32 v69, 0
    v_mov_b32 v70, 0
    v_mov_b32 v71, 0
    v_mov_b32 v72, 0
    v_mov_b32 v73, 0
    v_mov_b32 v74, 0
    v_mov_b32 v75, 0
    v_mov_b32 v76, 0
    v_mov_b32 v77, 0
    v_mov_b32 v78, 0
    v_mov_b32 v79, 0
    s_waitcnt vmcnt(16)
    v_mfma_f32_16x16x32_bf16 v[16:19], v[80:83], v[96:99], v[16:19]
    v_mfma_f32_16x16x32_bf16 v[20:23], v[80:83], v[100:103], v[20:23]
    v_mfma_f32_16x16x32_bf16 v[24:27], v[80:83], v[104:107], v[24:27]
    v_mfma_f32_16x16x32_bf16 v[28:31], v[80:83], v[108:111], v[28:31]
    v_mfma_f32_16x16x32_bf16 v[32:35], v[84:87], v[96:99], v[32:35]
    v_mfma_f32_16x16x32_bf16 v[36:39], v[84:87], v[100:103], v[36:39]
    v_mfma_f32_16x16x32_bf16 v[40:43], v[84:87], v[104:107], v[40:43]
    v_mfma_f32_16x16x32_bf16 v[44:47], v[84:87], v[108:111], v[44:47]
    v_mfma_f32_16x16x32_bf16 v[48:51], v[88:91], v[96:99], v[48:51]
    v_mfma_f32_16x16x32_bf16 v[52:55], v[88:91], v[100:103], v[52:55]
    v_mfma_f32_16x16x32_bf16 v[56:59], v[88:91], v[104:107], v[56:59]
    v_mfma_f32_16x16x32_bf16 v[60:63], v[88:91], v[108:111], v[60:63]
    v_mfma_f32_16x16x32_bf16 v[64:67], v[92:95], v[96:99], v[64:67]
    v_mfma_f32_16x16x32_bf16 v[68:71], v[92:95], v[100:103], v[68:71]
    v_mfma_f32_16x16x32_bf16 v[72:75], v[92:95], v[104:107], v[72:75]
    v_mfma_f32_16x16x32_bf16 v[76:79], v[92:95], v[108:111], v[76:79]
    s_waitcnt vmcnt(12)
    v_mfma_f32_16x16x32_bf16 v[16:19], v[112:115], v[128:131], v[16:19]
    v_mfma_f32_16x16x32_bf16 v[20:23], v[112:115], v[132:135], v[20:23]
    v_mfma_f32_16x16x32_bf16 v[24:27], v[112:115], v[136:139], v[24:27]
    v_mfma_f32_16x16x32_bf16 v[28:31], v[112:115], v[140:143], v[28:31]
    v_mfma_f32_16x16x32_bf16 v[32:35], v[116:119], v[128:131], v[32:35]
    v_mfma_f32_16x16x32_bf16 v[36:39], v[116:119], v[132:135], v[36:39]
    v_mfma_f32_16x16x32_bf16 v[40:43], v[116:119], v[136:139], v[40:43]
    v_mfma_f32_16x16x32_bf16 v[44:47], v[116:119], v[140:143], v[44:47]
    v_mfma_f32_16x16x32_bf16 v[48:51], v[120:123], v[128:131], v[48:51]
    v_mfma_f32_16x16x32_bf16 v[52:55], v[120:123], v[132:135], v[52:55]
    v_mfma_f32_16x16x32_bf16 v[56:59], v[120:123], v[136:139], v[56:59]
    v_mfma_f32_16x16x32_bf16 v[60:63], v[120:123], v[140:143], v[60:63]
    v_mfma_f32_16x16x32_bf16 v[64:67], v[124:127], v[128:131], v[64:67]
    v_mfma_f32_16x16x32_bf16 v[68:71], v[124:127], v[132:135], v[68:71]
    v_mfma_f32_16x16x32_bf16 v[72:75], v[124:127], v[136:139], v[72:75]
    v_mfma_f32_16x16x32_bf16 v[76:79], v[124:127], v[140:143], v[76:79]
    s_waitcnt vmcnt(8)
    v_mfma_f32_16x16x32_bf16 v[16:19], v[144:147], v[160:163], v[16:19]
    v_mfma_f32_16x16x32_bf16 v[20:23], v[144:147], v[164:167], v[20:23]
    v_mfma_f32_16x16x32_bf16 v[24:27], v[144:147], v[168:171], v[24:27]
    v_mfma_f32_16x16x32_bf16 v[28:31], v[144:147], v[172:175], v[28:31]
    v_mfma_f32_16x16x32_bf16 v[32:35], v[148:151], v[160:163], v[32:35]
    v_mfma_f32_16x16x32_bf16 v[36:39], v[148:151], v[164:167], v[36:39]
    v_mfma_f32_16x16x32_bf16 v[40:43], v[148:151], v[168:171], v[40:43]
    v_mfma_f32_16x16x32_bf16 v[44:47], v[148:151], v[172:175], v[44:47]
    v_mfma_f32_16x16x32_bf16 v[48:51], v[152:155], v[160:163], v[48:51]
    v_mfma_f32_16x16x32_bf16 v[52:55], v[152:155], v[164:167], v[52:55]
    v_mfma_f32_16x16x32_bf16 v[56:59], v[152:155], v[168:171], v[56:59]
    v_mfma_f32_16x16x32_bf16 v[60:63], v[152:155], v[172:175], v[60:63]
    v_mfma_f32_16x16x32_bf16 v[64:67], v[156:159], v[160:163], v[64:67]
    v_mfma_f32_16x16x32_bf16 v[68:71], v[156:159], v[164:167], v[68:71]
    v_mfma_f32_16x16x32_bf16 v[72:75], v[156:159], v[168:171], v[72:75]
    v_mfma_f32_16x16x32_bf16 v[76:79], v[156:159], v[172:175], v[76:79]
    s_waitcnt vmcnt(4)
    v_mfma_f32_16x16x32_bf16 v[16:19], v[176:179], v[192:195], v[16:19]
    v_mfma_f32_16x16x32_bf16 v[20:23], v[176:179], v[196:199], v[20:23]
    v_mfma_f32_16x16x32_bf16 v[24:27], v[176:179], v[200:203], v[24:27]
    v_mfma_f32_16x16x32_bf16 v[28:31], v[176:179], v[204:207], v[28:31]
    v_mfma_f32_16x16x32_bf16 v[32:35], v[180:183], v[192:195], v[32:35]
    v_mfma_f32_16x16x32_bf16 v[36:39], v[180:183], v[196:199], v[36:39]
    v_mfma_f32_16x16x32_bf16 v[40:43], v[180:183], v[200:203], v[40:43]
    v_mfma_f32_16x16x32_bf16 v[44:47], v[180:183], v[204:207], v[44:47]
    v_mfma_f32_16x16x32_bf16 v[48:51], v[184:187], v[192:195], v[48:51]
    v_mfma_f32_16x16x32_bf16 v[52:55], v[184:187], v[196:199], v[52:55]
    v_mfma_f32_16x16x32_bf16 v[56:59], v[184:187], v[200:203], v[56:59]
    v_mfma_f32_16x16x32_bf16 v[60:63], v[184:187], v[204:207], v[60:63]
    v_mfma_f32_16x16x32_bf16 v[64:67], v[188:191], v[192:195], v[64:67]
    v_mfma_f32_16x16x32_bf16 v[68:71], v[188:191], v[196:199], v[68:71]
    v_mfma_f32_16x16x32_bf16 v[72:75], v[188:191], v[200:203], v[72:75]
    v_mfma_f32_16x16x32_bf16 v[76:79], v[188:191], v[204:207], v[76:79]
    s_waitcnt vmcnt(0)
    v_mfma_f32_16x16x32_bf16 v[16:19], v[208:211], v[224:227], v[16:19]
    v_mfma_f32_16x16x32_bf16 v[20:23], v[208:211], v[228:231], v[20:23]
    v_mfma_f32_16x16x32_bf16 v[24:27], v[208:211], v[232:235], v[24:27]
    v_mfma_f32_16x16x32_bf16 v[28:31], v[208:211], v[236:239], v[28:31]
    v_mfma_f32_16x16x32_bf16 v[32:35], v[212:215], v[224:227], v[32:35]
    v_mfma_f32_16x16x32_bf16 v[36:39], v[212:215], v[228:231], v[36:39]
    v_mfma_f32_16x16x32_bf16 v[40:43], v[212:215], v[232:235], v[40:43]
    v_mfma_f32_16x16x32_bf16 v[44:47], v[212:215], v[236:239], v[44:47]
    v_mfma_f32_16x16x32_bf16 v[48:51], v[216:219], v[224:227], v[48:51]
    v_mfma_f32_16x16x32_bf16 v[52:55], v[216:219], v[228:231], v[52:55]
    v_mfma_f32_16x16x32_bf16 v[56:59], v[216:219], v[232:235], v[56:59]
    v_mfma_f32_16x16x32_bf16 v[60:63], v[216:219], v[236:239], v[60:63]
    v_mfma_f32_16x16x32_bf16 v[64:67], v[220:223], v[224:227], v[64:67]
    v_mfma_f32_16x16x32_bf16 v[68:71], v[220:223], v[228:231], v[68:71]
    v_mfma_f32_16x16x32_bf16 v[72:75], v[220:223], v[232:235], v[72:75]
    v_mfma_f32_16x16x32_bf16 v[76:79], v[220:223], v[236:239], v[76:79]
    s_nop 7
    v_and_b32 v6, 63, v0
    v_lshlrev_b32 v6, 4, v6
    s_cmp_eq_u32 s52, 0
    s_cbranch_scc1 wk_ffn1_w0a
    s_sub_u32 s22, s52, 1
    s_mul_i32 s22, s22, 16384
    v_add_u32 v7, s22, v6
    ds_write_b128 v7, v[16:19] offset:0
    ds_write_b128 v7, v[20:23] offset:1024
    ds_write_b128 v7, v[24:27] offset:2048
    ds_write_b128 v7, v[28:31] offset:3072
    ds_write_b128 v7, v[32:35] offset:4096
    ds_write_b128 v7, v[36:39] offset:5120
    ds_write_b128 v7, v[40:43] offset:6144
    ds_write_b128 v7, v[44:47] offset:7168
    ds_write_b128 v7, v[48:51] offset:8192
    ds_write_b128 v7, v[52:55] offset:9216
    ds_write_b128 v7, v[56:59] offset:10240
    ds_write_b128 v7, v[60:63] offset:11264
    ds_write_b128 v7, v[64:67] offset:12288
    ds_write_b128 v7, v[68:71] offset:13312
    ds_write_b128 v7, v[72:75] offset:14336
    ds_write_b128 v7, v[76:79] offset:15360
    s_waitcnt lgkmcnt(0)
wk_ffn1_w0a:
    s_barrier
    s_cmp_lg_u32 s52, 0
    s_cbranch_scc1 wk_fin
    ds_read_b128 v[80:83], v6 offset:0
    ds_read_b128 v[84:87], v6 offset:1024
    ds_read_b128 v[88:91], v6 offset:2048
    ds_read_b128 v[92:95], v6 offset:3072
    ds_read_b128 v[96:99], v6 offset:4096
    ds_read_b128 v[100:103], v6 offset:5120
    ds_read_b128 v[104:107], v6 offset:6144
    ds_read_b128 v[108:111], v6 offset:7168
    ds_read_b128 v[112:115], v6 offset:8192
    ds_read_b128 v[116:119], v6 offset:9216
    ds_read_b128 v[120:123], v6 offset:10240
    ds_read_b128 v[124:127], v6 offset:11264
    ds_read_b128 v[128:131], v6 offset:12288
    ds_read_b128 v[132:135], v6 offset:13312
    ds_read_b128 v[136:139], v6 offset:14336
    ds_read_b128 v[140:143], v6 offset:15360
    s_waitcnt lgkmcnt(0)
    v_add_f32 v16, v16, v80
    v_add_f32 v17, v17, v81
    v_add_f32 v18, v18, v82
    v_add_f32 v19, v19, v83
    v_add_f32 v20, v20, v84
    v_add_f32 v21, v21, v85
    v_add_f32 v22, v22, v86
    v_add_f32 v23, v23, v87
    v_add_f32 v24, v24, v88
    v_add_f32 v25, v25, v89
    v_add_f32 v26, v26, v90
    v_add_f32 v27, v27, v91
    v_add_f32 v28, v28, v92
    v_add_f32 v29, v29, v93
    v_add_f32 v30, v30, v94
    v_add_f32 v31, v31, v95
    v_add_f32 v32, v32, v96
    v_add_f32 v33, v33, v97
    v_add_f32 v34, v34, v98
    v_add_f32 v35, v35, v99
    v_add_f32 v36, v36, v100
    v_add_f32 v37, v37, v101
    v_add_f32 v38, v38, v102
    v_add_f32 v39, v39, v103
    v_add_f32 v40, v40, v104
    v_add_f32 v41, v41, v105
    v_add_f32 v42, v42, v106
    v_add_f32 v43, v43, v107
    v_add_f32 v44, v44, v108
    v_add_f32 v45, v45, v109
    v_add_f32 v46, v46, v110
    v_add_f32 v47, v47, v111
    v_add_f32 v48, v48, v112
    v_add_f32 v49, v49, v113
    v_add_f32 v50, v50, v114
    v_add_f32 v51, v51, v115
    v_add_f32 v52, v52, v116
    v_add_f32 v53, v53, v117
    v_add_f32 v54, v54, v118
    v_add_f32 v55, v55, v119
    v_add_f32 v56, v56, v120
    v_add_f32 v57, v57, v121
    v_add_f32 v58, v58, v122
    v_add_f32 v59, v59, v123
    v_add_f32 v60, v60, v124
    v_add_f32 v61, v61, v125
    v_add_f32 v62, v62, v126
    v_add_f32 v63, v63, v127
    v_add_f32 v64, v64, v128
    v_add_f32 v65, v65, v129
    v_add_f32 v66, v66, v130
    v_add_f32 v67, v67, v131
    v_add_f32 v68, v68, v132
    v_add_f32 v69, v69, v133
    v_add_f32 v70, v70, v134
    v_add_f32 v71, v71, v135
    v_add_f32 v72, v72, v136
    v_add_f32 v73, v73, v137
    v_add_f32 v74, v74, v138
    v_add_f32 v75, v75, v139
    v_add_f32 v76, v76, v140
    v_add_f32 v77, v77, v141
    v_add_f32 v78, v78, v142
    v_add_f32 v79, v79, v143
    ds_read_b128 v[80:83], v6 offset:16384
    ds_read_b128 v[84:87], v6 offset:17408
    ds_read_b128 v[88:91], v6 offset:18432
    ds_read_b128 v[92:95], v6 offset:19456
    ds_read_b128 v[96:99], v6 offset:20480
    ds_read_b128 v[100:103], v6 offset:21504
    ds_read_b128 v[104:107], v6 offset:22528
    ds_read_b128 v[108:111], v6 offset:23552
    ds_read_b128 v[112:115], v6 offset:24576
    ds_read_b128 v[116:119], v6 offset:25600
    ds_read_b128 v[120:123], v6 offset:26624
    ds_read_b128 v[124:127], v6 offset:27648
    ds_read_b128 v[128:131], v6 offset:28672
    ds_read_b128 v[132:135], v6 offset:29696
    ds_read_b128 v[136:139], v6 offset:30720
    ds_read_b128 v[140:143], v6 offset:31744
    s_waitcnt lgkmcnt(0)
    v_add_f32 v16, v16, v80
    v_add_f32 v17, v17, v81
    v_add_f32 v18, v18, v82
    v_add_f32 v19, v19, v83
    v_add_f32 v20, v20, v84
    v_add_f32 v21, v21, v85
    v_add_f32 v22, v22, v86
    v_add_f32 v23, v23, v87
    v_add_f32 v24, v24, v88
    v_add_f32 v25, v25, v89
    v_add_f32 v26, v26, v90
    v_add_f32 v27, v27, v91
    v_add_f32 v28, v28, v92
    v_add_f32 v29, v29, v93
    v_add_f32 v30, v30, v94
    v_add_f32 v31, v31, v95
    v_add_f32 v32, v32, v96
    v_add_f32 v33, v33, v97
    v_add_f32 v34, v34, v98
    v_add_f32 v35, v35, v99
    v_add_f32 v36, v36, v100
    v_add_f32 v37, v37, v101
    v_add_f32 v38, v38, v102
    v_add_f32 v39, v39, v103
    v_add_f32 v40, v40, v104
    v_add_f32 v41, v41, v105
    v_add_f32 v42, v42, v106
    v_add_f32 v43, v43, v107
    v_add_f32 v44, v44, v108
    v_add_f32 v45, v45, v109
    v_add_f32 v46, v46, v110
    v_add_f32 v47, v47, v111
    v_add_f32 v48, v48, v112
    v_add_f32 v49, v49, v113
    v_add_f32 v50, v50, v114
    v_add_f32 v51, v51, v115
    v_add_f32 v52, v52, v116
    v_add_f32 v53, v53, v117
    v_add_f32 v54, v54, v118
    v_add_f32 v55, v55, v119
    v_add_f32 v56, v56, v120
    v_add_f32 v57, v57, v121
    v_add_f32 v58, v58, v122
    v_add_f32 v59, v59, v123
    v_add_f32 v60, v60, v124
    v_add_f32 v61, v61, v125
    v_add_f32 v62, v62, v126
    v_add_f32 v63, v63, v127
    v_add_f32 v64, v64, v128
    v_add_f32 v65, v65, v129
    v_add_f32 v66, v66, v130
    v_add_f32 v67, v67, v131
    v_add_f32 v68, v68, v132
    v_add_f32 v69, v69, v133
    v_add_f32 v70, v70, v134
    v_add_f32 v71, v71, v135
    v_add_f32 v72, v72, v136
    v_add_f32 v73, v73, v137
    v_add_f32 v74, v74, v138
    v_add_f32 v75, v75, v139
    v_add_f32 v76, v76, v140
    v_add_f32 v77, v77, v141
    v_add_f32 v78, v78, v142
    v_add_f32 v79, v79, v143
    ds_read_b128 v[80:83], v6 offset:32768
    ds_read_b128 v[84:87], v6 offset:33792
    ds_read_b128 v[88:91], v6 offset:34816
    ds_read_b128 v[92:95], v6 offset:35840
    ds_read_b128 v[96:99], v6 offset:36864
    ds_read_b128 v[100:103], v6 offset:37888
    ds_read_b128 v[104:107], v6 offset:38912
    ds_read_b128 v[108:111], v6 offset:39936
    ds_read_b128 v[112:115], v6 offset:40960
    ds_read_b128 v[116:119], v6 offset:41984
    ds_read_b128 v[120:123], v6 offset:43008
    ds_read_b128 v[124:127], v6 offset:44032
    ds_read_b128 v[128:131], v6 offset:45056
    ds_read_b128 v[132:135], v6 offset:46080
    ds_read_b128 v[136:139], v6 offset:47104
    ds_read_b128 v[140:143], v6 offset:48128
    s_waitcnt lgkmcnt(0)
    v_add_f32 v16, v16, v80
    v_add_f32 v17, v17, v81
    v_add_f32 v18, v18, v82
    v_add_f32 v19, v19, v83
    v_add_f32 v20, v20, v84
    v_add_f32 v21, v21, v85
    v_add_f32 v22, v22, v86
    v_add_f32 v23, v23, v87
    v_add_f32 v24, v24, v88
    v_add_f32 v25, v25, v89
    v_add_f32 v26, v26, v90
    v_add_f32 v27, v27, v91
    v_add_f32 v28, v28, v92
    v_add_f32 v29, v29, v93
    v_add_f32 v30, v30, v94
    v_add_f32 v31, v31, v95
    v_add_f32 v32, v32, v96
    v_add_f32 v33, v33, v97
    v_add_f32 v34, v34, v98
    v_add_f32 v35, v35, v99
    v_add_f32 v36, v36, v100
    v_add_f32 v37, v37, v101
    v_add_f32 v38, v38, v102
    v_add_f32 v39, v39, v103
    v_add_f32 v40, v40, v104
    v_add_f32 v41, v41, v105
    v_add_f32 v42, v42, v106
    v_add_f32 v43, v43, v107
    v_add_f32 v44, v44, v108
    v_add_f32 v45, v45, v109
    v_add_f32 v46, v46, v110
    v_add_f32 v47, v47, v111
    v_add_f32 v48, v48, v112
    v_add_f32 v49, v49, v113
    v_add_f32 v50, v50, v114
    v_add_f32 v51, v51, v115
    v_add_f32 v52, v52, v116
    v_add_f32 v53, v53, v117
    v_add_f32 v54, v54, v118
    v_add_f32 v55, v55, v119
    v_add_f32 v56, v56, v120
    v_add_f32 v57, v57, v121
    v_add_f32 v58, v58, v122
    v_add_f32 v59, v59, v123
    v_add_f32 v60, v60, v124
    v_add_f32 v61, v61, v125
    v_add_f32 v62, v62, v126
    v_add_f32 v63, v63, v127
    v_add_f32 v64, v64, v128
    v_add_f32 v65, v65, v129
    v_add_f32 v66, v66, v130
    v_add_f32 v67, v67, v131
    v_add_f32 v68, v68, v132
    v_add_f32 v69, v69, v133
    v_add_f32 v70, v70, v134
    v_add_f32 v71, v71, v135
    v_add_f32 v72, v72, v136
    v_add_f32 v73, v73, v137
    v_add_f32 v74, v74, v138
    v_add_f32 v75, v75, v139
    v_add_f32 v76, v76, v140
    v_add_f32 v77, v77, v141
    v_add_f32 v78, v78, v142
    v_add_f32 v79, v79, v143
    s_mul_i32 s23, s17, 64
    v_add_u32 v145, s23, v1
    s_mul_i32 s22, s16, 32
    v_lshlrev_b32 v146, 2, v2
    v_add_u32 v146, s22, v146
    v_mul_u32_u24 v147, 3072, v145
    v_lshl_add_u32 v147, v146, 1, v147
    s_mov_b32 s24, 241139712
    s_mov_b32 s26, 0x3d372713
    s_mov_b32 s27, 0x40135761
    s_add_u32 s25, s24, 0
    v_cvt_pk_bf16_f32 v152, v16, v17
    v_cvt_pk_bf16_f32 v153, v18, v19
    v_cvt_pk_bf16_f32 v154, v32, v33
    v_cvt_pk_bf16_f32 v155, v34, v35
    v_lshlrev_b32 v156, 16, v152
    v_lshlrev_b32 v160, 16, v154
    v_and_b32 v157, 0xffff0000, v152
    v_and_b32 v161, 0xffff0000, v154
    v_lshlrev_b32 v158, 16, v153
    v_lshlrev_b32 v162, 16, v155
    v_and_b32 v159, 0xffff0000, v153
    v_and_b32 v163, 0xffff0000, v155
    v_mul_f32 v164, v156, v156
    v_mul_f32 v164, s26, v164
    v_fma_f32 v164, v164, v156, v156
    v_mul_f32 v164, s27, v164
    v_sub_f32 v164, 0, v164
    v_min_f32 v164, 0x42fc0000, v164
    v_mul_f32 v165, v157, v157
    v_mul_f32 v165, s26, v165
    v_fma_f32 v165, v165, v157, v157
    v_mul_f32 v165, s27, v165
    v_sub_f32 v165, 0, v165
    v_min_f32 v165, 0x42fc0000, v165
    v_mul_f32 v166, v158, v158
    v_mul_f32 v166, s26, v166
    v_fma_f32 v166, v166, v158, v158
    v_mul_f32 v166, s27, v166
    v_sub_f32 v166, 0, v166
    v_min_f32 v166, 0x42fc0000, v166
    v_mul_f32 v167, v159, v159
    v_mul_f32 v167, s26, v167
    v_fma_f32 v167, v167, v159, v159
    v_mul_f32 v167, s27, v167
    v_sub_f32 v167, 0, v167
    v_min_f32 v167, 0x42fc0000, v167
    v_exp_f32 v164, v164
    v_exp_f32 v165, v165
    v_exp_f32 v166, v166
    v_exp_f32 v167, v167
    v_add_f32 v164, 1.0, v164
    v_add_f32 v165, 1.0, v165
    v_add_f32 v166, 1.0, v166
    v_add_f32 v167, 1.0, v167
    v_rcp_f32 v164, v164
    v_rcp_f32 v165, v165
    v_rcp_f32 v166, v166
    v_rcp_f32 v167, v167
    s_nop 0
    v_mul_f32 v156, v156, v164
    v_mul_f32 v157, v157, v165
    v_mul_f32 v158, v158, v166
    v_mul_f32 v159, v159, v167
    v_cvt_pk_bf16_f32 v152, v156, v157
    v_cvt_pk_bf16_f32 v153, v158, v159
    v_lshlrev_b32 v156, 16, v152
    v_mul_f32 v156, v156, v160
    v_and_b32 v157, 0xffff0000, v152
    v_mul_f32 v157, v157, v161
    v_lshlrev_b32 v158, 16, v153
    v_mul_f32 v158, v158, v162
    v_and_b32 v159, 0xffff0000, v153
    v_mul_f32 v159, v159, v163
    v_cvt_pk_bf16_f32 v148, v156, v157
    v_cvt_pk_bf16_f32 v149, v158, v159
    buffer_store_dwordx2 v[148:149], v147, s[4:7], s25 offen offset:0 sc1
    v_cvt_pk_bf16_f32 v152, v48, v49
    v_cvt_pk_bf16_f32 v153, v50, v51
    v_cvt_pk_bf16_f32 v154, v64, v65
    v_cvt_pk_bf16_f32 v155, v66, v67
    v_lshlrev_b32 v156, 16, v152
    v_lshlrev_b32 v160, 16, v154
    v_and_b32 v157, 0xffff0000, v152
    v_and_b32 v161, 0xffff0000, v154
    v_lshlrev_b32 v158, 16, v153
    v_lshlrev_b32 v162, 16, v155
    v_and_b32 v159, 0xffff0000, v153
    v_and_b32 v163, 0xffff0000, v155
    v_mul_f32 v164, v156, v156
    v_mul_f32 v164, s26, v164
    v_fma_f32 v164, v164, v156, v156
    v_mul_f32 v164, s27, v164
    v_sub_f32 v164, 0, v164
    v_min_f32 v164, 0x42fc0000, v164
    v_mul_f32 v165, v157, v157
    v_mul_f32 v165, s26, v165
    v_fma_f32 v165, v165, v157, v157
    v_mul_f32 v165, s27, v165
    v_sub_f32 v165, 0, v165
    v_min_f32 v165, 0x42fc0000, v165
    v_mul_f32 v166, v158, v158
    v_mul_f32 v166, s26, v166
    v_fma_f32 v166, v166, v158, v158
    v_mul_f32 v166, s27, v166
    v_sub_f32 v166, 0, v166
    v_min_f32 v166, 0x42fc0000, v166
    v_mul_f32 v167, v159, v159
    v_mul_f32 v167, s26, v167
    v_fma_f32 v167, v167, v159, v159
    v_mul_f32 v167, s27, v167
    v_sub_f32 v167, 0, v167
    v_min_f32 v167, 0x42fc0000, v167
    v_exp_f32 v164, v164
    v_exp_f32 v165, v165
    v_exp_f32 v166, v166
    v_exp_f32 v167, v167
    v_add_f32 v164, 1.0, v164
    v_add_f32 v165, 1.0, v165
    v_add_f32 v166, 1.0, v166
    v_add_f32 v167, 1.0, v167
    v_rcp_f32 v164, v164
    v_rcp_f32 v165, v165
    v_rcp_f32 v166, v166
    v_rcp_f32 v167, v167
    s_nop 0
    v_mul_f32 v156, v156, v164
    v_mul_f32 v157, v157, v165
    v_mul_f32 v158, v158, v166
    v_mul_f32 v159, v159, v167
    v_cvt_pk_bf16_f32 v152, v156, v157
    v_cvt_pk_bf16_f32 v153, v158, v159
    v_lshlrev_b32 v156, 16, v152
    v_mul_f32 v156, v156, v160
    v_and_b32 v157, 0xffff0000, v152
    v_mul_f32 v157, v157, v161
    v_lshlrev_b32 v158, 16, v153
    v_mul_f32 v158, v158, v162
    v_and_b32 v159, 0xffff0000, v153
    v_mul_f32 v159, v159, v163
    v_cvt_pk_bf16_f32 v150, v156, v157
    v_cvt_pk_bf16_f32 v151, v158, v159
    buffer_store_dwordx2 v[150:151], v147, s[4:7], s25 offen offset:32 sc1
    s_add_u32 s25, s24, 49152
    v_cvt_pk_bf16_f32 v152, v20, v21
    v_cvt_pk_bf16_f32 v153, v22, v23
    v_cvt_pk_bf16_f32 v154, v36, v37
    v_cvt_pk_bf16_f32 v155, v38, v39
    v_lshlrev_b32 v156, 16, v152
    v_lshlrev_b32 v160, 16, v154
    v_and_b32 v157, 0xffff0000, v152
    v_and_b32 v161, 0xffff0000, v154
    v_lshlrev_b32 v158, 16, v153
    v_lshlrev_b32 v162, 16, v155
    v_and_b32 v159, 0xffff0000, v153
    v_and_b32 v163, 0xffff0000, v155
    v_mul_f32 v164, v156, v156
    v_mul_f32 v164, s26, v164
    v_fma_f32 v164, v164, v156, v156
    v_mul_f32 v164, s27, v164
    v_sub_f32 v164, 0, v164
    v_min_f32 v164, 0x42fc0000, v164
    v_mul_f32 v165, v157, v157
    v_mul_f32 v165, s26, v165
    v_fma_f32 v165, v165, v157, v157
    v_mul_f32 v165, s27, v165
    v_sub_f32 v165, 0, v165
    v_min_f32 v165, 0x42fc0000, v165
    v_mul_f32 v166, v158, v158
    v_mul_f32 v166, s26, v166
    v_fma_f32 v166, v166, v158, v158
    v_mul_f32 v166, s27, v166
    v_sub_f32 v166, 0, v166
    v_min_f32 v166, 0x42fc0000, v166
    v_mul_f32 v167, v159, v159
    v_mul_f32 v167, s26, v167
    v_fma_f32 v167, v167, v159, v159
    v_mul_f32 v167, s27, v167
    v_sub_f32 v167, 0, v167
    v_min_f32 v167, 0x42fc0000, v167
    v_exp_f32 v164, v164
    v_exp_f32 v165, v165
    v_exp_f32 v166, v166
    v_exp_f32 v167, v167
    v_add_f32 v164, 1.0, v164
    v_add_f32 v165, 1.0, v165
    v_add_f32 v166, 1.0, v166
    v_add_f32 v167, 1.0, v167
    v_rcp_f32 v164, v164
    v_rcp_f32 v165, v165
    v_rcp_f32 v166, v166
    v_rcp_f32 v167, v167
    s_nop 0
    v_mul_f32 v156, v156, v164
    v_mul_f32 v157, v157, v165
    v_mul_f32 v158, v158, v166
    v_mul_f32 v159, v159, v167
    v_cvt_pk_bf16_f32 v152, v156, v157
    v_cvt_pk_bf16_f32 v153, v158, v159
    v_lshlrev_b32 v156, 16, v152
    v_mul_f32 v156, v156, v160
    v_and_b32 v157, 0xffff0000, v152
    v_mul_f32 v157, v157, v161
    v_lshlrev_b32 v158, 16, v153
    v_mul_f32 v158, v158, v162
    v_and_b32 v159, 0xffff0000, v153
    v_mul_f32 v159, v159, v163
    v_cvt_pk_bf16_f32 v148, v156, v157
    v_cvt_pk_bf16_f32 v149, v158, v159
    buffer_store_dwordx2 v[148:149], v147, s[4:7], s25 offen offset:0 sc1
    v_cvt_pk_bf16_f32 v152, v52, v53
    v_cvt_pk_bf16_f32 v153, v54, v55
    v_cvt_pk_bf16_f32 v154, v68, v69
    v_cvt_pk_bf16_f32 v155, v70, v71
    v_lshlrev_b32 v156, 16, v152
    v_lshlrev_b32 v160, 16, v154
    v_and_b32 v157, 0xffff0000, v152
    v_and_b32 v161, 0xffff0000, v154
    v_lshlrev_b32 v158, 16, v153
    v_lshlrev_b32 v162, 16, v155
    v_and_b32 v159, 0xffff0000, v153
    v_and_b32 v163, 0xffff0000, v155
    v_mul_f32 v164, v156, v156
    v_mul_f32 v164, s26, v164
    v_fma_f32 v164, v164, v156, v156
    v_mul_f32 v164, s27, v164
    v_sub_f32 v164, 0, v164
    v_min_f32 v164, 0x42fc0000, v164
    v_mul_f32 v165, v157, v157
    v_mul_f32 v165, s26, v165
    v_fma_f32 v165, v165, v157, v157
    v_mul_f32 v165, s27, v165
    v_sub_f32 v165, 0, v165
    v_min_f32 v165, 0x42fc0000, v165
    v_mul_f32 v166, v158, v158
    v_mul_f32 v166, s26, v166
    v_fma_f32 v166, v166, v158, v158
    v_mul_f32 v166, s27, v166
    v_sub_f32 v166, 0, v166
    v_min_f32 v166, 0x42fc0000, v166
    v_mul_f32 v167, v159, v159
    v_mul_f32 v167, s26, v167
    v_fma_f32 v167, v167, v159, v159
    v_mul_f32 v167, s27, v167
    v_sub_f32 v167, 0, v167
    v_min_f32 v167, 0x42fc0000, v167
    v_exp_f32 v164, v164
    v_exp_f32 v165, v165
    v_exp_f32 v166, v166
    v_exp_f32 v167, v167
    v_add_f32 v164, 1.0, v164
    v_add_f32 v165, 1.0, v165
    v_add_f32 v166, 1.0, v166
    v_add_f32 v167, 1.0, v167
    v_rcp_f32 v164, v164
    v_rcp_f32 v165, v165
    v_rcp_f32 v166, v166
    v_rcp_f32 v167, v167
    s_nop 0
    v_mul_f32 v156, v156, v164
    v_mul_f32 v157, v157, v165
    v_mul_f32 v158, v158, v166
    v_mul_f32 v159, v159, v167
    v_cvt_pk_bf16_f32 v152, v156, v157
    v_cvt_pk_bf16_f32 v153, v158, v159
    v_lshlrev_b32 v156, 16, v152
    v_mul_f32 v156, v156, v160
    v_and_b32 v157, 0xffff0000, v152
    v_mul_f32 v157, v157, v161
    v_lshlrev_b32 v158, 16, v153
    v_mul_f32 v158, v158, v162
    v_and_b32 v159, 0xffff0000, v153
    v_mul_f32 v159, v159, v163
    v_cvt_pk_bf16_f32 v150, v156, v157
    v_cvt_pk_bf16_f32 v151, v158, v159
    buffer_store_dwordx2 v[150:151], v147, s[4:7], s25 offen offset:32 sc1
    s_add_u32 s25, s24, 98304
    v_cvt_pk_bf16_f32 v152, v24, v25
    v_cvt_pk_bf16_f32 v153, v26, v27
    v_cvt_pk_bf16_f32 v154, v40, v41
    v_cvt_pk_bf16_f32 v155, v42, v43
    v_lshlrev_b32 v156, 16, v152
    v_lshlrev_b32 v160, 16, v154
    v_and_b32 v157, 0xffff0000, v152
    v_and_b32 v161, 0xffff0000, v154
    v_lshlrev_b32 v158, 16, v153
    v_lshlrev_b32 v162, 16, v155
    v_and_b32 v159, 0xffff0000, v153
    v_and_b32 v163, 0xffff0000, v155
    v_mul_f32 v164, v156, v156
    v_mul_f32 v164, s26, v164
    v_fma_f32 v164, v164, v156, v156
    v_mul_f32 v164, s27, v164
    v_sub_f32 v164, 0, v164
    v_min_f32 v164, 0x42fc0000, v164
    v_mul_f32 v165, v157, v157
    v_mul_f32 v165, s26, v165
    v_fma_f32 v165, v165, v157, v157
    v_mul_f32 v165, s27, v165
    v_sub_f32 v165, 0, v165
    v_min_f32 v165, 0x42fc0000, v165
    v_mul_f32 v166, v158, v158
    v_mul_f32 v166, s26, v166
    v_fma_f32 v166, v166, v158, v158
    v_mul_f32 v166, s27, v166
    v_sub_f32 v166, 0, v166
    v_min_f32 v166, 0x42fc0000, v166
    v_mul_f32 v167, v159, v159
    v_mul_f32 v167, s26, v167
    v_fma_f32 v167, v167, v159, v159
    v_mul_f32 v167, s27, v167
    v_sub_f32 v167, 0, v167
    v_min_f32 v167, 0x42fc0000, v167
    v_exp_f32 v164, v164
    v_exp_f32 v165, v165
    v_exp_f32 v166, v166
    v_exp_f32 v167, v167
    v_add_f32 v164, 1.0, v164
    v_add_f32 v165, 1.0, v165
    v_add_f32 v166, 1.0, v166
    v_add_f32 v167, 1.0, v167
    v_rcp_f32 v164, v164
    v_rcp_f32 v165, v165
    v_rcp_f32 v166, v166
    v_rcp_f32 v167, v167
    s_nop 0
    v_mul_f32 v156, v156, v164
    v_mul_f32 v157, v157, v165
    v_mul_f32 v158, v158, v166
    v_mul_f32 v159, v159, v167
    v_cvt_pk_bf16_f32 v152, v156, v157
    v_cvt_pk_bf16_f32 v153, v158, v159
    v_lshlrev_b32 v156, 16, v152
    v_mul_f32 v156, v156, v160
    v_and_b32 v157, 0xffff0000, v152
    v_mul_f32 v157, v157, v161
    v_lshlrev_b32 v158, 16, v153
    v_mul_f32 v158, v158, v162
    v_and_b32 v159, 0xffff0000, v153
    v_mul_f32 v159, v159, v163
    v_cvt_pk_bf16_f32 v148, v156, v157
    v_cvt_pk_bf16_f32 v149, v158, v159
    buffer_store_dwordx2 v[148:149], v147, s[4:7], s25 offen offset:0 sc1
    v_cvt_pk_bf16_f32 v152, v56, v57
    v_cvt_pk_bf16_f32 v153, v58, v59
    v_cvt_pk_bf16_f32 v154, v72, v73
    v_cvt_pk_bf16_f32 v155, v74, v75
    v_lshlrev_b32 v156, 16, v152
    v_lshlrev_b32 v160, 16, v154
    v_and_b32 v157, 0xffff0000, v152
    v_and_b32 v161, 0xffff0000, v154
    v_lshlrev_b32 v158, 16, v153
    v_lshlrev_b32 v162, 16, v155
    v_and_b32 v159, 0xffff0000, v153
    v_and_b32 v163, 0xffff0000, v155
    v_mul_f32 v164, v156, v156
    v_mul_f32 v164, s26, v164
    v_fma_f32 v164, v164, v156, v156
    v_mul_f32 v164, s27, v164
    v_sub_f32 v164, 0, v164
    v_min_f32 v164, 0x42fc0000, v164
    v_mul_f32 v165, v157, v157
    v_mul_f32 v165, s26, v165
    v_fma_f32 v165, v165, v157, v157
    v_mul_f32 v165, s27, v165
    v_sub_f32 v165, 0, v165
    v_min_f32 v165, 0x42fc0000, v165
    v_mul_f32 v166, v158, v158
    v_mul_f32 v166, s26, v166
    v_fma_f32 v166, v166, v158, v158
    v_mul_f32 v166, s27, v166
    v_sub_f32 v166, 0, v166
    v_min_f32 v166, 0x42fc0000, v166
    v_mul_f32 v167, v159, v159
    v_mul_f32 v167, s26, v167
    v_fma_f32 v167, v167, v159, v159
    v_mul_f32 v167, s27, v167
    v_sub_f32 v167, 0, v167
    v_min_f32 v167, 0x42fc0000, v167
    v_exp_f32 v164, v164
    v_exp_f32 v165, v165
    v_exp_f32 v166, v166
    v_exp_f32 v167, v167
    v_add_f32 v164, 1.0, v164
    v_add_f32 v165, 1.0, v165
    v_add_f32 v166, 1.0, v166
    v_add_f32 v167, 1.0, v167
    v_rcp_f32 v164, v164
    v_rcp_f32 v165, v165
    v_rcp_f32 v166, v166
    v_rcp_f32 v167, v167
    s_nop 0
    v_mul_f32 v156, v156, v164
    v_mul_f32 v157, v157, v165
    v_mul_f32 v158, v158, v166
    v_mul_f32 v159, v159, v167
    v_cvt_pk_bf16_f32 v152, v156, v157
    v_cvt_pk_bf16_f32 v153, v158, v159
    v_lshlrev_b32 v156, 16, v152
    v_mul_f32 v156, v156, v160
    v_and_b32 v157, 0xffff0000, v152
    v_mul_f32 v157, v157, v161
    v_lshlrev_b32 v158, 16, v153
    v_mul_f32 v158, v158, v162
    v_and_b32 v159, 0xffff0000, v153
    v_mul_f32 v159, v159, v163
    v_cvt_pk_bf16_f32 v150, v156, v157
    v_cvt_pk_bf16_f32 v151, v158, v159
    buffer_store_dwordx2 v[150:151], v147, s[4:7], s25 offen offset:32 sc1
    s_add_u32 s25, s24, 147456
    v_cvt_pk_bf16_f32 v152, v28, v29
    v_cvt_pk_bf16_f32 v153, v30, v31
    v_cvt_pk_bf16_f32 v154, v44, v45
    v_cvt_pk_bf16_f32 v155, v46, v47
    v_lshlrev_b32 v156, 16, v152
    v_lshlrev_b32 v160, 16, v154
    v_and_b32 v157, 0xffff0000, v152
    v_and_b32 v161, 0xffff0000, v154
    v_lshlrev_b32 v158, 16, v153
    v_lshlrev_b32 v162, 16, v155
    v_and_b32 v159, 0xffff0000, v153
    v_and_b32 v163, 0xffff0000, v155
    v_mul_f32 v164, v156, v156
    v_mul_f32 v164, s26, v164
    v_fma_f32 v164, v164, v156, v156
    v_mul_f32 v164, s27, v164
    v_sub_f32 v164, 0, v164
    v_min_f32 v164, 0x42fc0000, v164
    v_mul_f32 v165, v157, v157
    v_mul_f32 v165, s26, v165
    v_fma_f32 v165, v165, v157, v157
    v_mul_f32 v165, s27, v165
    v_sub_f32 v165, 0, v165
    v_min_f32 v165, 0x42fc0000, v165
    v_mul_f32 v166, v158, v158
    v_mul_f32 v166, s26, v166
    v_fma_f32 v166, v166, v158, v158
    v_mul_f32 v166, s27, v166
    v_sub_f32 v166, 0, v166
    v_min_f32 v166, 0x42fc0000, v166
    v_mul_f32 v167, v159, v159
    v_mul_f32 v167, s26, v167
    v_fma_f32 v167, v167, v159, v159
    v_mul_f32 v167, s27, v167
    v_sub_f32 v167, 0, v167
    v_min_f32 v167, 0x42fc0000, v167
    v_exp_f32 v164, v164
    v_exp_f32 v165, v165
    v_exp_f32 v166, v166
    v_exp_f32 v167, v167
    v_add_f32 v164, 1.0, v164
    v_add_f32 v165, 1.0, v165
    v_add_f32 v166, 1.0, v166
    v_add_f32 v167, 1.0, v167
    v_rcp_f32 v164, v164
    v_rcp_f32 v165, v165
    v_rcp_f32 v166, v166
    v_rcp_f32 v167, v167
    s_nop 0
    v_mul_f32 v156, v156, v164
    v_mul_f32 v157, v157, v165
    v_mul_f32 v158, v158, v166
    v_mul_f32 v159, v159, v167
    v_cvt_pk_bf16_f32 v152, v156, v157
    v_cvt_pk_bf16_f32 v153, v158, v159
    v_lshlrev_b32 v156, 16, v152
    v_mul_f32 v156, v156, v160
    v_and_b32 v157, 0xffff0000, v152
    v_mul_f32 v157, v157, v161
    v_lshlrev_b32 v158, 16, v153
    v_mul_f32 v158, v158, v162
    v_and_b32 v159, 0xffff0000, v153
    v_mul_f32 v159, v159, v163
    v_cvt_pk_bf16_f32 v148, v156, v157
    v_cvt_pk_bf16_f32 v149, v158, v159
    buffer_store_dwordx2 v[148:149], v147, s[4:7], s25 offen offset:0 sc1
    v_cvt_pk_bf16_f32 v152, v60, v61
    v_cvt_pk_bf16_f32 v153, v62, v63
    v_cvt_pk_bf16_f32 v154, v76, v77
    v_cvt_pk_bf16_f32 v155, v78, v79
    v_lshlrev_b32 v156, 16, v152
    v_lshlrev_b32 v160, 16, v154
    v_and_b32 v157, 0xffff0000, v152
    v_and_b32 v161, 0xffff0000, v154
    v_lshlrev_b32 v158, 16, v153
    v_lshlrev_b32 v162, 16, v155
    v_and_b32 v159, 0xffff0000, v153
    v_and_b32 v163, 0xffff0000, v155
    v_mul_f32 v164, v156, v156
    v_mul_f32 v164, s26, v164
    v_fma_f32 v164, v164, v156, v156
    v_mul_f32 v164, s27, v164
    v_sub_f32 v164, 0, v164
    v_min_f32 v164, 0x42fc0000, v164
    v_mul_f32 v165, v157, v157
    v_mul_f32 v165, s26, v165
    v_fma_f32 v165, v165, v157, v157
    v_mul_f32 v165, s27, v165
    v_sub_f32 v165, 0, v165
    v_min_f32 v165, 0x42fc0000, v165
    v_mul_f32 v166, v158, v158
    v_mul_f32 v166, s26, v166
    v_fma_f32 v166, v166, v158, v158
    v_mul_f32 v166, s27, v166
    v_sub_f32 v166, 0, v166
    v_min_f32 v166, 0x42fc0000, v166
    v_mul_f32 v167, v159, v159
    v_mul_f32 v167, s26, v167
    v_fma_f32 v167, v167, v159, v159
    v_mul_f32 v167, s27, v167
    v_sub_f32 v167, 0, v167
    v_min_f32 v167, 0x42fc0000, v167
    v_exp_f32 v164, v164
    v_exp_f32 v165, v165
    v_exp_f32 v166, v166
    v_exp_f32 v167, v167
    v_add_f32 v164, 1.0, v164
    v_add_f32 v165, 1.0, v165
    v_add_f32 v166, 1.0, v166
    v_add_f32 v167, 1.0, v167
    v_rcp_f32 v164, v164
    v_rcp_f32 v165, v165
    v_rcp_f32 v166, v166
    v_rcp_f32 v167, v167
    s_nop 0
    v_mul_f32 v156, v156, v164
    v_mul_f32 v157, v157, v165
    v_mul_f32 v158, v158, v166
    v_mul_f32 v159, v159, v167
    v_cvt_pk_bf16_f32 v152, v156, v157
    v_cvt_pk_bf16_f32 v153, v158, v159
    v_lshlrev_b32 v156, 16, v152
    v_mul_f32 v156, v156, v160
    v_and_b32 v157, 0xffff0000, v152
    v_mul_f32 v157, v157, v161
    v_lshlrev_b32 v158, 16, v153
    v_mul_f32 v158, v158, v162
    v_and_b32 v159, 0xffff0000, v153
    v_mul_f32 v159, v159, v163
    v_cvt_pk_bf16_f32 v150, v156, v157
    v_cvt_pk_bf16_f32 v151, v158, v159
    buffer_store_dwordx2 v[150:151], v147, s[4:7], s25 offen offset:32 sc1
    s_branch wk_fin
wk_ffn2:
    v_and_b32 v1, 15, v0
    v_bfe_u32 v2, v0, 4, 2
    v_mul_u32_u24 v4, 3072, v1
    v_lshl_add_u32 v4, v2, 4, v4
    v_mul_u32_u24 v5, 3072, v1
    v_lshl_add_u32 v5, v2, 4, v5
    s_mul_i32 s20, s16, 98304
    s_add_u32 s20, s20, 38010880
    s_mul_i32 s21, s17, 98304
    s_add_u32 s21, s21, 241139712
    s_mul_i32 s22, s52, 768
    s_add_u32 s20, s20, s22
    s_add_u32 s21, s21, s22
    s_add_u32 s24, s20, 0
    s_add_u32 s25, s20, 49152
    s_add_u32 s28, s21, 0
    s_add_u32 s29, s21, 49152
    buffer_load_dwordx4 v[32:35], v4, s[4:7], s24 offen offset:0 sc1
    buffer_load_dwordx4 v[36:39], v4, s[4:7], s25 offen offset:0 sc1
    buffer_load_dwordx4 v[48:51], v4, s[4:7], s24 offen offset:64 sc1
    buffer_load_dwordx4 v[52:55], v4, s[4:7], s25 offen offset:64 sc1
    buffer_load_dwordx4 v[64:67], v4, s[4:7], s24 offen offset:128 sc1
    buffer_load_dwordx4 v[68:71], v4, s[4:7], s25 offen offset:128 sc1
    buffer_load_dwordx4 v[80:83], v4, s[4:7], s24 offen offset:192 sc1
    buffer_load_dwordx4 v[84:87], v4, s[4:7], s25 offen offset:192 sc1
    buffer_load_dwordx4 v[96:99], v4, s[4:7], s24 offen offset:256 sc1
    buffer_load_dwordx4 v[100:103], v4, s[4:7], s25 offen offset:256 sc1
    buffer_load_dwordx4 v[112:115], v4, s[4:7], s24 offen offset:320 sc1
    buffer_load_dwordx4 v[116:119], v4, s[4:7], s25 offen offset:320 sc1
    buffer_load_dwordx4 v[128:131], v4, s[4:7], s24 offen offset:384 sc1
    buffer_load_dwordx4 v[132:135], v4, s[4:7], s25 offen offset:384 sc1
    buffer_load_dwordx4 v[144:147], v4, s[4:7], s24 offen offset:448 sc1
    buffer_load_dwordx4 v[148:151], v4, s[4:7], s25 offen offset:448 sc1
    buffer_load_dwordx4 v[160:163], v4, s[4:7], s24 offen offset:512 sc1
    buffer_load_dwordx4 v[164:167], v4, s[4:7], s25 offen offset:512 sc1
    buffer_load_dwordx4 v[176:179], v4, s[4:7], s24 offen offset:576 sc1
    buffer_load_dwordx4 v[180:183], v4, s[4:7], s25 offen offset:576 sc1
    buffer_load_dwordx4 v[192:195], v4, s[4:7], s24 offen offset:640 sc1
    buffer_load_dwordx4 v[196:199], v4, s[4:7], s25 offen offset:640 sc1
    buffer_load_dwordx4 v[208:211], v4, s[4:7], s24 offen offset:704 sc1
    buffer_load_dwordx4 v[212:215], v4, s[4:7], s25 offen offset:704 sc1
    s_mov_b32 s36, 0
wk_wf:
    buffer_load_dword v6, off, s[4:7], s66 sc1
    s_waitcnt vmcnt(0)
    v_readfirstlane_b32 s35, v6
    s_add_u32 s36, s36, 1
    s_cmp_ge_u32 s36, 262144
    s_cbranch_scc1 chain_done
    s_cmp_ge_u32 s35, 96
    s_cbranch_scc1 wk_wf_ok
    s_sleep 4
    s_branch wk_wf
wk_wf_ok:
    buffer_load_dwordx4 v[40:43], v5, s[4:7], s28 offen offset:0 sc1
    buffer_load_dwordx4 v[44:47], v5, s[4:7], s29 offen offset:0 sc1
    buffer_load_dwordx4 v[56:59], v5, s[4:7], s28 offen offset:64 sc1
    buffer_load_dwordx4 v[60:63], v5, s[4:7], s29 offen offset:64 sc1
    buffer_load_dwordx4 v[72:75], v5, s[4:7], s28 offen offset:128 sc1
    buffer_load_dwordx4 v[76:79], v5, s[4:7], s29 offen offset:128 sc1
    buffer_load_dwordx4 v[88:91], v5, s[4:7], s28 offen offset:192 sc1
    buffer_load_dwordx4 v[92:95], v5, s[4:7], s29 offen offset:192 sc1
    buffer_load_dwordx4 v[104:107], v5, s[4:7], s28 offen offset:256 sc1
    buffer_load_dwordx4 v[108:111], v5, s[4:7], s29 offen offset:256 sc1
    buffer_load_dwordx4 v[120:123], v5, s[4:7], s28 offen offset:320 sc1
    buffer_load_dwordx4 v[124:127], v5, s[4:7], s29 offen offset:320 sc1
    buffer_load_dwordx4 v[136:139], v5, s[4:7], s28 offen offset:384 sc1
    buffer_load_dwordx4 v[140:143], v5, s[4:7], s29 offen offset:384 sc1
    buffer_load_dwordx4 v[152:155], v5, s[4:7], s28 offen offset:448 sc1
    buffer_load_dwordx4 v[156:159], v5, s[4:7], s29 offen offset:448 sc1
    buffer_load_dwordx4 v[168:171], v5, s[4:7], s28 offen offset:512 sc1
    buffer_load_dwordx4 v[172:175], v5, s[4:7], s29 offen offset:512 sc1
    buffer_load_dwordx4 v[184:187], v5, s[4:7], s28 offen offset:576 sc1
    buffer_load_dwordx4 v[188:191], v5, s[4:7], s29 offen offset:576 sc1
    buffer_load_dwordx4 v[200:203], v5, s[4:7], s28 offen offset:640 sc1
    buffer_load_dwordx4 v[204:207], v5, s[4:7], s29 offen offset:640 sc1
    buffer_load_dwordx4 v[216:219], v5, s[4:7], s28 offen offset:704 sc1
    buffer_load_dwordx4 v[220:223], v5, s[4:7], s29 offen offset:704 sc1
    v_mov_b32 v16, 0
    v_mov_b32 v17, 0
    v_mov_b32 v18, 0
    v_mov_b32 v19, 0
    v_mov_b32 v20, 0
    v_mov_b32 v21, 0
    v_mov_b32 v22, 0
    v_mov_b32 v23, 0
    v_mov_b32 v24, 0
    v_mov_b32 v25, 0
    v_mov_b32 v26, 0
    v_mov_b32 v27, 0
    v_mov_b32 v28, 0
    v_mov_b32 v29, 0
    v_mov_b32 v30, 0
    v_mov_b32 v31, 0
    s_waitcnt vmcnt(22)
    v_mfma_f32_16x16x32_bf16 v[16:19], v[32:35], v[40:43], v[16:19]
    v_mfma_f32_16x16x32_bf16 v[20:23], v[32:35], v[44:47], v[20:23]
    v_mfma_f32_16x16x32_bf16 v[24:27], v[36:39], v[40:43], v[24:27]
    v_mfma_f32_16x16x32_bf16 v[28:31], v[36:39], v[44:47], v[28:31]
    s_waitcnt vmcnt(20)
    v_mfma_f32_16x16x32_bf16 v[16:19], v[48:51], v[56:59], v[16:19]
    v_mfma_f32_16x16x32_bf16 v[20:23], v[48:51], v[60:63], v[20:23]
    v_mfma_f32_16x16x32_bf16 v[24:27], v[52:55], v[56:59], v[24:27]
    v_mfma_f32_16x16x32_bf16 v[28:31], v[52:55], v[60:63], v[28:31]
    s_waitcnt vmcnt(18)
    v_mfma_f32_16x16x32_bf16 v[16:19], v[64:67], v[72:75], v[16:19]
    v_mfma_f32_16x16x32_bf16 v[20:23], v[64:67], v[76:79], v[20:23]
    v_mfma_f32_16x16x32_bf16 v[24:27], v[68:71], v[72:75], v[24:27]
    v_mfma_f32_16x16x32_bf16 v[28:31], v[68:71], v[76:79], v[28:31]
    s_waitcnt vmcnt(16)
    v_mfma_f32_16x16x32_bf16 v[16:19], v[80:83], v[88:91], v[16:19]
    v_mfma_f32_16x16x32_bf16 v[20:23], v[80:83], v[92:95], v[20:23]
    v_mfma_f32_16x16x32_bf16 v[24:27], v[84:87], v[88:91], v[24:27]
    v_mfma_f32_16x16x32_bf16 v[28:31], v[84:87], v[92:95], v[28:31]
    s_waitcnt vmcnt(14)
    v_mfma_f32_16x16x32_bf16 v[16:19], v[96:99], v[104:107], v[16:19]
    v_mfma_f32_16x16x32_bf16 v[20:23], v[96:99], v[108:111], v[20:23]
    v_mfma_f32_16x16x32_bf16 v[24:27], v[100:103], v[104:107], v[24:27]
    v_mfma_f32_16x16x32_bf16 v[28:31], v[100:103], v[108:111], v[28:31]
    s_waitcnt vmcnt(12)
    v_mfma_f32_16x16x32_bf16 v[16:19], v[112:115], v[120:123], v[16:19]
    v_mfma_f32_16x16x32_bf16 v[20:23], v[112:115], v[124:127], v[20:23]
    v_mfma_f32_16x16x32_bf16 v[24:27], v[116:119], v[120:123], v[24:27]
    v_mfma_f32_16x16x32_bf16 v[28:31], v[116:119], v[124:127], v[28:31]
    s_waitcnt vmcnt(10)
    v_mfma_f32_16x16x32_bf16 v[16:19], v[128:131], v[136:139], v[16:19]
    v_mfma_f32_16x16x32_bf16 v[20:23], v[128:131], v[140:143], v[20:23]
    v_mfma_f32_16x16x32_bf16 v[24:27], v[132:135], v[136:139], v[24:27]
    v_mfma_f32_16x16x32_bf16 v[28:31], v[132:135], v[140:143], v[28:31]
    s_waitcnt vmcnt(8)
    v_mfma_f32_16x16x32_bf16 v[16:19], v[144:147], v[152:155], v[16:19]
    v_mfma_f32_16x16x32_bf16 v[20:23], v[144:147], v[156:159], v[20:23]
    v_mfma_f32_16x16x32_bf16 v[24:27], v[148:151], v[152:155], v[24:27]
    v_mfma_f32_16x16x32_bf16 v[28:31], v[148:151], v[156:159], v[28:31]
    s_waitcnt vmcnt(6)
    v_mfma_f32_16x16x32_bf16 v[16:19], v[160:163], v[168:171], v[16:19]
    v_mfma_f32_16x16x32_bf16 v[20:23], v[160:163], v[172:175], v[20:23]
    v_mfma_f32_16x16x32_bf16 v[24:27], v[164:167], v[168:171], v[24:27]
    v_mfma_f32_16x16x32_bf16 v[28:31], v[164:167], v[172:175], v[28:31]
    s_waitcnt vmcnt(4)
    v_mfma_f32_16x16x32_bf16 v[16:19], v[176:179], v[184:187], v[16:19]
    v_mfma_f32_16x16x32_bf16 v[20:23], v[176:179], v[188:191], v[20:23]
    v_mfma_f32_16x16x32_bf16 v[24:27], v[180:183], v[184:187], v[24:27]
    v_mfma_f32_16x16x32_bf16 v[28:31], v[180:183], v[188:191], v[28:31]
    s_waitcnt vmcnt(2)
    v_mfma_f32_16x16x32_bf16 v[16:19], v[192:195], v[200:203], v[16:19]
    v_mfma_f32_16x16x32_bf16 v[20:23], v[192:195], v[204:207], v[20:23]
    v_mfma_f32_16x16x32_bf16 v[24:27], v[196:199], v[200:203], v[24:27]
    v_mfma_f32_16x16x32_bf16 v[28:31], v[196:199], v[204:207], v[28:31]
    s_waitcnt vmcnt(0)
    v_mfma_f32_16x16x32_bf16 v[16:19], v[208:211], v[216:219], v[16:19]
    v_mfma_f32_16x16x32_bf16 v[20:23], v[208:211], v[220:223], v[20:23]
    v_mfma_f32_16x16x32_bf16 v[24:27], v[212:215], v[216:219], v[24:27]
    v_mfma_f32_16x16x32_bf16 v[28:31], v[212:215], v[220:223], v[28:31]
    s_nop 7
    v_and_b32 v6, 63, v0
    v_lshlrev_b32 v6, 4, v6
    s_cmp_eq_u32 s52, 0
    s_cbranch_scc1 wk_ffn2_w0a
    s_sub_u32 s22, s52, 1
    s_mul_i32 s22, s22, 4096
    v_add_u32 v7, s22, v6
    ds_write_b128 v7, v[16:19] offset:0
    ds_write_b128 v7, v[20:23] offset:1024
    ds_write_b128 v7, v[24:27] offset:2048
    ds_write_b128 v7, v[28:31] offset:3072
    s_waitcnt lgkmcnt(0)
wk_ffn2_w0a:
    s_barrier
    s_cmp_lg_u32 s52, 0
    s_cbranch_scc1 wk_fin
    ds_read_b128 v[32:35], v6 offset:0
    ds_read_b128 v[36:39], v6 offset:1024
    ds_read_b128 v[40:43], v6 offset:2048
    ds_read_b128 v[44:47], v6 offset:3072
    s_waitcnt lgkmcnt(0)
    v_add_f32 v16, v16, v32
    v_add_f32 v17, v17, v33
    v_add_f32 v18, v18, v34
    v_add_f32 v19, v19, v35
    v_add_f32 v20, v20, v36
    v_add_f32 v21, v21, v37
    v_add_f32 v22, v22, v38
    v_add_f32 v23, v23, v39
    v_add_f32 v24, v24, v40
    v_add_f32 v25, v25, v41
    v_add_f32 v26, v26, v42
    v_add_f32 v27, v27, v43
    v_add_f32 v28, v28, v44
    v_add_f32 v29, v29, v45
    v_add_f32 v30, v30, v46
    v_add_f32 v31, v31, v47
    ds_read_b128 v[32:35], v6 offset:4096
    ds_read_b128 v[36:39], v6 offset:5120
    ds_read_b128 v[40:43], v6 offset:6144
    ds_read_b128 v[44:47], v6 offset:7168
    s_waitcnt lgkmcnt(0)
    v_add_f32 v16, v16, v32
    v_add_f32 v17, v17, v33
    v_add_f32 v18, v18, v34
    v_add_f32 v19, v19, v35
    v_add_f32 v20, v20, v36
    v_add_f32 v21, v21, v37
    v_add_f32 v22, v22, v38
    v_add_f32 v23, v23, v39
    v_add_f32 v24, v24, v40
    v_add_f32 v25, v25, v41
    v_add_f32 v26, v26, v42
    v_add_f32 v27, v27, v43
    v_add_f32 v28, v28, v44
    v_add_f32 v29, v29, v45
    v_add_f32 v30, v30, v46
    v_add_f32 v31, v31, v47
    ds_read_b128 v[32:35], v6 offset:8192
    ds_read_b128 v[36:39], v6 offset:9216
    ds_read_b128 v[40:43], v6 offset:10240
    ds_read_b128 v[44:47], v6 offset:11264
    s_waitcnt lgkmcnt(0)
    v_add_f32 v16, v16, v32
    v_add_f32 v17, v17, v33
    v_add_f32 v18, v18, v34
    v_add_f32 v19, v19, v35
    v_add_f32 v20, v20, v36
    v_add_f32 v21, v21, v37
    v_add_f32 v22, v22, v38
    v_add_f32 v23, v23, v39
    v_add_f32 v24, v24, v40
    v_add_f32 v25, v25, v41
    v_add_f32 v26, v26, v42
    v_add_f32 v27, v27, v43
    v_add_f32 v28, v28, v44
    v_add_f32 v29, v29, v45
    v_add_f32 v30, v30, v46
    v_add_f32 v31, v31, v47
    s_mul_i32 s23, s17, 32
    v_add_u32 v49, s23, v1
    s_mul_i32 s22, s16, 32
    v_lshlrev_b32 v48, 2, v2
    v_add_u32 v48, s22, v48
    v_mul_u32_u24 v50, 1280, v49
    v_lshl_add_u32 v50, v48, 1, v50
    s_mov_b32 s24, 235896832
    s_add_u32 s25, s24, 0
    s_mov_b32 s26, 0
    buffer_load_dwordx2 v[76:77], v50, s[4:7], s25 offen offset:0 sc1
    buffer_load_dwordx2 v[78:79], v50, s[4:7], s25 offen offset:32 sc1
    s_waitcnt vmcnt(0)
    v_cvt_pk_bf16_f32 v64, v16, v17
    v_cvt_pk_bf16_f32 v65, v18, v19
    v_lshlrev_b32 v66, 16, v64
    v_lshlrev_b32 v70, 16, v76
    v_add_f32 v66, v66, v70
    v_and_b32 v67, 0xffff0000, v64
    v_and_b32 v71, 0xffff0000, v76
    v_add_f32 v67, v67, v71
    v_lshlrev_b32 v68, 16, v65
    v_lshlrev_b32 v72, 16, v77
    v_add_f32 v68, v68, v72
    v_and_b32 v69, 0xffff0000, v65
    v_and_b32 v73, 0xffff0000, v77
    v_add_f32 v69, v69, v73
    v_cvt_pk_bf16_f32 v52, v66, v67
    v_cvt_pk_bf16_f32 v53, v68, v69
    buffer_store_dwordx2 v[52:53], v50, s[12:15], s26 offen offset:0
    v_cvt_pk_bf16_f32 v64, v24, v25
    v_cvt_pk_bf16_f32 v65, v26, v27
    v_lshlrev_b32 v66, 16, v64
    v_lshlrev_b32 v70, 16, v78
    v_add_f32 v66, v66, v70
    v_and_b32 v67, 0xffff0000, v64
    v_and_b32 v71, 0xffff0000, v78
    v_add_f32 v67, v67, v71
    v_lshlrev_b32 v68, 16, v65
    v_lshlrev_b32 v72, 16, v79
    v_add_f32 v68, v68, v72
    v_and_b32 v69, 0xffff0000, v65
    v_and_b32 v73, 0xffff0000, v79
    v_add_f32 v69, v69, v73
    v_cvt_pk_bf16_f32 v54, v66, v67
    v_cvt_pk_bf16_f32 v55, v68, v69
    buffer_store_dwordx2 v[54:55], v50, s[12:15], s26 offen offset:32
    s_add_u32 s25, s24, 20480
    s_mov_b32 s26, 20480
    buffer_load_dwordx2 v[76:77], v50, s[4:7], s25 offen offset:0 sc1
    buffer_load_dwordx2 v[78:79], v50, s[4:7], s25 offen offset:32 sc1
    s_waitcnt vmcnt(0)
    v_cvt_pk_bf16_f32 v64, v20, v21
    v_cvt_pk_bf16_f32 v65, v22, v23
    v_lshlrev_b32 v66, 16, v64
    v_lshlrev_b32 v70, 16, v76
    v_add_f32 v66, v66, v70
    v_and_b32 v67, 0xffff0000, v64
    v_and_b32 v71, 0xffff0000, v76
    v_add_f32 v67, v67, v71
    v_lshlrev_b32 v68, 16, v65
    v_lshlrev_b32 v72, 16, v77
    v_add_f32 v68, v68, v72
    v_and_b32 v69, 0xffff0000, v65
    v_and_b32 v73, 0xffff0000, v77
    v_add_f32 v69, v69, v73
    v_cvt_pk_bf16_f32 v52, v66, v67
    v_cvt_pk_bf16_f32 v53, v68, v69
    buffer_store_dwordx2 v[52:53], v50, s[12:15], s26 offen offset:0
    v_cvt_pk_bf16_f32 v64, v28, v29
    v_cvt_pk_bf16_f32 v65, v30, v31
    v_lshlrev_b32 v66, 16, v64
    v_lshlrev_b32 v70, 16, v78
    v_add_f32 v66, v66, v70
    v_and_b32 v67, 0xffff0000, v64
    v_and_b32 v71, 0xffff0000, v78
    v_add_f32 v67, v67, v71
    v_lshlrev_b32 v68, 16, v65
    v_lshlrev_b32 v72, 16, v79
    v_add_f32 v68, v68, v72
    v_and_b32 v69, 0xffff0000, v65
    v_and_b32 v73, 0xffff0000, v79
    v_add_f32 v69, v69, v73
    v_cvt_pk_bf16_f32 v54, v66, v67
    v_cvt_pk_bf16_f32 v55, v68, v69
    buffer_store_dwordx2 v[54:55], v50, s[12:15], s26 offen offset:32
    s_branch wk_fin
wk_fin:
    s_mov_b64 exec, -1
    s_waitcnt vmcnt(0)
    s_barrier
    s_cmp_lg_u32 s52, 0
    s_cbranch_scc1 wk_nosig
    s_mov_b64 exec, 1
    v_mov_b32 v1, 1
    buffer_atomic_add v1, off, s[4:7], s53 sc1
    s_mov_b64 exec, -1
wk_nosig:
    s_branch wk_loop
chain_done:
    s_endpgm
.section .rodata,"a"
.p2align 6
.amdhsa_kernel prep_kernel
  .amdhsa_next_free_vgpr 32
  .amdhsa_next_free_sgpr 40
  .amdhsa_accum_offset 32
  .amdhsa_group_segment_fixed_size 0
  .amdhsa_kernarg_size 112
  .amdhsa_user_sgpr_count 2
  .amdhsa_user_sgpr_kernarg_segment_ptr 1
  .amdhsa_system_sgpr_workgroup_id_x 1
.end_amdhsa_kernel
.p2align 6
.amdhsa_kernel chain_kernel
  .amdhsa_next_free_vgpr 512
  .amdhsa_next_free_sgpr 72
  .amdhsa_accum_offset 256
  .amdhsa_group_segment_fixed_size 0
  .amdhsa_kernarg_size 112
  .amdhsa_user_sgpr_count 2
  .amdhsa_user_sgpr_kernarg_segment_ptr 1
  .amdhsa_system_sgpr_workgroup_id_x 1
.end_amdhsa_kernel
```
